```python
import torch

def _softmax(x, axis=-1):
    return torch.softmax(x, dim=axis)
def _gelu(x):
    return torch.nn.functional.gelu(x, approximate="tanh")
def _silu(x):
    return torch.nn.functional.silu(x)
def _sigmoid(x):
    return torch.sigmoid(x)
def _layernorm(x, axis=-1, eps=1e-5):
    m = x.mean(dim=axis, keepdim=True)
    v = x.var(dim=axis, keepdim=True, unbiased=False)
    return (x - m) / torch.sqrt(v + eps)
def _scatter_add(tgt, idx, src, axis=0):
    return tgt.clone().index_add_(axis, idx, src)
def _segment_sum(src, seg, n):
    out = torch.zeros((n,) + src.shape[1:], dtype=src.dtype)
    return out.index_add_(0, seg, src)
def _pad(x, pw):
    flat = tuple(v for pair in reversed(pw) for v in pair)
    return torch.nn.functional.pad(x, flat)

kernel_name = 'sequential_preLN__sliding_block__mixer_s_mlp__prompt'

def setup_inputs():

    _w = (lambda a: (lambda t: t.to(torch.bfloat16) if t.is_floating_point() else t)(torch.as_tensor(a)))
    def _A_setup():
        B, S, D = 1, 2048, 640
        return {
            "x": _w((lambda *s: torch.randn(*s, dtype=torch.bfloat16) * 0.05)(B, S, D)),
            "wqkv": _w((lambda *s: torch.randn(*s, dtype=torch.bfloat16) * 0.05)(D, 3 * D)),
            "wo": _w((lambda *s: torch.randn(*s, dtype=torch.bfloat16) * 0.05)(D, D)),
        }
    _A_in = _A_setup()

    def _B_setup():
        B, S, D, F = 1, 2048, 640, 1728
        return {
            "x":  _w((lambda *s: torch.randn(*s, dtype=torch.bfloat16) * 0.05)(B, S, D)),
            "w1": _w((lambda *s: torch.randn(*s, dtype=torch.bfloat16) * 3.2)(D, D) * (D ** -0.5)),
            "w2": _w((lambda *s: torch.randn(*s, dtype=torch.bfloat16) * 3.2)(D, D) * (D ** -0.5)),
            "w3": _w((lambda *s: torch.randn(*s, dtype=torch.bfloat16) * 3.2)(D, F) * (D ** -0.5)),
            "w4": _w((lambda *s: torch.randn(*s, dtype=torch.bfloat16) * 3.2)(F, D) * (F ** -0.5)),
        }
    _B_in = _B_setup()

    return {
        "A_x": _A_in["x"],
        "A_wqkv": _A_in["wqkv"],
        "A_wo": _A_in["wo"],
        "B_x": _B_in["x"],
        "B_w1": _B_in["w1"],
        "B_w2": _B_in["w2"],
        "B_w3": _B_in["w3"],
        "B_w4": _B_in["w4"],
    }

def reference(A_x, A_wqkv, A_wo, B_x, B_w1, B_w2, B_w3, B_w4):
    def _A_ref(x, wqkv, wo):
        B, S, D = x.shape
        H = 32; Dh = D // H; W = 256
        qkv = (lambda x, *d: x.permute(*d))((x @ wqkv).reshape(B, S, 3, H, Dh), 2, 0, 3, 1, 4)
        q, k, v = qkv[0], qkv[1], qkv[2]
        scores = torch.einsum("bhqd,bhkd->bhqk", q, k) * (Dh ** -0.5)
        idx = torch.arange(S)
        mask = (idx[:, None] - idx[None, :] >= 0) & (idx[:, None] - idx[None, :] < W)
        scores = torch.where(mask[None, None], scores, -1e9)
        p = _softmax(scores, axis=-1)
        o = torch.einsum("bhqk,bhkd->bhqd", p, v)
        return (lambda x, *d: x.permute(*d))(o, 0, 2, 1, 3).reshape(B, S, D) @ wo

    def _B_ref(x, w1, w2, w3, w4):
        B, S, D = x.shape
        h = _gelu(_layernorm(x, axis=-1) @ w1)
        c = D // 4
        g0 = _pad(h[:, :, 0*c:1*c], ((0, 0), (1, 0), (0, 0)))[:, :S, :]
        g1 = _pad(h[:, :, 1*c:2*c], ((0, 0), (0, 1), (0, 0)))[:, 1:, :]
        g2 = _pad(h[:, :, 2*c:3*c], ((0, 0), (2, 0), (0, 0)))[:, :S, :]
        g3 = _pad(h[:, :, 3*c:   ], ((0, 0), (0, 2), (0, 0)))[:, 2:, :]
        hs = torch.concatenate([g0, g1, g2, g3], axis=-1) @ w2
        x1 = x + hs
        h2 = _gelu(_layernorm(x1, axis=-1) @ w3) @ w4
        return x1 + h2

    x = A_x
    h = x + _A_ref(_layernorm(x, axis=-1), A_wqkv, A_wo)
    h2 = h + _B_ref(_layernorm(h, axis=-1), B_w1, B_w2, B_w3, B_w4)
    return h2
```

```asm
; @launch grid=(256,1,1) block=(256,1,1) lds=163840
.amdgcn_target "amdgcn-amd-amdhsa--gfx950"
.text
.globl sequential_preLN__sliding_block__mixer_s_mlp__prompt_kernel
.p2align 8
.type sequential_preLN__sliding_block__mixer_s_mlp__prompt_kernel,@function
sequential_preLN__sliding_block__mixer_s_mlp__prompt_kernel:
  s_cmp_ge_u32 s2, 256
  s_cbranch_scc1 Lend
  s_load_dwordx16 s[64:79], s[0:1], 0
  s_load_dwordx4 s[80:83], s[0:1], 64
  s_load_dwordx2 s[84:85], s[0:1], 80
  s_getpc_b64 s[88:89]
  s_and_b32 s89, s89, 0xffff
  s_mov_b32 s90, CODE_BYTES
  s_mov_b32 s91, 0x20000
  s_lshr_b32 s54, s2, 3
  s_lshl_b32 s58, s54, 11
  v_lshlrev_b32 v5, 3, v0
  v_and_b32 v6, 3, v0
  v_lshl_add_u32 v5, v6, 7, v5
  s_mov_b64 exec, 15
  buffer_load_dword v244, v5, s[88:91], s58 offen
  s_mov_b64 exec, -1
  s_getreg_b32 s51, hwreg(HW_REG_XCC_ID)
  v_and_b32 v1, 63, v0
  v_lshrrev_b32 v5, 6, v0
  v_and_b32 v2, 15, v0
  v_readfirstlane_b32 s52, v5
  v_lshrrev_b32 v3, 4, v1
  v_lshlrev_b32 v4, 4, v1
  v_mov_b32 v251, 0
  s_and_b32 s53, s2, 7
  s_mov_b32 s10, 2621440
  s_mov_b32 s11, 0x20000
  s_mov_b32 s14, 2457600
  s_mov_b32 s15, 0x20000
  s_mov_b32 s18, 819200
  s_mov_b32 s19, 0x20000
  s_mov_b32 s22, 819200
  s_mov_b32 s23, 0x20000
  s_mov_b32 s26, 819200
  s_mov_b32 s27, 0x20000
  s_mov_b32 s30, 2211840
  s_mov_b32 s31, 0x20000
  s_mov_b32 s34, 2211840
  s_mov_b32 s35, 0x20000
  s_mov_b32 s38, 2621440
  s_mov_b32 s39, 0x20000
  s_mov_b32 s42, 29360128
  s_mov_b32 s43, 0x20000
  s_lshr_b32 s58, s54, 3
  s_lshr_b32 s92, s53, 1
  s_lshl_b32 s92, s92, 2
  s_add_u32 s92, s92, s58
  s_and_b32 s93, s54, 7
  s_and_b32 s58, s53, 1
  s_lshl_b32 s58, s58, 3
  s_add_u32 s93, s93, s58
  s_lshl_b32 s58, s92, 4
  s_add_u32 s58, s58, s93
  s_lshl_b32 s58, s58, 2
  s_add_u32 s58, s58, s52
  s_lshl_b32 s50, s58, 1
  v_lshrrev_b32 v5, 5, v1
  v_mul_u32_u24 v5, 1280, v5
  v_and_b32 v6, 31, v1
  v_lshl_add_u32 v236, v6, 4, v5
  v_mov_b32 v7, 2147483648
  v_cmp_gt_u32 vcc, 16, v6
  s_nop 1
  v_cndmask_b32 v237, v7, v236, vcc
  s_cmp_eq_u32 s93, 15
  s_nop 0
  s_cbranch_scc1 Lspare
  s_mul_i32 s47, s92, 15
  s_add_u32 s47, s47, s93
  s_lshr_b32 s88, s47, 1
  s_min_u32 s88, s88, 113
  s_getpc_b64 s[90:91]
Lpct_1:
  s_add_u32 s90, s90, Lrtab-Lpct_1
  s_addc_u32 s91, s91, 0
  v_lshrrev_b32 v5, 3, v1
  v_mul_u32_u24 v7, 1280, v5
  v_xor_b32 v6, v3, v1
  v_and_b32 v6, 7, v6
  v_lshl_add_u32 v8, v6, 4, v7
  v_xor_b32 v9, 64, v8
  v_add_u32 v9, 10240, v9
  v_add_u32 v10, 20480, v8
  v_add_u32 v11, 20480, v9
  v_lshrrev_b32 v6, 1, v2
  v_xor_b32 v6, v6, v3
  v_lshlrev_b32 v6, 5, v6
  v_and_b32 v7, 1, v1
  v_lshl_add_u32 v6, v7, 4, v6
  v_mul_u32_u24 v5, 3840, v3
  v_add_u32 v12, v5, v6
  v_add_u32 v13, 15360, v12
  v_xor_b32 v6, 128, v6
  v_add3_u32 v14, v5, v6, 0
  v_add_u32 v14, 30720, v14
  v_add_u32 v15, 15360, v14
  s_add_u32 s58, s92, s93
  s_mul_i32 s59, s58, 683
  s_lshr_b32 s59, s59, 11
  s_mul_i32 s59, s59, 3
  s_sub_u32 s4, s58, s59
  s_mul_i32 s4, s4, 3
  s_lshl_b32 s58, s92, 7
  s_lshl_b32 s59, s52, 5
  s_add_u32 s58, s58, s59
  s_mul_i32 s6, s58, 1280
  s_mul_i32 s59, s52, 61440
  s_lshl_b32 s58, s93, 8
  s_add_u32 s7, s58, s59
  s_lshl_b32 s46, s52, 12
  s_lshl_b32 s94, s4, 7
  s_add_u32 s94, s94, s6
  s_mul_i32 s95, s4, 245760
  s_add_u32 s95, s95, s7
  s_add_u32 s4, s6, 1280
  s_waitcnt lgkmcnt(0)
  s_mov_b32 s8, s64
  s_and_b32 s9, s65, 0xffff
  s_mov_b32 s12, s66
  s_and_b32 s13, s67, 0xffff
  s_lshl_b32 s58, s88, 2
  s_load_dword s5, s[90:91], s58
  s_add_u32 m0, s46, 0
  s_nop 0
  buffer_load_dwordx4 v8, s[8:11], s94 offen  lds
  s_add_u32 m0, s46, 1024
  s_nop 0
  buffer_load_dwordx4 v9, s[8:11], s94 offen  lds
  s_add_u32 m0, s46, 2048
  s_nop 0
  buffer_load_dwordx4 v10, s[8:11], s94 offen  lds
  s_add_u32 m0, s46, 3072
  s_nop 0
  buffer_load_dwordx4 v11, s[8:11], s94 offen  lds
  s_add_u32 m0, s46, 16384
  s_nop 0
  buffer_load_dwordx4 v12, s[12:15], s95 offen  lds
  s_add_u32 m0, s46, 17408
  s_nop 0
  buffer_load_dwordx4 v13, s[12:15], s95 offen  lds
  s_add_u32 m0, s46, 18432
  s_nop 0
  buffer_load_dwordx4 v14, s[12:15], s95 offen  lds
  s_add_u32 m0, s46, 19456
  s_nop 0
  buffer_load_dwordx4 v15, s[12:15], s95 offen  lds
  s_add_u32 s94, s94, 128
  s_add_u32 s95, s95, 245760
  s_cmp_eq_u32 s94, s4
  s_cselect_b32 s94, s6, s94
  s_cselect_b32 s95, s7, s95
  s_mov_b32 s16, s68
  s_and_b32 s17, s69, 0xffff
  s_mov_b32 s20, s72
  s_and_b32 s21, s73, 0xffff
  s_mov_b32 s24, s74
  s_and_b32 s25, s75, 0xffff
  s_mov_b32 s28, s76
  s_and_b32 s29, s77, 0xffff
  s_mov_b32 s32, s78
  s_and_b32 s33, s79, 0xffff
  s_mov_b32 s36, s80
  s_and_b32 s37, s81, 0xffff
  s_mov_b32 s40, s84
  s_and_b32 s41, s85, 0xffff
  s_add_u32 s86, s84, 21209088
  s_addc_u32 s87, s85, 0
  s_load_dword s3, s[86:87], 0
  s_and_b32 s51, s51, 15
  s_mov_b32 s55, 0
  s_lshr_b32 s58, s54, 3
  s_lshl_b32 s58, s58, 2
  s_add_u32 s58, s58, s52
  s_lshl_b32 s59, s53, 4
  s_add_u32 s56, s58, s59
  s_lshl_b32 s44, s58, 8
  s_mul_i32 s59, s53, 1310720
  s_add_u32 s44, s44, s59
  s_and_b32 s57, s54, 7
  v_lshlrev_b32 v248, 4, v2
  v_lshl_add_u32 v248, v3, 12, v248
  s_mov_b32 s64, s47
  s_mul_i32 s65, s52, 3072
  s_add_u32 s65, s65, 151552
  s_lshr_b32 s58, s52, 1
  s_lshl_b32 s58, s58, 13
  v_lshrrev_b32 v5, 1, v2
  v_xor_b32 v5, v5, v3
  v_lshlrev_b32 v5, 4, v5
  v_lshl_add_u32 v5, v2, 7, v5
  v_add_u32 v16, s58, v5
  v_xor_b32 v17, 64, v16
  s_and_b32 s59, s52, 1
  s_lshl_b32 s59, s59, 2
  v_lshrrev_b32 v5, 2, v2
  v_and_b32 v6, 1, v3
  v_lshl_or_b32 v6, v6, 2, v5
  v_xor_b32 v6, s59, v6
  v_lshl_add_u32 v5, v3, 3, v5
  v_lshlrev_b32 v5, 8, v5
  v_and_b32 v7, 3, v1
  v_lshl_add_u32 v5, v7, 3, v5
  v_add_u32 v5, 16384, v5
  v_xor_b32 v7, 0, v6
  v_lshl_add_u32 v18, v7, 5, v5
  v_xor_b32 v7, 1, v6
  v_lshl_add_u32 v19, v7, 5, v5
  v_xor_b32 v7, 2, v6
  v_lshl_add_u32 v20, v7, 5, v5
  v_xor_b32 v7, 3, v6
  v_lshl_add_u32 v21, v7, 5, v5
  v_mov_b32 v208, 0x3f803f80
  v_mov_b32 v209, 0x3f803f80
  v_mov_b32 v210, 0x3f803f80
  v_mov_b32 v211, 0x3f803f80
  v_cmp_eq_u32 vcc, 0, v2
  s_nop 1
  v_cndmask_b32 v212, 0, v208, vcc
  v_cndmask_b32 v213, 0, v208, vcc
  v_cndmask_b32 v214, 0, v208, vcc
  v_cndmask_b32 v215, 0, v208, vcc
  v_cmp_eq_u32 vcc, 1, v2
  s_nop 1
  v_cndmask_b32 v216, 0, v208, vcc
  v_cndmask_b32 v217, 0, v208, vcc
  v_cndmask_b32 v218, 0, v208, vcc
  v_cndmask_b32 v219, 0, v208, vcc
  v_cmp_eq_u32 vcc, 2, v2
  s_nop 1
  v_cndmask_b32 v220, 0, v208, vcc
  v_cndmask_b32 v221, 0, v208, vcc
  v_cndmask_b32 v222, 0, v208, vcc
  v_cndmask_b32 v223, 0, v208, vcc
  v_cmp_eq_u32 vcc, 3, v2
  s_nop 1
  v_cndmask_b32 v224, 0, v208, vcc
  v_cndmask_b32 v225, 0, v208, vcc
  v_cndmask_b32 v226, 0, v208, vcc
  v_cndmask_b32 v227, 0, v208, vcc
  v_cmp_eq_u32 vcc, 4, v2
  s_nop 1
  v_cndmask_b32 v228, 0, v208, vcc
  v_cndmask_b32 v229, 0, v208, vcc
  v_cndmask_b32 v230, 0, v208, vcc
  v_cndmask_b32 v231, 0, v208, vcc
  v_lshlrev_b32 v5, 6, v2
  v_lshl_add_u32 v31, v3, 4, v5
  v_mov_b32 v5, 2147483648
  v_cmp_gt_u32 vcc, 8, v2
  s_nop 1
  v_cndmask_b32 v31, v5, v31, vcc
  v_lshrrev_b32 v5, 2, v1
  v_and_b32 v6, 3, v1
  v_lshlrev_b32 v5, 7, v5
  v_lshl_add_u32 v30, v6, 3, v5
  v_add_u32 v30, 131072, v30
  v_add_u32 v22, 0x10000, v16
  v_add_u32 v23, 0x10000, v17
  v_add_u32 v24, 0x10000, v18
  v_add_u32 v25, 0x10000, v19
  v_add_u32 v26, 0x10000, v20
  v_add_u32 v27, 0x10000, v21
  s_add_u32 m0, s46, 32768
  s_nop 0
  buffer_load_dwordx4 v8, s[8:11], s94 offen  lds
  s_add_u32 m0, s46, 33792
  s_nop 0
  buffer_load_dwordx4 v9, s[8:11], s94 offen  lds
  s_add_u32 m0, s46, 34816
  s_nop 0
  buffer_load_dwordx4 v10, s[8:11], s94 offen  lds
  s_add_u32 m0, s46, 35840
  s_nop 0
  buffer_load_dwordx4 v11, s[8:11], s94 offen  lds
  s_add_u32 m0, s46, 49152
  s_nop 0
  buffer_load_dwordx4 v12, s[12:15], s95 offen  lds
  s_add_u32 m0, s46, 50176
  s_nop 0
  buffer_load_dwordx4 v13, s[12:15], s95 offen  lds
  s_add_u32 m0, s46, 51200
  s_nop 0
  buffer_load_dwordx4 v14, s[12:15], s95 offen  lds
  s_add_u32 m0, s46, 52224
  s_nop 0
  buffer_load_dwordx4 v15, s[12:15], s95 offen  lds
  s_add_u32 s94, s94, 128
  s_add_u32 s95, s95, 245760
  s_cmp_eq_u32 s94, s4
  s_cselect_b32 s94, s6, s94
  s_cselect_b32 s95, s7, s95
  s_waitcnt lgkmcnt(0)
  s_add_u32 s3, s3, 0x9e3779b9
  s_waitcnt vmcnt(8)
  s_barrier
  ds_read_b128 v[144:147], v16 offset:0
  ds_read_b64_tr_b16 v[176:177], v18 offset:0
  ds_read_b64_tr_b16 v[178:179], v18 offset:1024
  ds_read_b128 v[148:151], v16 offset:2048
  ds_read_b64_tr_b16 v[180:181], v19 offset:0
  ds_read_b64_tr_b16 v[182:183], v19 offset:1024
  ds_read_b128 v[152:155], v16 offset:4096
  ds_read_b64_tr_b16 v[184:185], v20 offset:0
  ds_read_b64_tr_b16 v[186:187], v20 offset:1024
  ds_read_b128 v[156:159], v16 offset:6144
  ds_read_b64_tr_b16 v[188:189], v21 offset:0
  ds_read_b64_tr_b16 v[190:191], v21 offset:1024
  s_waitcnt lgkmcnt(0)
  v_mfma_f32_16x16x32_bf16 v[64:67], v[176:179], v[144:147], 0
  ds_read_b128 v[160:163], v17 offset:0
  s_add_u32 m0, s46, 65536
  s_mul_i32 s58, s50, 1280
  buffer_load_dwordx4 v[32:35], v236, s[8:11], s58 offen offset:0
  buffer_load_dwordx4 v[36:39], v236, s[8:11], s58 offen offset:512
  buffer_load_dwordx4 v[40:43], v237, s[8:11], s58 offen offset:1024
  v_mfma_f32_16x16x32_bf16 v[80:83], v[176:179], v[148:151], 0
  ds_read_b64_tr_b16 v[192:193], v18 offset:8192
  buffer_load_dwordx4 v8, s[8:11], s94 offen  lds
  s_cmp_lt_u32 s88, 20
  s_cselect_b32 s76, s16, s20
  s_cselect_b32 s77, s17, s21
  v_mfma_f32_16x16x32_bf16 v[96:99], v[176:179], v[152:155], 0
  ds_read_b64_tr_b16 v[194:195], v18 offset:9216
  s_add_u32 m0, s46, 66560
  s_cmp_lt_u32 s88, 40
  s_cselect_b32 s76, s76, s24
  s_cselect_b32 s77, s77, s25
  v_mfma_f32_16x16x32_bf16 v[112:115], v[176:179], v[156:159], 0
  ds_read_b128 v[164:167], v17 offset:2048
  buffer_load_dwordx4 v9, s[8:11], s94 offen  lds
  s_cmp_lt_u32 s88, 60
  s_cselect_b32 s76, s76, s32
  s_cselect_b32 s77, s77, s33
  s_cselect_b32 s78, s18, s34
  v_mfma_f32_16x16x32_bf16 v[128:131], v[176:179], v[208:211], 0
  ds_read_b64_tr_b16 v[196:197], v19 offset:8192
  s_add_u32 m0, s46, 67584
  s_nop 0
  buffer_load_dwordx4 v10, s[8:11], s94 offen  lds
  v_mfma_f32_16x16x32_bf16 v[68:71], v[180:183], v[144:147], 0
  ds_read_b64_tr_b16 v[198:199], v19 offset:9216
  s_cmp_lt_u32 s64, 228
  s_cselect_b32 s82, s78, 0
  s_cmp_lt_u32 s64, 228
  s_cselect_b32 s78, s82, 0
  s_mov_b32 s79, 0x20000
  s_add_u32 m0, s46, 68608
  v_mfma_f32_16x16x32_bf16 v[84:87], v[180:183], v[148:151], 0
  ds_read_b128 v[168:171], v17 offset:4096
  s_bfe_u32 s58, s5, 393234
  v_lshrrev_b32 v5, 5, v1
  v_mul_u32_u24 v5, s58, v5
  v_mfma_f32_16x16x32_bf16 v[100:103], v[180:183], v[152:155], 0
  ds_read_b64_tr_b16 v[200:201], v20 offset:8192
  buffer_load_dwordx4 v11, s[8:11], s94 offen  lds
  v_bfe_u32 v6, v1, 3, 2
  v_add_u32 v5, v5, v6
  v_mfma_f32_16x16x32_bf16 v[116:119], v[180:183], v[156:159], 0
  ds_read_b64_tr_b16 v[202:203], v20 offset:9216
  s_add_u32 m0, s46, 81920
  s_nop 0
  buffer_load_dwordx4 v12, s[12:15], s95 offen  lds
  v_mfma_f32_16x16x32_bf16 v[132:135], v[180:183], v[208:211], 0
  ds_read_b128 v[172:175], v17 offset:6144
  v_mul_u32_u24 v5, 1280, v5
  v_and_b32 v6, 7, v1
  s_add_u32 m0, s46, 82944
  v_mfma_f32_16x16x32_bf16 v[72:75], v[184:187], v[144:147], 0
  ds_read_b64_tr_b16 v[204:205], v21 offset:8192
  v_lshl_add_u32 v28, v6, 4, v5
  s_and_b32 s58, s5, 0x7ff
  buffer_load_dwordx4 v13, s[12:15], s95 offen  lds
  v_mfma_f32_16x16x32_bf16 v[88:91], v[184:187], v[148:151], 0
  ds_read_b64_tr_b16 v[206:207], v21 offset:9216
  s_bfe_u32 s59, s5, 458763
  s_lshr_b32 s60, s52, 1
  s_mul_i32 s59, s59, s60
  s_add_u32 m0, s46, 83968
  v_mfma_f32_16x16x32_bf16 v[104:107], v[184:187], v[152:155], 0
  s_add_u32 s58, s58, s59
  s_lshr_b32 s59, s5, 24
  s_and_b32 s60, s52, 1
  buffer_load_dwordx4 v14, s[12:15], s95 offen  lds
  v_mfma_f32_16x16x32_bf16 v[120:123], v[184:187], v[156:159], 0
  s_add_u32 m0, s46, 84992
  v_mfma_f32_16x16x32_bf16 v[136:139], v[184:187], v[208:211], 0
  s_mul_i32 s59, s59, s60
  s_add_u32 s58, s58, s59
  s_mul_i32 s58, s58, 1280
  buffer_load_dwordx4 v15, s[12:15], s95 offen  lds
  v_mfma_f32_16x16x32_bf16 v[76:79], v[188:191], v[144:147], 0
  s_and_b32 s59, s64, 1
  s_mul_i32 s59, s59, 640
  s_add_u32 s80, s58, s59
  s_add_u32 s94, s94, 128
  s_add_u32 s95, s95, 245760
  v_mfma_f32_16x16x32_bf16 v[92:95], v[188:191], v[148:151], 0
  s_lshl_b32 s81, s52, 10
  s_cmp_eq_u32 s94, s4
  s_cselect_b32 s94, s6, s94
  s_cselect_b32 s95, s7, s95
  v_mfma_f32_16x16x32_bf16 v[108:111], v[188:191], v[152:155], 0
  s_add_u32 m0, s81, 131072
  s_nop 0
  buffer_load_dwordx4 v28, s[76:79], s80 offen offset:0  lds
  s_add_u32 m0, s81, 135040
  s_nop 0
  buffer_load_dwordx4 v28, s[76:79], s80 offen offset:128  lds
  v_mfma_f32_16x16x32_bf16 v[124:127], v[188:191], v[156:159], 0
  s_add_u32 m0, s81, 139008
  s_nop 0
  buffer_load_dwordx4 v28, s[76:79], s80 offen offset:256  lds
  s_add_u32 m0, s81, 142976
  s_nop 0
  buffer_load_dwordx4 v28, s[76:79], s80 offen offset:384  lds
  v_mfma_f32_16x16x32_bf16 v[140:143], v[188:191], v[208:211], 0
  s_add_u32 m0, s81, 146944
  s_nop 0
  buffer_load_dwordx4 v28, s[76:79], s80 offen offset:512  lds
  s_waitcnt vmcnt(16)
  s_waitcnt lgkmcnt(0)
  s_barrier
  v_mfma_f32_16x16x32_bf16 v[64:67], v[192:195], v[160:163], v[64:67]
  ds_read_b128 v[144:147], v16 offset:32768
  s_add_u32 m0, s46, 98304
  v_mfma_f32_16x16x32_bf16 v[80:83], v[192:195], v[164:167], v[80:83]
  ds_read_b64_tr_b16 v[176:177], v18 offset:32768
  buffer_load_dwordx4 v8, s[8:11], s94 offen  lds
  v_mfma_f32_16x16x32_bf16 v[96:99], v[192:195], v[168:171], v[96:99]
  ds_read_b64_tr_b16 v[178:179], v18 offset:33792
  s_add_u32 m0, s46, 99328
  v_mfma_f32_16x16x32_bf16 v[112:115], v[192:195], v[172:175], v[112:115]
  ds_read_b128 v[148:151], v16 offset:34816
  buffer_load_dwordx4 v9, s[8:11], s94 offen  lds
  v_mfma_f32_16x16x32_bf16 v[128:131], v[192:195], v[208:211], v[128:131]
  ds_read_b64_tr_b16 v[180:181], v19 offset:32768
  s_add_u32 m0, s46, 100352
  v_mfma_f32_16x16x32_bf16 v[68:71], v[196:199], v[160:163], v[68:71]
  ds_read_b64_tr_b16 v[182:183], v19 offset:33792
  buffer_load_dwordx4 v10, s[8:11], s94 offen  lds
  v_mfma_f32_16x16x32_bf16 v[84:87], v[196:199], v[164:167], v[84:87]
  ds_read_b128 v[152:155], v16 offset:36864
  s_add_u32 m0, s46, 101376
  v_mfma_f32_16x16x32_bf16 v[100:103], v[196:199], v[168:171], v[100:103]
  ds_read_b64_tr_b16 v[184:185], v20 offset:32768
  buffer_load_dwordx4 v11, s[8:11], s94 offen  lds
  v_mfma_f32_16x16x32_bf16 v[116:119], v[196:199], v[172:175], v[116:119]
  ds_read_b64_tr_b16 v[186:187], v20 offset:33792
  s_add_u32 m0, s46, 114688
  v_mfma_f32_16x16x32_bf16 v[132:135], v[196:199], v[208:211], v[132:135]
  ds_read_b128 v[156:159], v16 offset:38912
  v_mfma_f32_16x16x32_bf16 v[72:75], v[200:203], v[160:163], v[72:75]
  ds_read_b64_tr_b16 v[188:189], v21 offset:32768
  buffer_load_dwordx4 v12, s[12:15], s95 offen  lds
  v_mfma_f32_16x16x32_bf16 v[88:91], v[200:203], v[164:167], v[88:91]
  ds_read_b64_tr_b16 v[190:191], v21 offset:33792
  s_add_u32 m0, s46, 115712
  v_mfma_f32_16x16x32_bf16 v[104:107], v[200:203], v[168:171], v[104:107]
  buffer_load_dwordx4 v13, s[12:15], s95 offen  lds
  v_mfma_f32_16x16x32_bf16 v[120:123], v[200:203], v[172:175], v[120:123]
  s_add_u32 m0, s46, 116736
  v_mfma_f32_16x16x32_bf16 v[136:139], v[200:203], v[208:211], v[136:139]
  buffer_load_dwordx4 v14, s[12:15], s95 offen  lds
  v_mfma_f32_16x16x32_bf16 v[76:79], v[204:207], v[160:163], v[76:79]
  s_add_u32 m0, s46, 117760
  v_mfma_f32_16x16x32_bf16 v[92:95], v[204:207], v[164:167], v[92:95]
  buffer_load_dwordx4 v15, s[12:15], s95 offen  lds
  v_mfma_f32_16x16x32_bf16 v[108:111], v[204:207], v[168:171], v[108:111]
  s_add_u32 s94, s94, 128
  s_add_u32 s95, s95, 245760
  v_mfma_f32_16x16x32_bf16 v[124:127], v[204:207], v[172:175], v[124:127]
  s_cmp_eq_u32 s94, s4
  s_cselect_b32 s94, s6, s94
  s_cselect_b32 s95, s7, s95
  v_mfma_f32_16x16x32_bf16 v[140:143], v[204:207], v[208:211], v[140:143]
  s_waitcnt lgkmcnt(0)
  v_mfma_f32_16x16x32_bf16 v[64:67], v[176:179], v[144:147], v[64:67]
  ds_read_b128 v[160:163], v17 offset:32768
  s_add_u32 m0, s46, 0
  v_mfma_f32_16x16x32_bf16 v[80:83], v[176:179], v[148:151], v[80:83]
  ds_read_b64_tr_b16 v[192:193], v18 offset:40960
  v_mfma_f32_16x16x32_bf16 v[96:99], v[176:179], v[152:155], v[96:99]
  ds_read_b64_tr_b16 v[194:195], v18 offset:41984
  buffer_load_dwordx4 v8, s[8:11], s94 offen  lds
  v_mfma_f32_16x16x32_bf16 v[112:115], v[176:179], v[156:159], v[112:115]
  ds_read_b128 v[164:167], v17 offset:34816
  v_mfma_f32_16x16x32_bf16 v[128:131], v[176:179], v[208:211], v[128:131]
  ds_read_b64_tr_b16 v[196:197], v19 offset:40960
  v_mfma_f32_16x16x32_bf16 v[68:71], v[180:183], v[144:147], v[68:71]
  ds_read_b64_tr_b16 v[198:199], v19 offset:41984
  s_add_u32 m0, s46, 1024
  v_mfma_f32_16x16x32_bf16 v[84:87], v[180:183], v[148:151], v[84:87]
  ds_read_b128 v[168:171], v17 offset:36864
  v_mfma_f32_16x16x32_bf16 v[100:103], v[180:183], v[152:155], v[100:103]
  ds_read_b64_tr_b16 v[200:201], v20 offset:40960
  buffer_load_dwordx4 v9, s[8:11], s94 offen  lds
  v_mfma_f32_16x16x32_bf16 v[116:119], v[180:183], v[156:159], v[116:119]
  ds_read_b64_tr_b16 v[202:203], v20 offset:41984
  v_mfma_f32_16x16x32_bf16 v[132:135], v[180:183], v[208:211], v[132:135]
  ds_read_b128 v[172:175], v17 offset:38912
  v_mfma_f32_16x16x32_bf16 v[72:75], v[184:187], v[144:147], v[72:75]
  ds_read_b64_tr_b16 v[204:205], v21 offset:40960
  s_add_u32 m0, s46, 2048
  v_mfma_f32_16x16x32_bf16 v[88:91], v[184:187], v[148:151], v[88:91]
  ds_read_b64_tr_b16 v[206:207], v21 offset:41984
  v_mfma_f32_16x16x32_bf16 v[104:107], v[184:187], v[152:155], v[104:107]
  buffer_load_dwordx4 v10, s[8:11], s94 offen  lds
  v_mfma_f32_16x16x32_bf16 v[120:123], v[184:187], v[156:159], v[120:123]
  v_mfma_f32_16x16x32_bf16 v[136:139], v[184:187], v[208:211], v[136:139]
  v_mfma_f32_16x16x32_bf16 v[76:79], v[188:191], v[144:147], v[76:79]
  s_add_u32 m0, s46, 3072
  v_mfma_f32_16x16x32_bf16 v[92:95], v[188:191], v[148:151], v[92:95]
  v_mfma_f32_16x16x32_bf16 v[108:111], v[188:191], v[152:155], v[108:111]
  buffer_load_dwordx4 v11, s[8:11], s94 offen  lds
  v_mfma_f32_16x16x32_bf16 v[124:127], v[188:191], v[156:159], v[124:127]
  v_mfma_f32_16x16x32_bf16 v[140:143], v[188:191], v[208:211], v[140:143]
  s_waitcnt vmcnt(17)
  s_waitcnt vmcnt(12)
  s_waitcnt lgkmcnt(0)
  s_barrier
  s_mov_b32 s60, 0x3f803f80
  v_mov_b32 v44, 0
  v_mov_b32 v45, 0
  v_dot2_f32_bf16 v44, v32, s60, v44
  v_dot2_f32_bf16 v45, v32, v32, v45
  v_dot2_f32_bf16 v44, v33, s60, v44
  v_dot2_f32_bf16 v45, v33, v33, v45
  v_dot2_f32_bf16 v44, v34, s60, v44
  v_dot2_f32_bf16 v45, v34, v34, v45
  v_dot2_f32_bf16 v44, v35, s60, v44
  v_dot2_f32_bf16 v45, v35, v35, v45
  v_dot2_f32_bf16 v44, v36, s60, v44
  v_dot2_f32_bf16 v45, v36, v36, v45
  v_dot2_f32_bf16 v44, v37, s60, v44
  v_dot2_f32_bf16 v45, v37, v37, v45
  v_dot2_f32_bf16 v44, v38, s60, v44
  v_dot2_f32_bf16 v45, v38, v38, v45
  v_dot2_f32_bf16 v44, v39, s60, v44
  v_dot2_f32_bf16 v45, v39, v39, v45
  v_dot2_f32_bf16 v44, v40, s60, v44
  v_dot2_f32_bf16 v45, v40, v40, v45
  v_dot2_f32_bf16 v44, v41, s60, v44
  v_dot2_f32_bf16 v45, v41, v41, v45
  v_dot2_f32_bf16 v44, v42, s60, v44
  v_dot2_f32_bf16 v45, v42, v42, v45
  v_dot2_f32_bf16 v44, v43, s60, v44
  v_dot2_f32_bf16 v45, v43, v43, v45
  s_nop 3
  v_add_f32_dpp v44, v44, v44 row_ror:8 row_mask:0xf bank_mask:0xf
  v_add_f32_dpp v45, v45, v45 row_ror:8 row_mask:0xf bank_mask:0xf
  s_nop 0
  v_add_f32_dpp v44, v44, v44 row_ror:4 row_mask:0xf bank_mask:0xf
  v_add_f32_dpp v45, v45, v45 row_ror:4 row_mask:0xf bank_mask:0xf
  s_nop 0
  v_add_f32_dpp v44, v44, v44 row_ror:2 row_mask:0xf bank_mask:0xf
  v_add_f32_dpp v45, v45, v45 row_ror:2 row_mask:0xf bank_mask:0xf
  s_nop 0
  v_add_f32_dpp v44, v44, v44 row_ror:1 row_mask:0xf bank_mask:0xf
  v_add_f32_dpp v45, v45, v45 row_ror:1 row_mask:0xf bank_mask:0xf
  v_mov_b32 v46, v44
  v_mov_b32 v47, v45
  s_nop 0
  v_permlane16_swap_b32 v44, v46
  v_permlane16_swap_b32 v45, v47
  v_add_f32 v44, v44, v46
  v_add_f32 v45, v45, v47
  v_mul_f32 v44, 0x3acccccd, v44
  v_mul_f32 v45, 0x3acccccd, v45
  v_fma_f32 v45, -v44, v44, v45
  v_max_f32 v45, 0, v45
  v_add_f32 v45, 0x3727c5ac, v45
  v_rsq_f32 v45, v45
  v_mov_b32 v46, s3
  v_mov_b32 v47, s3
  v_lshrrev_b32 v5, 5, v1
  v_lshlrev_b32 v5, 6, v5
  v_lshl_add_u32 v5, v2, 4, v5
  s_lshl_b32 s58, s50, 6
  s_add_u32 s58, s58, 21495808
  s_mov_b32 exec_lo, 15
  s_mov_b32 exec_hi, 15
  buffer_store_dwordx4 v[44:47], v5, s[40:43], s58 offen sc1
  s_mov_b64 exec, -1
  v_mfma_f32_16x16x32_bf16 v[64:67], v[192:195], v[160:163], v[64:67]
  ds_read_b128 v[144:147], v22 offset:0
  s_add_u32 m0, s46, 16384
  s_mul_i32 s58, s52, 5
  s_add_u32 s58, s58, 0
  s_lshr_b32 s59, s58, 2
  v_mfma_f32_16x16x32_bf16 v[80:83], v[192:195], v[164:167], v[80:83]
  ds_read_b64_tr_b16 v[176:177], v24 offset:0
  s_lshl_b32 s59, s59, 12
  s_and_b32 s58, s58, 3
  s_lshl_b32 s58, s58, 5
  s_add_u32 s58, s58, s59
  v_add_u32 v5, s58, v30
  v_mfma_f32_16x16x32_bf16 v[96:99], v[192:195], v[168:171], v[96:99]
  ds_read_b64_tr_b16 v[178:179], v24 offset:1024
  buffer_load_dwordx4 v12, s[12:15], s95 offen  lds
  ds_read_b64_tr_b16 v[44:45], v5 offset:0
  v_mfma_f32_16x16x32_bf16 v[112:115], v[192:195], v[172:175], v[112:115]
  ds_read_b128 v[148:151], v22 offset:2048
  ds_read_b64_tr_b16 v[46:47], v5 offset:2048
  v_mfma_f32_16x16x32_bf16 v[128:131], v[192:195], v[208:211], v[128:131]
  ds_read_b64_tr_b16 v[180:181], v25 offset:0
  s_add_u32 m0, s46, 17408
  s_mul_i32 s58, s52, 5
  s_add_u32 s58, s58, 1
  s_lshr_b32 s59, s58, 2
  v_mfma_f32_16x16x32_bf16 v[68:71], v[196:199], v[160:163], v[68:71]
  ds_read_b64_tr_b16 v[182:183], v25 offset:1024
  s_lshl_b32 s59, s59, 12
  s_and_b32 s58, s58, 3
  s_lshl_b32 s58, s58, 5
  s_add_u32 s58, s58, s59
  v_add_u32 v5, s58, v30
  v_mfma_f32_16x16x32_bf16 v[84:87], v[196:199], v[164:167], v[84:87]
  ds_read_b128 v[152:155], v22 offset:4096
  buffer_load_dwordx4 v13, s[12:15], s95 offen  lds
  ds_read_b64_tr_b16 v[48:49], v5 offset:0
  v_mfma_f32_16x16x32_bf16 v[100:103], v[196:199], v[168:171], v[100:103]
  ds_read_b64_tr_b16 v[184:185], v26 offset:0
  ds_read_b64_tr_b16 v[50:51], v5 offset:2048
  v_mfma_f32_16x16x32_bf16 v[116:119], v[196:199], v[172:175], v[116:119]
  ds_read_b64_tr_b16 v[186:187], v26 offset:1024
  s_add_u32 m0, s46, 18432
  s_mul_i32 s58, s52, 5
  s_add_u32 s58, s58, 2
  s_lshr_b32 s59, s58, 2
  v_mfma_f32_16x16x32_bf16 v[132:135], v[196:199], v[208:211], v[132:135]
  ds_read_b128 v[156:159], v22 offset:6144
  s_lshl_b32 s59, s59, 12
  s_and_b32 s58, s58, 3
  s_lshl_b32 s58, s58, 5
  s_add_u32 s58, s58, s59
  v_add_u32 v5, s58, v30
  v_mfma_f32_16x16x32_bf16 v[72:75], v[200:203], v[160:163], v[72:75]
  ds_read_b64_tr_b16 v[188:189], v27 offset:0
  buffer_load_dwordx4 v14, s[12:15], s95 offen  lds
  ds_read_b64_tr_b16 v[52:53], v5 offset:0
  v_mfma_f32_16x16x32_bf16 v[88:91], v[200:203], v[164:167], v[88:91]
  ds_read_b64_tr_b16 v[190:191], v27 offset:1024
  ds_read_b64_tr_b16 v[54:55], v5 offset:2048
  v_mfma_f32_16x16x32_bf16 v[104:107], v[200:203], v[168:171], v[104:107]
  s_add_u32 m0, s46, 19456
  s_mul_i32 s58, s52, 5
  s_add_u32 s58, s58, 3
  s_lshr_b32 s59, s58, 2
  v_mfma_f32_16x16x32_bf16 v[120:123], v[200:203], v[172:175], v[120:123]
  s_lshl_b32 s59, s59, 12
  s_and_b32 s58, s58, 3
  s_lshl_b32 s58, s58, 5
  s_add_u32 s58, s58, s59
  v_add_u32 v5, s58, v30
  v_mfma_f32_16x16x32_bf16 v[136:139], v[200:203], v[208:211], v[136:139]
  buffer_load_dwordx4 v15, s[12:15], s95 offen  lds
  ds_read_b64_tr_b16 v[56:57], v5 offset:0
  v_mfma_f32_16x16x32_bf16 v[76:79], v[204:207], v[160:163], v[76:79]
  ds_read_b64_tr_b16 v[58:59], v5 offset:2048
  v_mfma_f32_16x16x32_bf16 v[92:95], v[204:207], v[164:167], v[92:95]
  s_add_u32 s94, s94, 128
  s_add_u32 s95, s95, 245760
  s_mul_i32 s58, s52, 5
  s_add_u32 s58, s58, 4
  s_lshr_b32 s59, s58, 2
  v_mfma_f32_16x16x32_bf16 v[108:111], v[204:207], v[168:171], v[108:111]
  s_lshl_b32 s59, s59, 12
  s_and_b32 s58, s58, 3
  s_lshl_b32 s58, s58, 5
  s_add_u32 s58, s58, s59
  v_add_u32 v5, s58, v30
  v_mfma_f32_16x16x32_bf16 v[124:127], v[204:207], v[172:175], v[124:127]
  s_cmp_eq_u32 s94, s4
  s_cselect_b32 s94, s6, s94
  s_cselect_b32 s95, s7, s95
  ds_read_b64_tr_b16 v[60:61], v5 offset:0
  v_mfma_f32_16x16x32_bf16 v[140:143], v[204:207], v[208:211], v[140:143]
  ds_read_b64_tr_b16 v[62:63], v5 offset:2048
  s_waitcnt lgkmcnt(0)
  v_mfma_f32_16x16x32_bf16 v[64:67], v[176:179], v[144:147], v[64:67]
  ds_read_b128 v[160:163], v23 offset:0
  s_add_u32 m0, s46, 32768
  v_mfma_f32_16x16x32_bf16 v[80:83], v[176:179], v[148:151], v[80:83]
  ds_read_b64_tr_b16 v[192:193], v24 offset:8192
  v_mfma_f32_16x16x32_bf16 v[232:235], v[44:47], v[212:215], 0
  v_mfma_f32_16x16x32_bf16 v[96:99], v[176:179], v[152:155], v[96:99]
  ds_read_b64_tr_b16 v[194:195], v24 offset:9216
  v_mfma_f32_16x16x32_bf16 v[232:235], v[48:51], v[216:219], v[232:235]
  v_mfma_f32_16x16x32_bf16 v[112:115], v[176:179], v[156:159], v[112:115]
  ds_read_b128 v[164:167], v23 offset:2048
  buffer_load_dwordx4 v8, s[8:11], s94 offen  lds
  v_mfma_f32_16x16x32_bf16 v[128:131], v[176:179], v[208:211], v[128:131]
  ds_read_b64_tr_b16 v[196:197], v25 offset:8192
  v_mfma_f32_16x16x32_bf16 v[232:235], v[52:55], v[220:223], v[232:235]
  v_mfma_f32_16x16x32_bf16 v[68:71], v[180:183], v[144:147], v[68:71]
  ds_read_b64_tr_b16 v[198:199], v25 offset:9216
  s_add_u32 m0, s46, 33792
  v_mfma_f32_16x16x32_bf16 v[84:87], v[180:183], v[148:151], v[84:87]
  ds_read_b128 v[168:171], v23 offset:4096
  v_mfma_f32_16x16x32_bf16 v[232:235], v[56:59], v[224:227], v[232:235]
  v_mfma_f32_16x16x32_bf16 v[100:103], v[180:183], v[152:155], v[100:103]
  ds_read_b64_tr_b16 v[200:201], v26 offset:8192
  v_mfma_f32_16x16x32_bf16 v[232:235], v[60:63], v[228:231], v[232:235]
  v_mfma_f32_16x16x32_bf16 v[116:119], v[180:183], v[156:159], v[116:119]
  ds_read_b64_tr_b16 v[202:203], v26 offset:9216
  buffer_load_dwordx4 v9, s[8:11], s94 offen  lds
  v_mfma_f32_16x16x32_bf16 v[132:135], v[180:183], v[208:211], v[132:135]
  ds_read_b128 v[172:175], v23 offset:6144
  s_lshl_b32 s66, s64, 2
  s_add_u32 s66, s66, s52
  s_mul_i32 s67, s66, 5120
  v_mfma_f32_16x16x32_bf16 v[72:75], v[184:187], v[144:147], v[72:75]
  ds_read_b64_tr_b16 v[204:205], v27 offset:8192
  s_add_u32 m0, s46, 34816
  v_mfma_f32_16x16x32_bf16 v[88:91], v[184:187], v[148:151], v[88:91]
  ds_read_b64_tr_b16 v[206:207], v27 offset:9216
  s_add_u32 s67, s67, 13107200
  s_cmp_lt_u32 s64, 228
  s_cselect_b32 s67, s67, 0x40000000
  v_mfma_f32_16x16x32_bf16 v[104:107], v[184:187], v[152:155], v[104:107]
  buffer_load_dwordx4 v10, s[8:11], s94 offen  lds
  v_mfma_f32_16x16x32_bf16 v[120:123], v[184:187], v[156:159], v[120:123]
  s_add_u32 s73, s67, 4096
  v_mfma_f32_16x16x32_bf16 v[136:139], v[184:187], v[208:211], v[136:139]
  buffer_store_dwordx4 v[44:47], v4, s[40:43], s67 offen offset:0 sc1
  v_mfma_f32_16x16x32_bf16 v[76:79], v[188:191], v[144:147], v[76:79]
  s_add_u32 m0, s46, 35840
  v_mfma_f32_16x16x32_bf16 v[92:95], v[188:191], v[148:151], v[92:95]
  buffer_store_dwordx4 v[48:51], v4, s[40:43], s67 offen offset:1024 sc1
  v_mfma_f32_16x16x32_bf16 v[108:111], v[188:191], v[152:155], v[108:111]
  buffer_load_dwordx4 v11, s[8:11], s94 offen  lds
  v_mfma_f32_16x16x32_bf16 v[124:127], v[188:191], v[156:159], v[124:127]
  buffer_store_dwordx4 v[52:55], v4, s[40:43], s67 offen offset:2048 sc1
  v_mfma_f32_16x16x32_bf16 v[140:143], v[188:191], v[208:211], v[140:143]
  s_waitcnt vmcnt(16)
  s_waitcnt lgkmcnt(0)
  s_barrier
  v_mfma_f32_16x16x32_bf16 v[64:67], v[192:195], v[160:163], v[64:67]
  ds_read_b128 v[144:147], v22 offset:32768
  s_add_u32 m0, s46, 49152
  v_mfma_f32_16x16x32_bf16 v[80:83], v[192:195], v[164:167], v[80:83]
  ds_read_b64_tr_b16 v[176:177], v24 offset:32768
  buffer_store_dwordx4 v[56:59], v4, s[40:43], s67 offen offset:3072 sc1
  v_mfma_f32_16x16x32_bf16 v[96:99], v[192:195], v[168:171], v[96:99]
  ds_read_b64_tr_b16 v[178:179], v24 offset:33792
  buffer_load_dwordx4 v12, s[12:15], s95 offen  lds
  v_mfma_f32_16x16x32_bf16 v[112:115], v[192:195], v[172:175], v[112:115]
  ds_read_b128 v[148:151], v22 offset:34816
  v_mfma_f32_16x16x32_bf16 v[128:131], v[192:195], v[208:211], v[128:131]
  ds_read_b64_tr_b16 v[180:181], v25 offset:32768
  s_add_u32 m0, s46, 50176
  v_mfma_f32_16x16x32_bf16 v[68:71], v[196:199], v[160:163], v[68:71]
  ds_read_b64_tr_b16 v[182:183], v25 offset:33792
  buffer_store_dwordx4 v[60:63], v4, s[40:43], s73 offen offset:0 sc1
  v_mfma_f32_16x16x32_bf16 v[84:87], v[196:199], v[164:167], v[84:87]
  ds_read_b128 v[152:155], v22 offset:36864
  buffer_load_dwordx4 v13, s[12:15], s95 offen  lds
  v_mfma_f32_16x16x32_bf16 v[100:103], v[196:199], v[168:171], v[100:103]
  ds_read_b64_tr_b16 v[184:185], v26 offset:32768
  v_mfma_f32_16x16x32_bf16 v[116:119], v[196:199], v[172:175], v[116:119]
  ds_read_b64_tr_b16 v[186:187], v26 offset:33792
  s_add_u32 m0, s46, 51200
  v_mfma_f32_16x16x32_bf16 v[132:135], v[196:199], v[208:211], v[132:135]
  ds_read_b128 v[156:159], v22 offset:38912
  s_sub_u32 s59, s66, 160
  s_lshl_b32 s58, s59, 9
  s_add_u32 s58, s58, 20185088
  v_mfma_f32_16x16x32_bf16 v[72:75], v[200:203], v[160:163], v[72:75]
  ds_read_b64_tr_b16 v[188:189], v27 offset:32768
  buffer_load_dwordx4 v14, s[12:15], s95 offen  lds
  v_mfma_f32_16x16x32_bf16 v[88:91], v[200:203], v[164:167], v[88:91]
  ds_read_b64_tr_b16 v[190:191], v27 offset:33792
  v_mfma_f32_16x16x32_bf16 v[104:107], v[200:203], v[168:171], v[104:107]
  s_add_u32 m0, s46, 52224
  v_mfma_f32_16x16x32_bf16 v[120:123], v[200:203], v[172:175], v[120:123]
  s_cmp_lt_u32 s59, 160
  s_cselect_b32 s58, s58, 0x40000000
  v_mfma_f32_16x16x32_bf16 v[136:139], v[200:203], v[208:211], v[136:139]
  buffer_load_dwordx4 v15, s[12:15], s95 offen  lds
  v_mfma_f32_16x16x32_bf16 v[76:79], v[204:207], v[160:163], v[76:79]
  v_mfma_f32_16x16x32_bf16 v[92:95], v[204:207], v[164:167], v[92:95]
  s_add_u32 s94, s94, 128
  s_add_u32 s95, s95, 245760
  v_mfma_f32_16x16x32_bf16 v[108:111], v[204:207], v[168:171], v[108:111]
  buffer_store_dwordx4 v[232:235], v31, s[40:43], s58 offen sc1
  v_mfma_f32_16x16x32_bf16 v[124:127], v[204:207], v[172:175], v[124:127]
  s_cmp_eq_u32 s94, s4
  s_cselect_b32 s94, s6, s94
  s_cselect_b32 s95, s7, s95
  v_mfma_f32_16x16x32_bf16 v[140:143], v[204:207], v[208:211], v[140:143]
  s_waitcnt lgkmcnt(0)
  v_mfma_f32_16x16x32_bf16 v[64:67], v[176:179], v[144:147], v[64:67]
  ds_read_b128 v[160:163], v23 offset:32768
  s_add_u32 m0, s46, 65536
  v_mfma_f32_16x16x32_bf16 v[80:83], v[176:179], v[148:151], v[80:83]
  ds_read_b64_tr_b16 v[192:193], v24 offset:40960
  v_mfma_f32_16x16x32_bf16 v[96:99], v[176:179], v[152:155], v[96:99]
  ds_read_b64_tr_b16 v[194:195], v24 offset:41984
  buffer_load_dwordx4 v8, s[8:11], s94 offen  lds
  v_mfma_f32_16x16x32_bf16 v[112:115], v[176:179], v[156:159], v[112:115]
  ds_read_b128 v[164:167], v23 offset:34816
  v_mfma_f32_16x16x32_bf16 v[128:131], v[176:179], v[208:211], v[128:131]
  ds_read_b64_tr_b16 v[196:197], v25 offset:40960
  v_mfma_f32_16x16x32_bf16 v[68:71], v[180:183], v[144:147], v[68:71]
  ds_read_b64_tr_b16 v[198:199], v25 offset:41984
  s_add_u32 m0, s46, 66560
  v_mfma_f32_16x16x32_bf16 v[84:87], v[180:183], v[148:151], v[84:87]
  ds_read_b128 v[168:171], v23 offset:36864
  v_mfma_f32_16x16x32_bf16 v[100:103], v[180:183], v[152:155], v[100:103]
  ds_read_b64_tr_b16 v[200:201], v26 offset:40960
  buffer_load_dwordx4 v9, s[8:11], s94 offen  lds
  v_mfma_f32_16x16x32_bf16 v[116:119], v[180:183], v[156:159], v[116:119]
  ds_read_b64_tr_b16 v[202:203], v26 offset:41984
  v_mfma_f32_16x16x32_bf16 v[132:135], v[180:183], v[208:211], v[132:135]
  ds_read_b128 v[172:175], v23 offset:38912
  v_mfma_f32_16x16x32_bf16 v[72:75], v[184:187], v[144:147], v[72:75]
  ds_read_b64_tr_b16 v[204:205], v27 offset:40960
  s_add_u32 m0, s46, 67584
  v_mfma_f32_16x16x32_bf16 v[88:91], v[184:187], v[148:151], v[88:91]
  ds_read_b64_tr_b16 v[206:207], v27 offset:41984
  v_mfma_f32_16x16x32_bf16 v[104:107], v[184:187], v[152:155], v[104:107]
  buffer_load_dwordx4 v10, s[8:11], s94 offen  lds
  v_mfma_f32_16x16x32_bf16 v[120:123], v[184:187], v[156:159], v[120:123]
  v_mfma_f32_16x16x32_bf16 v[136:139], v[184:187], v[208:211], v[136:139]
  v_mfma_f32_16x16x32_bf16 v[76:79], v[188:191], v[144:147], v[76:79]
  s_add_u32 m0, s46, 68608
  v_mfma_f32_16x16x32_bf16 v[92:95], v[188:191], v[148:151], v[92:95]
  v_mfma_f32_16x16x32_bf16 v[108:111], v[188:191], v[152:155], v[108:111]
  buffer_load_dwordx4 v11, s[8:11], s94 offen  lds
  v_mfma_f32_16x16x32_bf16 v[124:127], v[188:191], v[156:159], v[124:127]
  v_mfma_f32_16x16x32_bf16 v[140:143], v[188:191], v[208:211], v[140:143]
  s_waitcnt vmcnt(18)
  s_waitcnt lgkmcnt(0)
  s_barrier
  v_mfma_f32_16x16x32_bf16 v[64:67], v[192:195], v[160:163], v[64:67]
  ds_read_b128 v[144:147], v16 offset:0
  s_add_u32 m0, s46, 81920
  v_mfma_f32_16x16x32_bf16 v[80:83], v[192:195], v[164:167], v[80:83]
  ds_read_b64_tr_b16 v[176:177], v18 offset:0
  v_mfma_f32_16x16x32_bf16 v[96:99], v[192:195], v[168:171], v[96:99]
  ds_read_b64_tr_b16 v[178:179], v18 offset:1024
  buffer_load_dwordx4 v12, s[12:15], s95 offen  lds
  v_mfma_f32_16x16x32_bf16 v[112:115], v[192:195], v[172:175], v[112:115]
  ds_read_b128 v[148:151], v16 offset:2048
  v_mfma_f32_16x16x32_bf16 v[128:131], v[192:195], v[208:211], v[128:131]
  ds_read_b64_tr_b16 v[180:181], v19 offset:0
  s_add_u32 m0, s46, 82944
  v_mfma_f32_16x16x32_bf16 v[68:71], v[196:199], v[160:163], v[68:71]
  ds_read_b64_tr_b16 v[182:183], v19 offset:1024
  v_mfma_f32_16x16x32_bf16 v[84:87], v[196:199], v[164:167], v[84:87]
  ds_read_b128 v[152:155], v16 offset:4096
  buffer_load_dwordx4 v13, s[12:15], s95 offen  lds
  v_mfma_f32_16x16x32_bf16 v[100:103], v[196:199], v[168:171], v[100:103]
  ds_read_b64_tr_b16 v[184:185], v20 offset:0
  v_mfma_f32_16x16x32_bf16 v[116:119], v[196:199], v[172:175], v[116:119]
  ds_read_b64_tr_b16 v[186:187], v20 offset:1024
  s_add_u32 m0, s46, 83968
  v_mfma_f32_16x16x32_bf16 v[132:135], v[196:199], v[208:211], v[132:135]
  ds_read_b128 v[156:159], v16 offset:6144
  v_mfma_f32_16x16x32_bf16 v[72:75], v[200:203], v[160:163], v[72:75]
  ds_read_b64_tr_b16 v[188:189], v21 offset:0
  buffer_load_dwordx4 v14, s[12:15], s95 offen  lds
  v_mfma_f32_16x16x32_bf16 v[88:91], v[200:203], v[164:167], v[88:91]
  ds_read_b64_tr_b16 v[190:191], v21 offset:1024
  v_mfma_f32_16x16x32_bf16 v[104:107], v[200:203], v[168:171], v[104:107]
  s_add_u32 m0, s46, 84992
  v_mfma_f32_16x16x32_bf16 v[120:123], v[200:203], v[172:175], v[120:123]
  v_mfma_f32_16x16x32_bf16 v[136:139], v[200:203], v[208:211], v[136:139]
  buffer_load_dwordx4 v15, s[12:15], s95 offen  lds
  v_mfma_f32_16x16x32_bf16 v[76:79], v[204:207], v[160:163], v[76:79]
  v_mfma_f32_16x16x32_bf16 v[92:95], v[204:207], v[164:167], v[92:95]
  s_add_u32 s94, s94, 128
  s_add_u32 s95, s95, 245760
  v_mfma_f32_16x16x32_bf16 v[108:111], v[204:207], v[168:171], v[108:111]
  v_mfma_f32_16x16x32_bf16 v[124:127], v[204:207], v[172:175], v[124:127]
  s_cmp_eq_u32 s94, s4
  s_cselect_b32 s94, s6, s94
  s_cselect_b32 s95, s7, s95
  v_mfma_f32_16x16x32_bf16 v[140:143], v[204:207], v[208:211], v[140:143]
  s_waitcnt lgkmcnt(0)
  v_mfma_f32_16x16x32_bf16 v[64:67], v[176:179], v[144:147], v[64:67]
  ds_read_b128 v[160:163], v17 offset:0
  s_add_u32 m0, s46, 98304
  v_mfma_f32_16x16x32_bf16 v[80:83], v[176:179], v[148:151], v[80:83]
  ds_read_b64_tr_b16 v[192:193], v18 offset:8192
  v_mfma_f32_16x16x32_bf16 v[96:99], v[176:179], v[152:155], v[96:99]
  ds_read_b64_tr_b16 v[194:195], v18 offset:9216
  buffer_load_dwordx4 v8, s[8:11], s94 offen  lds
  v_mfma_f32_16x16x32_bf16 v[112:115], v[176:179], v[156:159], v[112:115]
  ds_read_b128 v[164:167], v17 offset:2048
  v_mfma_f32_16x16x32_bf16 v[128:131], v[176:179], v[208:211], v[128:131]
  ds_read_b64_tr_b16 v[196:197], v19 offset:8192
  v_mfma_f32_16x16x32_bf16 v[68:71], v[180:183], v[144:147], v[68:71]
  ds_read_b64_tr_b16 v[198:199], v19 offset:9216
  s_add_u32 m0, s46, 99328
  v_mfma_f32_16x16x32_bf16 v[84:87], v[180:183], v[148:151], v[84:87]
  ds_read_b128 v[168:171], v17 offset:4096
  v_mfma_f32_16x16x32_bf16 v[100:103], v[180:183], v[152:155], v[100:103]
  ds_read_b64_tr_b16 v[200:201], v20 offset:8192
  buffer_load_dwordx4 v9, s[8:11], s94 offen  lds
  v_mfma_f32_16x16x32_bf16 v[116:119], v[180:183], v[156:159], v[116:119]
  ds_read_b64_tr_b16 v[202:203], v20 offset:9216
  v_mfma_f32_16x16x32_bf16 v[132:135], v[180:183], v[208:211], v[132:135]
  ds_read_b128 v[172:175], v17 offset:6144
  v_mfma_f32_16x16x32_bf16 v[72:75], v[184:187], v[144:147], v[72:75]
  ds_read_b64_tr_b16 v[204:205], v21 offset:8192
  s_add_u32 m0, s46, 100352
  v_mfma_f32_16x16x32_bf16 v[88:91], v[184:187], v[148:151], v[88:91]
  ds_read_b64_tr_b16 v[206:207], v21 offset:9216
  v_mfma_f32_16x16x32_bf16 v[104:107], v[184:187], v[152:155], v[104:107]
  buffer_load_dwordx4 v10, s[8:11], s94 offen  lds
  v_mfma_f32_16x16x32_bf16 v[120:123], v[184:187], v[156:159], v[120:123]
  v_mfma_f32_16x16x32_bf16 v[136:139], v[184:187], v[208:211], v[136:139]
  v_mfma_f32_16x16x32_bf16 v[76:79], v[188:191], v[144:147], v[76:79]
  s_add_u32 m0, s46, 101376
  v_mfma_f32_16x16x32_bf16 v[92:95], v[188:191], v[148:151], v[92:95]
  v_mfma_f32_16x16x32_bf16 v[108:111], v[188:191], v[152:155], v[108:111]
  buffer_load_dwordx4 v11, s[8:11], s94 offen  lds
  v_mfma_f32_16x16x32_bf16 v[124:127], v[188:191], v[156:159], v[124:127]
  v_mfma_f32_16x16x32_bf16 v[140:143], v[188:191], v[208:211], v[140:143]
  s_waitcnt vmcnt(13)
  s_waitcnt vmcnt(12)
  s_waitcnt lgkmcnt(0)
  s_barrier
  s_lshl_b32 s58, s64, 7
  s_add_u32 s58, s58, 21004288
  s_cmp_lg_u32 s52, 0
  s_cbranch_scc1 Lfr
  v_mov_b32 v240, s3
  v_mov_b32 v241, s51
  v_mov_b32 v242, s3
  v_mov_b32 v243, s51
  s_mov_b64 exec, 0xff
  buffer_store_dwordx4 v[240:243], v4, s[40:43], s58 offen sc1
  s_mov_b64 exec, -1
  s_nop 0
Lfr:
  v_mfma_f32_16x16x32_bf16 v[64:67], v[192:195], v[160:163], v[64:67]
  ds_read_b128 v[144:147], v16 offset:32768
  s_add_u32 m0, s46, 114688
  v_mfma_f32_16x16x32_bf16 v[80:83], v[192:195], v[164:167], v[80:83]
  ds_read_b64_tr_b16 v[176:177], v18 offset:32768
  v_mfma_f32_16x16x32_bf16 v[96:99], v[192:195], v[168:171], v[96:99]
  ds_read_b64_tr_b16 v[178:179], v18 offset:33792
  buffer_load_dwordx4 v12, s[12:15], s95 offen  lds
  v_mfma_f32_16x16x32_bf16 v[112:115], v[192:195], v[172:175], v[112:115]
  ds_read_b128 v[148:151], v16 offset:34816
  v_mfma_f32_16x16x32_bf16 v[128:131], v[192:195], v[208:211], v[128:131]
  ds_read_b64_tr_b16 v[180:181], v19 offset:32768
  s_add_u32 m0, s46, 115712
  v_mfma_f32_16x16x32_bf16 v[68:71], v[196:199], v[160:163], v[68:71]
  ds_read_b64_tr_b16 v[182:183], v19 offset:33792
  v_mfma_f32_16x16x32_bf16 v[84:87], v[196:199], v[164:167], v[84:87]
  ds_read_b128 v[152:155], v16 offset:36864
  buffer_load_dwordx4 v13, s[12:15], s95 offen  lds
  v_mfma_f32_16x16x32_bf16 v[100:103], v[196:199], v[168:171], v[100:103]
  ds_read_b64_tr_b16 v[184:185], v20 offset:32768
  v_mfma_f32_16x16x32_bf16 v[116:119], v[196:199], v[172:175], v[116:119]
  ds_read_b64_tr_b16 v[186:187], v20 offset:33792
  s_add_u32 m0, s46, 116736
  v_mfma_f32_16x16x32_bf16 v[132:135], v[196:199], v[208:211], v[132:135]
  ds_read_b128 v[156:159], v16 offset:38912
  v_mfma_f32_16x16x32_bf16 v[72:75], v[200:203], v[160:163], v[72:75]
  ds_read_b64_tr_b16 v[188:189], v21 offset:32768
  buffer_load_dwordx4 v14, s[12:15], s95 offen  lds
  v_mfma_f32_16x16x32_bf16 v[88:91], v[200:203], v[164:167], v[88:91]
  ds_read_b64_tr_b16 v[190:191], v21 offset:33792
  v_mfma_f32_16x16x32_bf16 v[104:107], v[200:203], v[168:171], v[104:107]
  s_add_u32 m0, s46, 117760
  v_mfma_f32_16x16x32_bf16 v[120:123], v[200:203], v[172:175], v[120:123]
  v_mfma_f32_16x16x32_bf16 v[136:139], v[200:203], v[208:211], v[136:139]
  buffer_load_dwordx4 v15, s[12:15], s95 offen  lds
  v_mfma_f32_16x16x32_bf16 v[76:79], v[204:207], v[160:163], v[76:79]
  v_mfma_f32_16x16x32_bf16 v[92:95], v[204:207], v[164:167], v[92:95]
  s_add_u32 s94, s94, 128
  s_add_u32 s95, s95, 245760
  v_mfma_f32_16x16x32_bf16 v[108:111], v[204:207], v[168:171], v[108:111]
  v_mfma_f32_16x16x32_bf16 v[124:127], v[204:207], v[172:175], v[124:127]
  s_cmp_eq_u32 s94, s4
  s_cselect_b32 s94, s6, s94
  s_cselect_b32 s95, s7, s95
  v_mfma_f32_16x16x32_bf16 v[140:143], v[204:207], v[208:211], v[140:143]
  s_waitcnt lgkmcnt(0)
  v_mfma_f32_16x16x32_bf16 v[64:67], v[176:179], v[144:147], v[64:67]
  ds_read_b128 v[160:163], v17 offset:32768
  s_add_u32 m0, s46, 0
  v_mfma_f32_16x16x32_bf16 v[80:83], v[176:179], v[148:151], v[80:83]
  ds_read_b64_tr_b16 v[192:193], v18 offset:40960
  v_mfma_f32_16x16x32_bf16 v[96:99], v[176:179], v[152:155], v[96:99]
  ds_read_b64_tr_b16 v[194:195], v18 offset:41984
  buffer_load_dwordx4 v8, s[8:11], s94 offen  lds
  v_mfma_f32_16x16x32_bf16 v[112:115], v[176:179], v[156:159], v[112:115]
  ds_read_b128 v[164:167], v17 offset:34816
  v_mfma_f32_16x16x32_bf16 v[128:131], v[176:179], v[208:211], v[128:131]
  ds_read_b64_tr_b16 v[196:197], v19 offset:40960
  v_mfma_f32_16x16x32_bf16 v[68:71], v[180:183], v[144:147], v[68:71]
  ds_read_b64_tr_b16 v[198:199], v19 offset:41984
  s_add_u32 m0, s46, 1024
  v_mfma_f32_16x16x32_bf16 v[84:87], v[180:183], v[148:151], v[84:87]
  ds_read_b128 v[168:171], v17 offset:36864
  v_mfma_f32_16x16x32_bf16 v[100:103], v[180:183], v[152:155], v[100:103]
  ds_read_b64_tr_b16 v[200:201], v20 offset:40960
  buffer_load_dwordx4 v9, s[8:11], s94 offen  lds
  v_mfma_f32_16x16x32_bf16 v[116:119], v[180:183], v[156:159], v[116:119]
  ds_read_b64_tr_b16 v[202:203], v20 offset:41984
  v_mfma_f32_16x16x32_bf16 v[132:135], v[180:183], v[208:211], v[132:135]
  ds_read_b128 v[172:175], v17 offset:38912
  v_mfma_f32_16x16x32_bf16 v[72:75], v[184:187], v[144:147], v[72:75]
  ds_read_b64_tr_b16 v[204:205], v21 offset:40960
  s_add_u32 m0, s46, 2048
  v_mfma_f32_16x16x32_bf16 v[88:91], v[184:187], v[148:151], v[88:91]
  ds_read_b64_tr_b16 v[206:207], v21 offset:41984
  v_mfma_f32_16x16x32_bf16 v[104:107], v[184:187], v[152:155], v[104:107]
  buffer_load_dwordx4 v10, s[8:11], s94 offen  lds
  v_mfma_f32_16x16x32_bf16 v[120:123], v[184:187], v[156:159], v[120:123]
  v_mfma_f32_16x16x32_bf16 v[136:139], v[184:187], v[208:211], v[136:139]
  v_mfma_f32_16x16x32_bf16 v[76:79], v[188:191], v[144:147], v[76:79]
  s_add_u32 m0, s46, 3072
  v_mfma_f32_16x16x32_bf16 v[92:95], v[188:191], v[148:151], v[92:95]
  v_mfma_f32_16x16x32_bf16 v[108:111], v[188:191], v[152:155], v[108:111]
  buffer_load_dwordx4 v11, s[8:11], s94 offen  lds
  v_mfma_f32_16x16x32_bf16 v[124:127], v[188:191], v[156:159], v[124:127]
  v_mfma_f32_16x16x32_bf16 v[140:143], v[188:191], v[208:211], v[140:143]
  s_waitcnt vmcnt(12)
  s_waitcnt lgkmcnt(0)
  s_barrier
  v_mfma_f32_16x16x32_bf16 v[64:67], v[192:195], v[160:163], v[64:67]
  ds_read_b128 v[144:147], v22 offset:0
  s_add_u32 m0, s46, 16384
  v_mfma_f32_16x16x32_bf16 v[80:83], v[192:195], v[164:167], v[80:83]
  ds_read_b64_tr_b16 v[176:177], v24 offset:0
  buffer_load_dwordx4 v12, s[12:15], s95 offen  lds
  v_mfma_f32_16x16x32_bf16 v[96:99], v[192:195], v[168:171], v[96:99]
  ds_read_b64_tr_b16 v[178:179], v24 offset:1024
  s_add_u32 m0, s46, 17408
  v_mfma_f32_16x16x32_bf16 v[112:115], v[192:195], v[172:175], v[112:115]
  ds_read_b128 v[148:151], v22 offset:2048
  buffer_load_dwordx4 v13, s[12:15], s95 offen  lds
  v_mfma_f32_16x16x32_bf16 v[128:131], v[192:195], v[208:211], v[128:131]
  ds_read_b64_tr_b16 v[180:181], v25 offset:0
  s_add_u32 m0, s46, 18432
  v_mfma_f32_16x16x32_bf16 v[68:71], v[196:199], v[160:163], v[68:71]
  ds_read_b64_tr_b16 v[182:183], v25 offset:1024
  buffer_load_dwordx4 v14, s[12:15], s95 offen  lds
  v_mfma_f32_16x16x32_bf16 v[84:87], v[196:199], v[164:167], v[84:87]
  ds_read_b128 v[152:155], v22 offset:4096
  s_add_u32 m0, s46, 19456
  v_mfma_f32_16x16x32_bf16 v[100:103], v[196:199], v[168:171], v[100:103]
  ds_read_b64_tr_b16 v[184:185], v26 offset:0
  buffer_load_dwordx4 v15, s[12:15], s95 offen  lds
  v_mfma_f32_16x16x32_bf16 v[116:119], v[196:199], v[172:175], v[116:119]
  ds_read_b64_tr_b16 v[186:187], v26 offset:1024
  s_add_u32 s94, s94, 128
  s_add_u32 s95, s95, 245760
  v_mfma_f32_16x16x32_bf16 v[132:135], v[196:199], v[208:211], v[132:135]
  ds_read_b128 v[156:159], v22 offset:6144
  s_cmp_eq_u32 s94, s4
  s_cselect_b32 s94, s6, s94
  s_cselect_b32 s95, s7, s95
  v_mfma_f32_16x16x32_bf16 v[72:75], v[200:203], v[160:163], v[72:75]
  ds_read_b64_tr_b16 v[188:189], v27 offset:0
  s_mul_i32 s68, s56, 20480
  s_mul_i32 s69, s57, 160
  v_mfma_f32_16x16x32_bf16 v[88:91], v[200:203], v[164:167], v[88:91]
  ds_read_b64_tr_b16 v[190:191], v27 offset:1024
  s_add_u32 s68, s68, s69
  s_mov_b32 s69, 6554
  v_mfma_f32_16x16x32_bf16 v[104:107], v[200:203], v[168:171], v[104:107]
  v_add_u32 v5, 0, v1
  v_mul_u32_u24 v6, s69, v5
  v_lshrrev_b32 v6, 16, v6
  v_lshlrev_b32 v5, 4, v5
  v_mfma_f32_16x16x32_bf16 v[120:123], v[200:203], v[172:175], v[120:123]
  v_min_u32 v6, 15, v6
  v_mul_u32_u24 v6, 1120, v6
  v_add_u32 v239, v5, v6
  s_add_u32 m0, s65, 0
  v_mfma_f32_16x16x32_bf16 v[136:139], v[200:203], v[208:211], v[136:139]
  buffer_load_dwordx4 v239, s[8:11], s68 offen lds
  v_add_u32 v5, 64, v1
  v_mul_u32_u24 v6, s69, v5
  v_mfma_f32_16x16x32_bf16 v[76:79], v[204:207], v[160:163], v[76:79]
  v_lshrrev_b32 v6, 16, v6
  v_lshlrev_b32 v5, 4, v5
  v_min_u32 v6, 15, v6
  v_mul_u32_u24 v6, 1120, v6
  v_mfma_f32_16x16x32_bf16 v[92:95], v[204:207], v[164:167], v[92:95]
  v_add_u32 v239, v5, v6
  s_add_u32 m0, s65, 1024
  s_nop 0
  buffer_load_dwordx4 v239, s[8:11], s68 offen lds
  v_mfma_f32_16x16x32_bf16 v[108:111], v[204:207], v[168:171], v[108:111]
  v_add_u32 v5, 128, v1
  v_mul_u32_u24 v6, s69, v5
  v_lshrrev_b32 v6, 16, v6
  v_lshlrev_b32 v5, 4, v5
  v_mfma_f32_16x16x32_bf16 v[124:127], v[204:207], v[172:175], v[124:127]
  v_min_u32 v6, 15, v6
  v_mul_u32_u24 v6, 1120, v6
  v_add_u32 v239, v5, v6
  s_add_u32 m0, s65, 2048
  v_mfma_f32_16x16x32_bf16 v[140:143], v[204:207], v[208:211], v[140:143]
  buffer_load_dwordx4 v239, s[8:11], s68 offen lds
  s_waitcnt lgkmcnt(0)
  v_mfma_f32_16x16x32_bf16 v[64:67], v[176:179], v[144:147], v[64:67]
  ds_read_b128 v[160:163], v23 offset:0
  s_add_u32 m0, s46, 32768
  v_mfma_f32_16x16x32_bf16 v[80:83], v[176:179], v[148:151], v[80:83]
  ds_read_b64_tr_b16 v[192:193], v24 offset:8192
  v_mfma_f32_16x16x32_bf16 v[96:99], v[176:179], v[152:155], v[96:99]
  ds_read_b64_tr_b16 v[194:195], v24 offset:9216
  buffer_load_dwordx4 v8, s[8:11], s94 offen  lds
  v_mfma_f32_16x16x32_bf16 v[112:115], v[176:179], v[156:159], v[112:115]
  ds_read_b128 v[164:167], v23 offset:2048
  v_mfma_f32_16x16x32_bf16 v[128:131], v[176:179], v[208:211], v[128:131]
  ds_read_b64_tr_b16 v[196:197], v25 offset:8192
  v_mfma_f32_16x16x32_bf16 v[68:71], v[180:183], v[144:147], v[68:71]
  ds_read_b64_tr_b16 v[198:199], v25 offset:9216
  s_add_u32 m0, s46, 33792
  v_mfma_f32_16x16x32_bf16 v[84:87], v[180:183], v[148:151], v[84:87]
  ds_read_b128 v[168:171], v23 offset:4096
  v_mfma_f32_16x16x32_bf16 v[100:103], v[180:183], v[152:155], v[100:103]
  ds_read_b64_tr_b16 v[200:201], v26 offset:8192
  buffer_load_dwordx4 v9, s[8:11], s94 offen  lds
  v_mfma_f32_16x16x32_bf16 v[116:119], v[180:183], v[156:159], v[116:119]
  ds_read_b64_tr_b16 v[202:203], v26 offset:9216
  v_mfma_f32_16x16x32_bf16 v[132:135], v[180:183], v[208:211], v[132:135]
  ds_read_b128 v[172:175], v23 offset:6144
  v_mfma_f32_16x16x32_bf16 v[72:75], v[184:187], v[144:147], v[72:75]
  ds_read_b64_tr_b16 v[204:205], v27 offset:8192
  s_add_u32 m0, s46, 34816
  v_mfma_f32_16x16x32_bf16 v[88:91], v[184:187], v[148:151], v[88:91]
  ds_read_b64_tr_b16 v[206:207], v27 offset:9216
  v_mfma_f32_16x16x32_bf16 v[104:107], v[184:187], v[152:155], v[104:107]
  buffer_load_dwordx4 v10, s[8:11], s94 offen  lds
  v_mfma_f32_16x16x32_bf16 v[120:123], v[184:187], v[156:159], v[120:123]
  v_mfma_f32_16x16x32_bf16 v[136:139], v[184:187], v[208:211], v[136:139]
  v_mfma_f32_16x16x32_bf16 v[76:79], v[188:191], v[144:147], v[76:79]
  s_add_u32 m0, s46, 35840
  v_mfma_f32_16x16x32_bf16 v[92:95], v[188:191], v[148:151], v[92:95]
  v_mfma_f32_16x16x32_bf16 v[108:111], v[188:191], v[152:155], v[108:111]
  buffer_load_dwordx4 v11, s[8:11], s94 offen  lds
  v_mfma_f32_16x16x32_bf16 v[124:127], v[188:191], v[156:159], v[124:127]
  v_mfma_f32_16x16x32_bf16 v[140:143], v[188:191], v[208:211], v[140:143]
  s_waitcnt vmcnt(15)
  s_waitcnt lgkmcnt(0)
  s_barrier
  v_mfma_f32_16x16x32_bf16 v[64:67], v[192:195], v[160:163], v[64:67]
  ds_read_b128 v[144:147], v22 offset:32768
  s_add_u32 m0, s46, 49152
  v_mfma_f32_16x16x32_bf16 v[80:83], v[192:195], v[164:167], v[80:83]
  ds_read_b64_tr_b16 v[176:177], v24 offset:32768
  v_min_u32 v237, 4, v1
  v_mfma_f32_16x16x32_bf16 v[96:99], v[192:195], v[168:171], v[96:99]
  ds_read_b64_tr_b16 v[178:179], v24 offset:33792
  v_lshlrev_b32 v237, 2, v237
  v_mfma_f32_16x16x32_bf16 v[112:115], v[192:195], v[172:175], v[112:115]
  ds_read_b128 v[148:151], v22 offset:34816
  buffer_load_dwordx4 v12, s[12:15], s95 offen  lds
  v_mfma_f32_16x16x32_bf16 v[128:131], v[192:195], v[208:211], v[128:131]
  ds_read_b64_tr_b16 v[180:181], v25 offset:32768
  v_add_u32 v237, s52, v237
  v_mfma_f32_16x16x32_bf16 v[68:71], v[196:199], v[160:163], v[68:71]
  ds_read_b64_tr_b16 v[182:183], v25 offset:33792
  s_add_u32 m0, s46, 50176
  v_mfma_f32_16x16x32_bf16 v[84:87], v[196:199], v[164:167], v[84:87]
  ds_read_b128 v[152:155], v22 offset:36864
  v_add_u32 v237, 0, v237
  v_mfma_f32_16x16x32_bf16 v[100:103], v[196:199], v[168:171], v[100:103]
  ds_read_b64_tr_b16 v[184:185], v26 offset:32768
  buffer_load_dwordx4 v13, s[12:15], s95 offen  lds
  v_mfma_f32_16x16x32_bf16 v[116:119], v[196:199], v[172:175], v[116:119]
  ds_read_b64_tr_b16 v[186:187], v26 offset:33792
  v_min_u32 v237, 113, v237
  v_mfma_f32_16x16x32_bf16 v[132:135], v[196:199], v[208:211], v[132:135]
  ds_read_b128 v[156:159], v22 offset:38912
  s_add_u32 m0, s46, 51200
  v_mfma_f32_16x16x32_bf16 v[72:75], v[200:203], v[160:163], v[72:75]
  ds_read_b64_tr_b16 v[188:189], v27 offset:32768
  v_lshlrev_b32 v237, 8, v237
  v_mfma_f32_16x16x32_bf16 v[88:91], v[200:203], v[164:167], v[88:91]
  ds_read_b64_tr_b16 v[190:191], v27 offset:33792
  buffer_load_dwordx4 v14, s[12:15], s95 offen  lds
  v_mfma_f32_16x16x32_bf16 v[104:107], v[200:203], v[168:171], v[104:107]
  s_lshr_b32 s61, s57, 2
  s_add_u32 m0, s46, 52224
  v_mfma_f32_16x16x32_bf16 v[120:123], v[200:203], v[172:175], v[120:123]
  s_lshl_b32 s61, s61, 7
  v_mfma_f32_16x16x32_bf16 v[136:139], v[200:203], v[208:211], v[136:139]
  buffer_load_dwordx4 v15, s[12:15], s95 offen  lds
  v_mfma_f32_16x16x32_bf16 v[76:79], v[204:207], v[160:163], v[76:79]
  s_add_u32 s61, s61, 21004288
  v_mfma_f32_16x16x32_bf16 v[92:95], v[204:207], v[164:167], v[92:95]
  s_add_u32 s94, s94, 128
  s_add_u32 s95, s95, 245760
  v_mfma_f32_16x16x32_bf16 v[108:111], v[204:207], v[168:171], v[108:111]
  v_add_u32 v237, s61, v237
  v_mfma_f32_16x16x32_bf16 v[124:127], v[204:207], v[172:175], v[124:127]
  s_cmp_eq_u32 s94, s4
  s_cselect_b32 s94, s6, s94
  s_cselect_b32 s95, s7, s95
  v_mfma_f32_16x16x32_bf16 v[140:143], v[204:207], v[208:211], v[140:143]
  buffer_load_dword v238, v237, s[40:43], 0 offen sc1
  s_waitcnt lgkmcnt(0)
  v_mfma_f32_16x16x32_bf16 v[64:67], v[176:179], v[144:147], v[64:67]
  ds_read_b128 v[160:163], v23 offset:32768
  v_mfma_f32_16x16x32_bf16 v[80:83], v[176:179], v[148:151], v[80:83]
  ds_read_b64_tr_b16 v[192:193], v24 offset:40960
  v_mfma_f32_16x16x32_bf16 v[96:99], v[176:179], v[152:155], v[96:99]
  ds_read_b64_tr_b16 v[194:195], v24 offset:41984
  v_mfma_f32_16x16x32_bf16 v[112:115], v[176:179], v[156:159], v[112:115]
  ds_read_b128 v[164:167], v23 offset:34816
  v_mfma_f32_16x16x32_bf16 v[128:131], v[176:179], v[208:211], v[128:131]
  ds_read_b64_tr_b16 v[196:197], v25 offset:40960
  v_mfma_f32_16x16x32_bf16 v[68:71], v[180:183], v[144:147], v[68:71]
  ds_read_b64_tr_b16 v[198:199], v25 offset:41984
  v_mfma_f32_16x16x32_bf16 v[84:87], v[180:183], v[148:151], v[84:87]
  ds_read_b128 v[168:171], v23 offset:36864
  v_mfma_f32_16x16x32_bf16 v[100:103], v[180:183], v[152:155], v[100:103]
  ds_read_b64_tr_b16 v[200:201], v26 offset:40960
  v_mfma_f32_16x16x32_bf16 v[116:119], v[180:183], v[156:159], v[116:119]
  ds_read_b64_tr_b16 v[202:203], v26 offset:41984
  v_mfma_f32_16x16x32_bf16 v[132:135], v[180:183], v[208:211], v[132:135]
  ds_read_b128 v[172:175], v23 offset:38912
  v_mfma_f32_16x16x32_bf16 v[72:75], v[184:187], v[144:147], v[72:75]
  ds_read_b64_tr_b16 v[204:205], v27 offset:40960
  v_mfma_f32_16x16x32_bf16 v[88:91], v[184:187], v[148:151], v[88:91]
  ds_read_b64_tr_b16 v[206:207], v27 offset:41984
  v_mfma_f32_16x16x32_bf16 v[104:107], v[184:187], v[152:155], v[104:107]
  v_mfma_f32_16x16x32_bf16 v[120:123], v[184:187], v[156:159], v[120:123]
  v_mfma_f32_16x16x32_bf16 v[136:139], v[184:187], v[208:211], v[136:139]
  v_mfma_f32_16x16x32_bf16 v[76:79], v[188:191], v[144:147], v[76:79]
  v_mfma_f32_16x16x32_bf16 v[92:95], v[188:191], v[148:151], v[92:95]
  v_mfma_f32_16x16x32_bf16 v[108:111], v[188:191], v[152:155], v[108:111]
  v_mfma_f32_16x16x32_bf16 v[124:127], v[188:191], v[156:159], v[124:127]
  v_mfma_f32_16x16x32_bf16 v[140:143], v[188:191], v[208:211], v[140:143]
  s_waitcnt vmcnt(12)
  s_waitcnt lgkmcnt(0)
  s_barrier
  s_waitcnt vmcnt(0)
  v_cmp_ne_u32 vcc, s3, v238
  s_nop 4
  s_cbranch_vccz Luok_2
  s_mov_b32 s48, 0
Lpoll_3:
  buffer_load_dword v240, v237, s[40:43], 0 offen sc1
  s_add_u32 s48, s48, 1
  s_cmp_gt_u32 s48, 0x40000
  s_cbranch_scc1 Lend
  s_waitcnt vmcnt(0)
  v_cmp_ne_u32 vcc, s3, v240
  s_nop 4
  s_cbranch_vccnz Lpoll_3
Luok_2:
  v_mfma_f32_16x16x32_bf16 v[64:67], v[192:195], v[160:163], v[64:67]
  ds_read_b128 v[144:147], v16 offset:0
  s_lshr_b32 s59, s52, 1
  s_lshl_b32 s59, s59, 6
  s_lshl_b32 s58, s92, 7
  v_mfma_f32_16x16x32_bf16 v[80:83], v[192:195], v[164:167], v[80:83]
  ds_read_b64_tr_b16 v[176:177], v18 offset:0
  s_add_u32 s74, s58, s59
  s_lshl_b32 s85, s74, 6
  v_mfma_f32_16x16x32_bf16 v[96:99], v[192:195], v[168:171], v[96:99]
  ds_read_b64_tr_b16 v[178:179], v18 offset:1024
  v_mfma_f32_16x16x32_bf16 v[112:115], v[192:195], v[172:175], v[112:115]
  ds_read_b128 v[148:151], v16 offset:2048
  s_add_u32 s85, s85, 21495808
  v_lshlrev_b32 v29, 6, v2
  v_mfma_f32_16x16x32_bf16 v[128:131], v[192:195], v[208:211], v[128:131]
  ds_read_b64_tr_b16 v[180:181], v19 offset:0
  v_mfma_f32_16x16x32_bf16 v[68:71], v[196:199], v[160:163], v[68:71]
  ds_read_b64_tr_b16 v[182:183], v19 offset:1024
  buffer_load_dwordx4 v[32:35], v29, s[40:43], s85 offen offset:0 sc1
  buffer_load_dwordx4 v[36:39], v29, s[40:43], s85 offen offset:1024 sc1
  buffer_load_dwordx4 v[40:43], v29, s[40:43], s85 offen offset:2048 sc1
  buffer_load_dwordx4 v[44:47], v29, s[40:43], s85 offen offset:3072 sc1
  v_mfma_f32_16x16x32_bf16 v[84:87], v[196:199], v[164:167], v[84:87]
  ds_read_b128 v[152:155], v16 offset:4096
  s_mul_i32 s63, s57, 5120
  v_mfma_f32_16x16x32_bf16 v[100:103], v[196:199], v[168:171], v[100:103]
  ds_read_b64_tr_b16 v[184:185], v20 offset:0
  v_mfma_f32_16x16x32_bf16 v[116:119], v[196:199], v[172:175], v[116:119]
  ds_read_b64_tr_b16 v[186:187], v20 offset:1024
  s_mul_i32 s46, s52, 40960
  s_add_u32 s46, s46, s63
  s_add_u32 s46, s46, 13107200
  v_mfma_f32_16x16x32_bf16 v[132:135], v[196:199], v[208:211], v[132:135]
  ds_read_b128 v[156:159], v16 offset:6144
  v_mfma_f32_16x16x32_bf16 v[72:75], v[200:203], v[160:163], v[72:75]
  ds_read_b64_tr_b16 v[188:189], v21 offset:0
  s_add_u32 s47, s46, 0
  v_mfma_f32_16x16x32_bf16 v[88:91], v[200:203], v[164:167], v[88:91]
  ds_read_b64_tr_b16 v[190:191], v21 offset:1024
  buffer_load_dwordx4 a[56:59], v4, s[40:43], s47 offen offset:0 sc1
  v_mfma_f32_16x16x32_bf16 v[104:107], v[200:203], v[168:171], v[104:107]
  v_mfma_f32_16x16x32_bf16 v[120:123], v[200:203], v[172:175], v[120:123]
  buffer_load_dwordx4 a[60:63], v4, s[40:43], s47 offen offset:1024 sc1
  v_mfma_f32_16x16x32_bf16 v[136:139], v[200:203], v[208:211], v[136:139]
  v_mfma_f32_16x16x32_bf16 v[76:79], v[204:207], v[160:163], v[76:79]
  buffer_load_dwordx4 a[64:67], v4, s[40:43], s47 offen offset:2048 sc1
  v_mfma_f32_16x16x32_bf16 v[92:95], v[204:207], v[164:167], v[92:95]
  buffer_load_dwordx4 a[68:71], v4, s[40:43], s47 offen offset:3072 sc1
  v_mfma_f32_16x16x32_bf16 v[108:111], v[204:207], v[168:171], v[108:111]
  v_mfma_f32_16x16x32_bf16 v[124:127], v[204:207], v[172:175], v[124:127]
  s_add_u32 s47, s46, 4096
  v_mfma_f32_16x16x32_bf16 v[140:143], v[204:207], v[208:211], v[140:143]
  s_waitcnt lgkmcnt(0)
  v_mfma_f32_16x16x32_bf16 v[64:67], v[176:179], v[144:147], v[64:67]
  ds_read_b128 v[160:163], v17 offset:0
  buffer_load_dwordx4 a[72:75], v4, s[40:43], s47 offen offset:0 sc1
  v_mfma_f32_16x16x32_bf16 v[80:83], v[176:179], v[148:151], v[80:83]
  ds_read_b64_tr_b16 v[192:193], v18 offset:8192
  v_mfma_f32_16x16x32_bf16 v[96:99], v[176:179], v[152:155], v[96:99]
  ds_read_b64_tr_b16 v[194:195], v18 offset:9216
  s_add_u32 s47, s46, 163840
  v_mfma_f32_16x16x32_bf16 v[112:115], v[176:179], v[156:159], v[112:115]
  ds_read_b128 v[164:167], v17 offset:2048
  v_mfma_f32_16x16x32_bf16 v[128:131], v[176:179], v[208:211], v[128:131]
  ds_read_b64_tr_b16 v[196:197], v19 offset:8192
  v_mfma_f32_16x16x32_bf16 v[68:71], v[180:183], v[144:147], v[68:71]
  ds_read_b64_tr_b16 v[198:199], v19 offset:9216
  buffer_load_dwordx4 a[76:79], v4, s[40:43], s47 offen offset:0 sc1
  v_mfma_f32_16x16x32_bf16 v[84:87], v[180:183], v[148:151], v[84:87]
  ds_read_b128 v[168:171], v17 offset:4096
  v_mfma_f32_16x16x32_bf16 v[100:103], v[180:183], v[152:155], v[100:103]
  ds_read_b64_tr_b16 v[200:201], v20 offset:8192
  buffer_load_dwordx4 a[80:83], v4, s[40:43], s47 offen offset:1024 sc1
  v_mfma_f32_16x16x32_bf16 v[116:119], v[180:183], v[156:159], v[116:119]
  ds_read_b64_tr_b16 v[202:203], v20 offset:9216
  v_mfma_f32_16x16x32_bf16 v[132:135], v[180:183], v[208:211], v[132:135]
  ds_read_b128 v[172:175], v17 offset:6144
  v_mfma_f32_16x16x32_bf16 v[72:75], v[184:187], v[144:147], v[72:75]
  ds_read_b64_tr_b16 v[204:205], v21 offset:8192
  buffer_load_dwordx4 a[84:87], v4, s[40:43], s47 offen offset:2048 sc1
  v_mfma_f32_16x16x32_bf16 v[88:91], v[184:187], v[148:151], v[88:91]
  ds_read_b64_tr_b16 v[206:207], v21 offset:9216
  v_mfma_f32_16x16x32_bf16 v[104:107], v[184:187], v[152:155], v[104:107]
  buffer_load_dwordx4 a[88:91], v4, s[40:43], s47 offen offset:3072 sc1
  v_mfma_f32_16x16x32_bf16 v[120:123], v[184:187], v[156:159], v[120:123]
  v_mfma_f32_16x16x32_bf16 v[136:139], v[184:187], v[208:211], v[136:139]
  v_mfma_f32_16x16x32_bf16 v[76:79], v[188:191], v[144:147], v[76:79]
  s_add_u32 s47, s46, 167936
  v_mfma_f32_16x16x32_bf16 v[92:95], v[188:191], v[148:151], v[92:95]
  v_mfma_f32_16x16x32_bf16 v[108:111], v[188:191], v[152:155], v[108:111]
  buffer_load_dwordx4 a[92:95], v4, s[40:43], s47 offen offset:0 sc1
  v_mfma_f32_16x16x32_bf16 v[124:127], v[188:191], v[156:159], v[124:127]
  v_mfma_f32_16x16x32_bf16 v[140:143], v[188:191], v[208:211], v[140:143]
  s_waitcnt lgkmcnt(0)
  s_barrier
  v_mfma_f32_16x16x32_bf16 v[64:67], v[192:195], v[160:163], v[64:67]
  ds_read_b128 v[144:147], v16 offset:32768
  s_add_u32 s47, s46, 327680
  v_mfma_f32_16x16x32_bf16 v[80:83], v[192:195], v[164:167], v[80:83]
  ds_read_b64_tr_b16 v[176:177], v18 offset:32768
  v_mfma_f32_16x16x32_bf16 v[96:99], v[192:195], v[168:171], v[96:99]
  ds_read_b64_tr_b16 v[178:179], v18 offset:33792
  buffer_load_dwordx4 a[96:99], v4, s[40:43], s47 offen offset:0 sc1
  v_mfma_f32_16x16x32_bf16 v[112:115], v[192:195], v[172:175], v[112:115]
  ds_read_b128 v[148:151], v16 offset:34816
  v_mfma_f32_16x16x32_bf16 v[128:131], v[192:195], v[208:211], v[128:131]
  ds_read_b64_tr_b16 v[180:181], v19 offset:32768
  v_mfma_f32_16x16x32_bf16 v[68:71], v[196:199], v[160:163], v[68:71]
  ds_read_b64_tr_b16 v[182:183], v19 offset:33792
  buffer_load_dwordx4 a[100:103], v4, s[40:43], s47 offen offset:1024 sc1
  v_mfma_f32_16x16x32_bf16 v[84:87], v[196:199], v[164:167], v[84:87]
  ds_read_b128 v[152:155], v16 offset:36864
  v_mfma_f32_16x16x32_bf16 v[100:103], v[196:199], v[168:171], v[100:103]
  ds_read_b64_tr_b16 v[184:185], v20 offset:32768
  buffer_load_dwordx4 a[104:107], v4, s[40:43], s47 offen offset:2048 sc1
  v_mfma_f32_16x16x32_bf16 v[116:119], v[196:199], v[172:175], v[116:119]
  ds_read_b64_tr_b16 v[186:187], v20 offset:33792
  v_mfma_f32_16x16x32_bf16 v[132:135], v[196:199], v[208:211], v[132:135]
  ds_read_b128 v[156:159], v16 offset:38912
  v_mfma_f32_16x16x32_bf16 v[72:75], v[200:203], v[160:163], v[72:75]
  ds_read_b64_tr_b16 v[188:189], v21 offset:32768
  buffer_load_dwordx4 a[108:111], v4, s[40:43], s47 offen offset:3072 sc1
  v_mfma_f32_16x16x32_bf16 v[88:91], v[200:203], v[164:167], v[88:91]
  ds_read_b64_tr_b16 v[190:191], v21 offset:33792
  v_mfma_f32_16x16x32_bf16 v[104:107], v[200:203], v[168:171], v[104:107]
  s_add_u32 s47, s46, 331776
  v_mfma_f32_16x16x32_bf16 v[120:123], v[200:203], v[172:175], v[120:123]
  v_mfma_f32_16x16x32_bf16 v[136:139], v[200:203], v[208:211], v[136:139]
  v_mfma_f32_16x16x32_bf16 v[76:79], v[204:207], v[160:163], v[76:79]
  buffer_load_dwordx4 a[112:115], v4, s[40:43], s47 offen offset:0 sc1
  v_mfma_f32_16x16x32_bf16 v[92:95], v[204:207], v[164:167], v[92:95]
  v_mfma_f32_16x16x32_bf16 v[108:111], v[204:207], v[168:171], v[108:111]
  s_add_u32 s47, s46, 491520
  v_mfma_f32_16x16x32_bf16 v[124:127], v[204:207], v[172:175], v[124:127]
  v_mfma_f32_16x16x32_bf16 v[140:143], v[204:207], v[208:211], v[140:143]
  s_waitcnt lgkmcnt(0)
  v_mfma_f32_16x16x32_bf16 v[64:67], v[176:179], v[144:147], v[64:67]
  ds_read_b128 v[160:163], v17 offset:32768
  v_mul_u32_u24 v5, 160, v2
  v_lshl_add_u32 v5, v3, 3, v5
  v_mfma_f32_16x16x32_bf16 v[80:83], v[176:179], v[148:151], v[80:83]
  ds_read_b64_tr_b16 v[192:193], v18 offset:40960
  v_add_u32 v239, s65, v5
  v_mfma_f32_16x16x32_bf16 v[96:99], v[176:179], v[152:155], v[96:99]
  ds_read_b64_tr_b16 v[194:195], v18 offset:41984
  v_mfma_f32_16x16x32_bf16 v[112:115], v[176:179], v[156:159], v[112:115]
  ds_read_b128 v[164:167], v17 offset:34816
  ds_read_b64 a[0:1], v239 offset:0
  v_mfma_f32_16x16x32_bf16 v[128:131], v[176:179], v[208:211], v[128:131]
  ds_read_b64_tr_b16 v[196:197], v19 offset:40960
  v_mfma_f32_16x16x32_bf16 v[68:71], v[180:183], v[144:147], v[68:71]
  ds_read_b64_tr_b16 v[198:199], v19 offset:41984
  ds_read_b64 a[2:3], v239 offset:32
  v_mfma_f32_16x16x32_bf16 v[84:87], v[180:183], v[148:151], v[84:87]
  ds_read_b128 v[168:171], v17 offset:36864
  ds_read_b64 a[4:5], v239 offset:64
  v_mfma_f32_16x16x32_bf16 v[100:103], v[180:183], v[152:155], v[100:103]
  ds_read_b64_tr_b16 v[200:201], v20 offset:40960
  ds_read_b64 a[6:7], v239 offset:96
  v_mfma_f32_16x16x32_bf16 v[116:119], v[180:183], v[156:159], v[116:119]
  ds_read_b64_tr_b16 v[202:203], v20 offset:41984
  ds_read_b64 a[8:9], v239 offset:128
  v_mfma_f32_16x16x32_bf16 v[132:135], v[180:183], v[208:211], v[132:135]
  ds_read_b128 v[172:175], v17 offset:38912
  v_mfma_f32_16x16x32_bf16 v[72:75], v[184:187], v[144:147], v[72:75]
  ds_read_b64_tr_b16 v[204:205], v21 offset:40960
  buffer_load_dwordx4 a[116:119], v4, s[40:43], s47 offen offset:0 sc1
  v_mfma_f32_16x16x32_bf16 v[88:91], v[184:187], v[148:151], v[88:91]
  ds_read_b64_tr_b16 v[206:207], v21 offset:41984
  buffer_load_dwordx4 a[120:123], v4, s[40:43], s47 offen offset:1024 sc1
  v_mfma_f32_16x16x32_bf16 v[104:107], v[184:187], v[152:155], v[104:107]
  buffer_load_dwordx4 a[124:127], v4, s[40:43], s47 offen offset:2048 sc1
  v_mfma_f32_16x16x32_bf16 v[120:123], v[184:187], v[156:159], v[120:123]
  buffer_load_dwordx4 a[128:131], v4, s[40:43], s47 offen offset:3072 sc1
  v_mfma_f32_16x16x32_bf16 v[136:139], v[184:187], v[208:211], v[136:139]
  v_mfma_f32_16x16x32_bf16 v[76:79], v[188:191], v[144:147], v[76:79]
  s_add_u32 s47, s46, 495616
  v_mfma_f32_16x16x32_bf16 v[92:95], v[188:191], v[148:151], v[92:95]
  buffer_load_dwordx4 a[132:135], v4, s[40:43], s47 offen offset:0 sc1
  v_mfma_f32_16x16x32_bf16 v[108:111], v[188:191], v[152:155], v[108:111]
  s_add_u32 s47, s46, 655360
  v_mfma_f32_16x16x32_bf16 v[124:127], v[188:191], v[156:159], v[124:127]
  buffer_load_dwordx4 a[136:139], v4, s[40:43], s47 offen offset:0 sc1
  v_mfma_f32_16x16x32_bf16 v[140:143], v[188:191], v[208:211], v[140:143]
  s_waitcnt lgkmcnt(0)
  v_mfma_f32_16x16x32_bf16 v[64:67], v[192:195], v[160:163], v[64:67]
  v_min_u32 v237, 4, v1
  v_mfma_f32_16x16x32_bf16 v[80:83], v[192:195], v[164:167], v[80:83]
  v_lshlrev_b32 v237, 2, v237
  v_mfma_f32_16x16x32_bf16 v[96:99], v[192:195], v[168:171], v[96:99]
  v_add_u32 v237, s52, v237
  v_mfma_f32_16x16x32_bf16 v[112:115], v[192:195], v[172:175], v[112:115]
  v_add_u32 v237, 20, v237
  v_mfma_f32_16x16x32_bf16 v[128:131], v[192:195], v[208:211], v[128:131]
  v_mfma_f32_16x16x32_bf16 v[68:71], v[196:199], v[160:163], v[68:71]
  v_min_u32 v237, 113, v237
  v_mfma_f32_16x16x32_bf16 v[84:87], v[196:199], v[164:167], v[84:87]
  v_lshlrev_b32 v237, 8, v237
  v_mfma_f32_16x16x32_bf16 v[100:103], v[196:199], v[168:171], v[100:103]
  s_lshr_b32 s61, s57, 2
  v_mfma_f32_16x16x32_bf16 v[116:119], v[196:199], v[172:175], v[116:119]
  s_lshl_b32 s61, s61, 7
  v_mfma_f32_16x16x32_bf16 v[132:135], v[196:199], v[208:211], v[132:135]
  v_mfma_f32_16x16x32_bf16 v[72:75], v[200:203], v[160:163], v[72:75]
  s_add_u32 s61, s61, 21004288
  v_mfma_f32_16x16x32_bf16 v[88:91], v[200:203], v[164:167], v[88:91]
  v_add_u32 v237, s61, v237
  v_mfma_f32_16x16x32_bf16 v[104:107], v[200:203], v[168:171], v[104:107]
  buffer_load_dword v238, v237, s[40:43], 0 offen sc1
  v_mfma_f32_16x16x32_bf16 v[120:123], v[200:203], v[172:175], v[120:123]
  buffer_load_dwordx4 a[140:143], v4, s[40:43], s47 offen offset:1024 sc1
  v_mfma_f32_16x16x32_bf16 v[136:139], v[200:203], v[208:211], v[136:139]
  v_mfma_f32_16x16x32_bf16 v[76:79], v[204:207], v[160:163], v[76:79]
  buffer_load_dwordx4 a[144:147], v4, s[40:43], s47 offen offset:2048 sc1
  v_mfma_f32_16x16x32_bf16 v[92:95], v[204:207], v[164:167], v[92:95]
  buffer_load_dwordx4 a[148:151], v4, s[40:43], s47 offen offset:3072 sc1
  v_mfma_f32_16x16x32_bf16 v[108:111], v[204:207], v[168:171], v[108:111]
  s_add_u32 s47, s46, 659456
  v_mfma_f32_16x16x32_bf16 v[124:127], v[204:207], v[172:175], v[124:127]
  buffer_load_dwordx4 a[152:155], v4, s[40:43], s47 offen offset:0 sc1
  v_mfma_f32_16x16x32_bf16 v[140:143], v[204:207], v[208:211], v[140:143]
  s_waitcnt vmcnt(26)
  s_mov_b32 s48, 0
  s_nop 5
Lst_chk:
  v_xor_b32 v240, s3, v34
  v_xor_b32 v241, s3, v38
  v_xor_b32 v242, s3, v42
  v_xor_b32 v243, s3, v46
  v_or3_b32 v240, v240, v241, v242
  v_or_b32 v240, v240, v243
  v_cmp_ne_u32 vcc, 0, v240
  s_nop 4
  s_cbranch_vccz Lst_ok
  buffer_load_dwordx4 v[32:35], v29, s[40:43], s85 offen offset:0 sc1
  buffer_load_dwordx4 v[36:39], v29, s[40:43], s85 offen offset:1024 sc1
  buffer_load_dwordx4 v[40:43], v29, s[40:43], s85 offen offset:2048 sc1
  buffer_load_dwordx4 v[44:47], v29, s[40:43], s85 offen offset:3072 sc1
  s_add_u32 s48, s48, 1
  s_cmp_gt_u32 s48, 0x40000
  s_cbranch_scc1 Lend
  s_waitcnt vmcnt(0)
  s_branch Lst_chk
Lst_ok:
  v_and_b32 v5, 1, v3
  v_lshrrev_b32 v6, 1, v3
  v_lshl_or_b32 v5, v5, 1, v6
  v_lshlrev_b32 v5, 12, v5
  v_lshl_add_u32 v24, v2, 4, v5
  s_and_b32 s59, s52, 1
  s_lshl_b32 s59, s59, 3
  s_lshl_b32 s58, s93, 4
  s_add_u32 s58, s58, s59
  s_lshl_b32 s58, s58, 12
  s_and_b32 s59, s74, 255
  s_lshl_b32 s59, s59, 4
  s_add_u32 s75, s58, s59
  s_lshr_b32 s58, s92, 1
  s_mul_i32 s58, s58, 1310720
  s_add_u32 s75, s75, s58
  s_add_u32 s76, s75, 16384
  s_cmp_lt_u32 s93, 5
  s_cselect_b32 s60, 0x3ea52b5c, 1.0
  v_mul_f32 v10, s60, v33
  v_sub_f32 v8, 0, v32
  v_mul_f32 v11, s60, v33
  v_sub_f32 v9, 0, v32
  v_mul_f32 v14, s60, v37
  v_sub_f32 v12, 0, v36
  v_mul_f32 v15, s60, v37
  v_sub_f32 v13, 0, v36
  v_mul_f32 v18, s60, v41
  v_sub_f32 v16, 0, v40
  v_mul_f32 v19, s60, v41
  v_sub_f32 v17, 0, v40
  v_mul_f32 v22, s60, v45
  v_sub_f32 v20, 0, v44
  v_mul_f32 v23, s60, v45
  v_sub_f32 v21, 0, v44
  v_pk_fma_f32 v[64:65], v[8:9], v[128:129], v[64:65]
  v_pk_fma_f32 v[66:67], v[8:9], v[130:131], v[66:67]
  v_pk_fma_f32 v[68:69], v[8:9], v[132:133], v[68:69]
  v_pk_fma_f32 v[70:71], v[8:9], v[134:135], v[70:71]
  v_pk_mul_f32 v[64:65], v[10:11], v[64:65]
  v_pk_mul_f32 v[66:67], v[10:11], v[66:67]
  v_pk_mul_f32 v[68:69], v[10:11], v[68:69]
  v_pk_mul_f32 v[70:71], v[10:11], v[70:71]
  v_cvt_pk_bf16_f32 v144, v64, v65
  v_cvt_pk_bf16_f32 v145, v66, v67
  v_cvt_pk_bf16_f32 v146, v68, v69
  v_cvt_pk_bf16_f32 v147, v70, v71
  s_nop 0
  v_permlane16_swap_b32 v144, v146
  v_permlane16_swap_b32 v145, v147
  buffer_store_dwordx4 v[144:147], v24, s[40:43], s75 offen offset:0 sc1
  v_pk_fma_f32 v[72:73], v[8:9], v[136:137], v[72:73]
  v_pk_fma_f32 v[74:75], v[8:9], v[138:139], v[74:75]
  v_pk_fma_f32 v[76:77], v[8:9], v[140:141], v[76:77]
  v_pk_fma_f32 v[78:79], v[8:9], v[142:143], v[78:79]
  v_pk_mul_f32 v[72:73], v[10:11], v[72:73]
  v_pk_mul_f32 v[74:75], v[10:11], v[74:75]
  v_pk_mul_f32 v[76:77], v[10:11], v[76:77]
  v_pk_mul_f32 v[78:79], v[10:11], v[78:79]
  v_cvt_pk_bf16_f32 v148, v72, v73
  v_cvt_pk_bf16_f32 v149, v74, v75
  v_cvt_pk_bf16_f32 v150, v76, v77
  v_cvt_pk_bf16_f32 v151, v78, v79
  s_nop 0
  v_permlane16_swap_b32 v148, v150
  v_permlane16_swap_b32 v149, v151
  buffer_store_dwordx4 v[148:151], v24, s[40:43], s76 offen offset:0 sc1
  v_pk_fma_f32 v[80:81], v[12:13], v[128:129], v[80:81]
  v_pk_fma_f32 v[82:83], v[12:13], v[130:131], v[82:83]
  v_pk_fma_f32 v[84:85], v[12:13], v[132:133], v[84:85]
  v_pk_fma_f32 v[86:87], v[12:13], v[134:135], v[86:87]
  v_pk_mul_f32 v[80:81], v[14:15], v[80:81]
  v_pk_mul_f32 v[82:83], v[14:15], v[82:83]
  v_pk_mul_f32 v[84:85], v[14:15], v[84:85]
  v_pk_mul_f32 v[86:87], v[14:15], v[86:87]
  v_cvt_pk_bf16_f32 v152, v80, v81
  v_cvt_pk_bf16_f32 v153, v82, v83
  v_cvt_pk_bf16_f32 v154, v84, v85
  v_cvt_pk_bf16_f32 v155, v86, v87
  s_nop 0
  v_permlane16_swap_b32 v152, v154
  v_permlane16_swap_b32 v153, v155
  buffer_store_dwordx4 v[152:155], v24, s[40:43], s75 offen offset:256 sc1
  v_pk_fma_f32 v[88:89], v[12:13], v[136:137], v[88:89]
  v_pk_fma_f32 v[90:91], v[12:13], v[138:139], v[90:91]
  v_pk_fma_f32 v[92:93], v[12:13], v[140:141], v[92:93]
  v_pk_fma_f32 v[94:95], v[12:13], v[142:143], v[94:95]
  v_pk_mul_f32 v[88:89], v[14:15], v[88:89]
  v_pk_mul_f32 v[90:91], v[14:15], v[90:91]
  v_pk_mul_f32 v[92:93], v[14:15], v[92:93]
  v_pk_mul_f32 v[94:95], v[14:15], v[94:95]
  v_cvt_pk_bf16_f32 v156, v88, v89
  v_cvt_pk_bf16_f32 v157, v90, v91
  v_cvt_pk_bf16_f32 v158, v92, v93
  v_cvt_pk_bf16_f32 v159, v94, v95
  s_nop 0
  v_permlane16_swap_b32 v156, v158
  v_permlane16_swap_b32 v157, v159
  buffer_store_dwordx4 v[156:159], v24, s[40:43], s76 offen offset:256 sc1
  v_pk_fma_f32 v[96:97], v[16:17], v[128:129], v[96:97]
  v_pk_fma_f32 v[98:99], v[16:17], v[130:131], v[98:99]
  v_pk_fma_f32 v[100:101], v[16:17], v[132:133], v[100:101]
  v_pk_fma_f32 v[102:103], v[16:17], v[134:135], v[102:103]
  v_pk_mul_f32 v[96:97], v[18:19], v[96:97]
  v_pk_mul_f32 v[98:99], v[18:19], v[98:99]
  v_pk_mul_f32 v[100:101], v[18:19], v[100:101]
  v_pk_mul_f32 v[102:103], v[18:19], v[102:103]
  v_cvt_pk_bf16_f32 v160, v96, v97
  v_cvt_pk_bf16_f32 v161, v98, v99
  v_cvt_pk_bf16_f32 v162, v100, v101
  v_cvt_pk_bf16_f32 v163, v102, v103
  s_nop 0
  v_permlane16_swap_b32 v160, v162
  v_permlane16_swap_b32 v161, v163
  buffer_store_dwordx4 v[160:163], v24, s[40:43], s75 offen offset:512 sc1
  v_pk_fma_f32 v[104:105], v[16:17], v[136:137], v[104:105]
  v_pk_fma_f32 v[106:107], v[16:17], v[138:139], v[106:107]
  v_pk_fma_f32 v[108:109], v[16:17], v[140:141], v[108:109]
  v_pk_fma_f32 v[110:111], v[16:17], v[142:143], v[110:111]
  v_pk_mul_f32 v[104:105], v[18:19], v[104:105]
  v_pk_mul_f32 v[106:107], v[18:19], v[106:107]
  v_pk_mul_f32 v[108:109], v[18:19], v[108:109]
  v_pk_mul_f32 v[110:111], v[18:19], v[110:111]
  v_cvt_pk_bf16_f32 v164, v104, v105
  v_cvt_pk_bf16_f32 v165, v106, v107
  v_cvt_pk_bf16_f32 v166, v108, v109
  v_cvt_pk_bf16_f32 v167, v110, v111
  s_nop 0
  v_permlane16_swap_b32 v164, v166
  v_permlane16_swap_b32 v165, v167
  buffer_store_dwordx4 v[164:167], v24, s[40:43], s76 offen offset:512 sc1
  v_pk_fma_f32 v[112:113], v[20:21], v[128:129], v[112:113]
  v_pk_fma_f32 v[114:115], v[20:21], v[130:131], v[114:115]
  v_pk_fma_f32 v[116:117], v[20:21], v[132:133], v[116:117]
  v_pk_fma_f32 v[118:119], v[20:21], v[134:135], v[118:119]
  v_pk_mul_f32 v[112:113], v[22:23], v[112:113]
  v_pk_mul_f32 v[114:115], v[22:23], v[114:115]
  v_pk_mul_f32 v[116:117], v[22:23], v[116:117]
  v_pk_mul_f32 v[118:119], v[22:23], v[118:119]
  v_cvt_pk_bf16_f32 v168, v112, v113
  v_cvt_pk_bf16_f32 v169, v114, v115
  v_cvt_pk_bf16_f32 v170, v116, v117
  v_cvt_pk_bf16_f32 v171, v118, v119
  s_nop 0
  v_permlane16_swap_b32 v168, v170
  v_permlane16_swap_b32 v169, v171
  buffer_store_dwordx4 v[168:171], v24, s[40:43], s75 offen offset:768 sc1
  v_pk_fma_f32 v[120:121], v[20:21], v[136:137], v[120:121]
  v_pk_fma_f32 v[122:123], v[20:21], v[138:139], v[122:123]
  v_pk_fma_f32 v[124:125], v[20:21], v[140:141], v[124:125]
  v_pk_fma_f32 v[126:127], v[20:21], v[142:143], v[126:127]
  v_pk_mul_f32 v[120:121], v[22:23], v[120:121]
  v_pk_mul_f32 v[122:123], v[22:23], v[122:123]
  v_pk_mul_f32 v[124:125], v[22:23], v[124:125]
  v_pk_mul_f32 v[126:127], v[22:23], v[126:127]
  v_cvt_pk_bf16_f32 v172, v120, v121
  v_cvt_pk_bf16_f32 v173, v122, v123
  v_cvt_pk_bf16_f32 v174, v124, v125
  v_cvt_pk_bf16_f32 v175, v126, v127
  s_nop 0
  v_permlane16_swap_b32 v172, v174
  v_permlane16_swap_b32 v173, v175
  buffer_store_dwordx4 v[172:175], v24, s[40:43], s76 offen offset:768 sc1
  s_waitcnt vmcnt(12)
  v_cmp_ne_u32 vcc, s3, v238
  s_nop 4
  s_cbranch_vccz Luok_4
  s_mov_b32 s48, 0
Lpoll_5:
  buffer_load_dword v240, v237, s[40:43], 0 offen sc1
  s_add_u32 s48, s48, 1
  s_cmp_gt_u32 s48, 0x40000
  s_cbranch_scc1 Lend
  s_waitcnt vmcnt(0)
  v_cmp_ne_u32 vcc, s3, v240
  s_nop 4
  s_cbranch_vccnz Lpoll_5
Luok_4:
  s_mul_i32 s46, s52, 40960
  s_add_u32 s46, s46, s63
  s_add_u32 s46, s46, 13926400
  s_add_u32 s47, s46, 0
  buffer_load_dwordx4 a[156:159], v4, s[40:43], s47 offen offset:0 sc1
  buffer_load_dwordx4 a[160:163], v4, s[40:43], s47 offen offset:1024 sc1
  buffer_load_dwordx4 a[164:167], v4, s[40:43], s47 offen offset:2048 sc1
  buffer_load_dwordx4 a[168:171], v4, s[40:43], s47 offen offset:3072 sc1
  s_add_u32 s47, s46, 4096
  buffer_load_dwordx4 a[172:175], v4, s[40:43], s47 offen offset:0 sc1
  s_mov_b32 s6, s64
  s_mov_b32 s7, s66
  s_lshr_b32 s58, s54, 1
  s_mul_i32 s4, s58, 5
  s_and_b32 s59, s54, 1
  s_lshl_b32 s59, s59, 1
  s_add_u32 s4, s4, s59
  v_and_b32 v5, 31, v1
  v_lshlrev_b32 v5, 4, v5
  v_lshrrev_b32 v6, 5, v1
  v_lshl_add_u32 v6, v6, 12, v5
  s_mul_i32 s60, s53, 1310720
  s_lshl_b32 s61, s52, 10
  s_add_u32 s60, s60, s61
  s_mul_i32 s58, s58, 20480
  s_add_u32 s60, s60, s58
  s_mul_i32 s58, s59, 6144
  s_add_u32 s58, s58, s60
  v_add_u32 v254, s58, v6
  s_lshl_b32 s58, s59, 2
  s_add_u32 s58, s58, s60
  s_add_u32 s58, s58, 8192
  v_add_u32 v255, s58, v5
  v_and_b32 v5, 31, v1
  v_lshrrev_b32 v6, 5, v1
  v_lshlrev_b32 v6, 2, v6
  v_sub_u32 v5, v5, v6
  v_cmp_le_i32 s[64:65], 0, v5
  v_cmp_le_i32 s[66:67], 1, v5
  v_cmp_le_i32 s[68:69], 2, v5
  v_cmp_le_i32 s[70:71], 3, v5
  v_cmp_le_i32 s[72:73], 8, v5
  v_cmp_le_i32 s[74:75], 9, v5
  v_cmp_le_i32 s[76:77], 10, v5
  v_cmp_le_i32 s[78:79], 11, v5
  v_cmp_le_i32 s[80:81], 16, v5
  v_cmp_le_i32 s[82:83], 17, v5
  v_cmp_le_i32 s[84:85], 18, v5
  v_cmp_le_i32 s[86:87], 19, v5
  v_cmp_le_i32 s[88:89], 24, v5
  v_cmp_le_i32 s[90:91], 25, v5
  v_cmp_le_i32 s[98:99], 26, v5
  v_cmp_le_i32 s[100:101], 27, v5
  v_mov_b32 v6, 0xffff
  v_mov_b32 v7, 0xffff0000
  v_cndmask_b32 v24, 0, v6, s[64:65]
  v_cndmask_b32 v8, 0, v7, s[66:67]
  v_or_b32 v24, v24, v8
  v_cndmask_b32 v25, 0, v6, s[68:69]
  v_cndmask_b32 v8, 0, v7, s[70:71]
  v_or_b32 v25, v25, v8
  v_cndmask_b32 v26, 0, v6, s[72:73]
  v_cndmask_b32 v8, 0, v7, s[74:75]
  v_or_b32 v26, v26, v8
  v_cndmask_b32 v27, 0, v6, s[76:77]
  v_cndmask_b32 v8, 0, v7, s[78:79]
  v_or_b32 v27, v27, v8
  v_cndmask_b32 v28, 0, v6, s[80:81]
  v_cndmask_b32 v8, 0, v7, s[82:83]
  v_or_b32 v28, v28, v8
  v_cndmask_b32 v29, 0, v6, s[84:85]
  v_cndmask_b32 v8, 0, v7, s[86:87]
  v_or_b32 v29, v29, v8
  v_cndmask_b32 v30, 0, v6, s[88:89]
  v_cndmask_b32 v8, 0, v7, s[90:91]
  v_or_b32 v30, v30, v8
  v_cndmask_b32 v31, 0, v6, s[98:99]
  v_cndmask_b32 v8, 0, v7, s[100:101]
  v_or_b32 v31, v31, v8
  v_and_b32 v5, 31, v1
  v_lshrrev_b32 v6, 5, v1
  s_lshl_b32 s58, s52, 10
  v_lshl_add_u32 v5, v5, 4, s58
  v_lshl_add_u32 v252, v6, 13, v5
  v_mul_u32_u24 v7, 32960, v6
  v_add_u32 v246, v5, v7
  v_add_u32 v246, 16384, v246
  v_lshl_add_u32 v33, v6, 12, v5
  v_add_u32 v34, 8192, v5
  v_and_b32 v5, 1, v3
  v_and_b32 v7, 3, v1
  v_lshl_add_u32 v5, v5, 2, v7
  s_and_b32 s59, s54, 1
  v_add_u32 v7, s59, v5
  v_cmp_lt_u32 vcc, 4, v5
  s_nop 1
  v_cndmask_b32 v7, v7, 6, vcc
  v_lshrrev_b32 v8, 1, v7
  v_mul_u32_u24 v8, 8256, v8
  v_and_b32 v7, 1, v7
  v_lshl_add_u32 v8, v7, 3, v8
  v_lshrrev_b32 v7, 2, v2
  v_lshl_add_u32 v7, v6, 2, v7
  v_lshl_add_u32 v8, v7, 4, v8
  s_add_u32 s58, s58, 24576
  v_add_u32 v253, s58, v8
  s_mul_i32 s5, s53, 1310720
  s_lshl_b32 s58, s4, 12
  s_add_u32 s5, s5, s58
  s_and_b32 s58, s52, 1
  s_lshl_b32 s58, s58, 11
  s_add_u32 s58, s58, s5
  s_sub_u32 s59, s58, 1310720
  s_cmp_eq_u32 s53, 0
  s_cselect_b32 s59, 2147483648, s59
  s_cmp_lt_u32 s52, 2
  s_cselect_b32 s58, s59, s58
  v_and_b32 v5, 32, v1
  v_lshl_add_u32 v5, v5, 4, v4
  v_add_u32 v32, s58, v5
  s_lshl_b32 s58, s52, 11
  v_add_u32 v20, s58, v5
  s_lshl_b32 s58, s53, 1
  s_lshr_b32 s59, s52, 1
  s_add_u32 s59, s59, s58
  s_lshl_b32 s59, s59, 4
  s_add_u32 s58, s58, s52
  s_sub_u32 s58, s58, 2
  s_max_i32 s58, s58, 0
  s_lshl_b32 s58, s58, 4
  v_and_b32 v5, 1, v1
  v_lshl_add_u32 v5, v5, 1, s4
  v_lshrrev_b32 v5, 4, v5
  v_bfe_u32 v6, v1, 1, 1
  v_mul_u32_u24 v6, 5, v6
  v_add3_u32 v6, v6, v5, 5
  v_add_u32 v6, s58, v6
  v_add_u32 v5, s59, v5
  v_cmp_gt_u32 vcc, 4, v1
  s_nop 1
  v_cndmask_b32 v5, v5, v6, vcc
  v_lshlrev_b32 v35, 7, v5
  s_lshl_b32 s58, s52, 11
  v_add_u32 v36, s58, v4
  s_lshl_b32 s58, s53, 1
  s_add_u32 s58, s58, s52
  s_mov_b32 s59, 0x3f803f80
  s_cmp_lt_u32 s58, 2
  s_cselect_b32 s59, 0xf149f149, s59
  v_mov_b32 v8, s59
  v_mov_b32 v9, s59
  v_mov_b32 v10, s59
  v_mov_b32 v11, s59
  s_waitcnt vmcnt(5)
  s_barrier
  s_lshl_b32 s59, s92, 4
  s_add_u32 s59, s59, s93
  s_lshl_b32 s58, s59, 7
  s_add_u32 s58, s58, 20971520
  s_cmp_lg_u32 s52, 0
  s_cbranch_scc1 Lg1_nf
  v_mov_b32 v240, s3
  v_mov_b32 v241, s51
  v_mov_b32 v242, s3
  v_mov_b32 v243, s51
  s_mov_b64 exec, 0xff
  buffer_store_dwordx4 v[240:243], v4, s[40:43], s58 offen sc1
  s_mov_b64 exec, -1
  s_nop 0
Lg1_nf:
  s_branch Lg1_end
Lspare:
  v_lshrrev_b32 v5, 3, v1
  v_mul_u32_u24 v5, 3456, v5
  v_and_b32 v6, 7, v1
  v_lshl_add_u32 v22, v6, 4, v5
  s_mul_i32 s6, s52, 552960
  s_lshl_b32 s58, s92, 7
  s_add_u32 s6, s6, s58
  s_add_u32 s47, s6, 2048
  s_cmp_lt_u32 s92, 11
  s_cselect_b32 s47, s47, 0x40000000
  s_waitcnt lgkmcnt(0)
  s_mov_b32 s8, s64
  s_and_b32 s9, s65, 0xffff
  s_mov_b32 s12, s66
  s_and_b32 s13, s67, 0xffff
  s_mul_i32 s58, s50, 1280
  buffer_load_dwordx4 v[32:35], v236, s[8:11], s58 offen offset:0
  buffer_load_dwordx4 v[36:39], v236, s[8:11], s58 offen offset:512
  buffer_load_dwordx4 v[40:43], v237, s[8:11], s58 offen offset:1024
  s_mov_b32 s16, s68
  s_and_b32 s17, s69, 0xffff
  s_mov_b32 s20, s72
  s_and_b32 s21, s73, 0xffff
  s_mov_b32 s24, s74
  s_and_b32 s25, s75, 0xffff
  s_mov_b32 s28, s76
  s_and_b32 s29, s77, 0xffff
  s_mov_b32 s32, s78
  s_and_b32 s33, s79, 0xffff
  s_mov_b32 s36, s80
  s_and_b32 s37, s81, 0xffff
  s_mov_b32 s40, s84
  s_and_b32 s41, s85, 0xffff
  s_add_u32 s86, s84, 21209088
  s_addc_u32 s87, s85, 0
  s_load_dword s3, s[86:87], 0
  s_and_b32 s51, s51, 15
  s_mov_b32 s55, 0
  s_lshr_b32 s58, s54, 3
  s_lshl_b32 s58, s58, 2
  s_add_u32 s58, s58, s52
  s_lshl_b32 s59, s53, 4
  s_add_u32 s56, s58, s59
  s_lshl_b32 s44, s58, 8
  s_mul_i32 s59, s53, 1310720
  s_add_u32 s44, s44, s59
  s_and_b32 s57, s54, 7
  v_lshlrev_b32 v248, 4, v2
  v_lshl_add_u32 v248, v3, 12, v248
  buffer_load_dwordx4 v[56:59], v22, s[28:31], s6 offen
  s_add_u32 s6, s6, 27648
  buffer_load_dwordx4 v[60:63], v22, s[28:31], s6 offen
  s_add_u32 s6, s6, 27648
  buffer_load_dwordx4 v[64:67], v22, s[28:31], s6 offen
  s_add_u32 s6, s6, 27648
  buffer_load_dwordx4 v[68:71], v22, s[28:31], s6 offen
  s_add_u32 s6, s6, 27648
  buffer_load_dwordx4 v[72:75], v22, s[28:31], s6 offen
  s_add_u32 s6, s6, 27648
  buffer_load_dwordx4 v[76:79], v22, s[28:31], s6 offen
  s_add_u32 s6, s6, 27648
  buffer_load_dwordx4 v[80:83], v22, s[28:31], s6 offen
  s_add_u32 s6, s6, 27648
  buffer_load_dwordx4 v[84:87], v22, s[28:31], s6 offen
  s_add_u32 s6, s6, 27648
  s_waitcnt lgkmcnt(0)
  s_add_u32 s3, s3, 0x9e3779b9
  s_mul_i32 s5, s52, 3072
  s_add_u32 s5, s5, 151552
  s_add_u32 s59, s92, 240
  s_lshl_b32 s58, s59, 7
  s_add_u32 s58, s58, 21004288
  s_cmp_lg_u32 s52, 0
  s_cbranch_scc1 Lsp_nf2
  v_mov_b32 v240, s3
  v_mov_b32 v241, s51
  v_mov_b32 v242, s3
  v_mov_b32 v243, s51
  s_mov_b64 exec, 0xff
  buffer_store_dwordx4 v[240:243], v4, s[40:43], s58 offen sc1
  s_mov_b64 exec, -1
  s_nop 0
Lsp_nf2:
  s_waitcnt vmcnt(8)
  s_mov_b32 s60, 0x3f803f80
  v_mov_b32 v44, 0
  v_mov_b32 v45, 0
  v_dot2_f32_bf16 v44, v32, s60, v44
  v_dot2_f32_bf16 v45, v32, v32, v45
  v_dot2_f32_bf16 v44, v33, s60, v44
  v_dot2_f32_bf16 v45, v33, v33, v45
  v_dot2_f32_bf16 v44, v34, s60, v44
  v_dot2_f32_bf16 v45, v34, v34, v45
  v_dot2_f32_bf16 v44, v35, s60, v44
  v_dot2_f32_bf16 v45, v35, v35, v45
  v_dot2_f32_bf16 v44, v36, s60, v44
  v_dot2_f32_bf16 v45, v36, v36, v45
  v_dot2_f32_bf16 v44, v37, s60, v44
  v_dot2_f32_bf16 v45, v37, v37, v45
  v_dot2_f32_bf16 v44, v38, s60, v44
  v_dot2_f32_bf16 v45, v38, v38, v45
  v_dot2_f32_bf16 v44, v39, s60, v44
  v_dot2_f32_bf16 v45, v39, v39, v45
  v_dot2_f32_bf16 v44, v40, s60, v44
  v_dot2_f32_bf16 v45, v40, v40, v45
  v_dot2_f32_bf16 v44, v41, s60, v44
  v_dot2_f32_bf16 v45, v41, v41, v45
  v_dot2_f32_bf16 v44, v42, s60, v44
  v_dot2_f32_bf16 v45, v42, v42, v45
  v_dot2_f32_bf16 v44, v43, s60, v44
  v_dot2_f32_bf16 v45, v43, v43, v45
  s_nop 3
  v_add_f32_dpp v44, v44, v44 row_ror:8 row_mask:0xf bank_mask:0xf
  v_add_f32_dpp v45, v45, v45 row_ror:8 row_mask:0xf bank_mask:0xf
  s_nop 0
  v_add_f32_dpp v44, v44, v44 row_ror:4 row_mask:0xf bank_mask:0xf
  v_add_f32_dpp v45, v45, v45 row_ror:4 row_mask:0xf bank_mask:0xf
  s_nop 0
  v_add_f32_dpp v44, v44, v44 row_ror:2 row_mask:0xf bank_mask:0xf
  v_add_f32_dpp v45, v45, v45 row_ror:2 row_mask:0xf bank_mask:0xf
  s_nop 0
  v_add_f32_dpp v44, v44, v44 row_ror:1 row_mask:0xf bank_mask:0xf
  v_add_f32_dpp v45, v45, v45 row_ror:1 row_mask:0xf bank_mask:0xf
  v_mov_b32 v46, v44
  v_mov_b32 v47, v45
  s_nop 0
  v_permlane16_swap_b32 v44, v46
  v_permlane16_swap_b32 v45, v47
  v_add_f32 v44, v44, v46
  v_add_f32 v45, v45, v47
  v_mul_f32 v44, 0x3acccccd, v44
  v_mul_f32 v45, 0x3acccccd, v45
  v_fma_f32 v45, -v44, v44, v45
  v_max_f32 v45, 0, v45
  v_add_f32 v45, 0x3727c5ac, v45
  v_rsq_f32 v45, v45
  v_mov_b32 v46, s3
  v_mov_b32 v47, s3
  v_lshrrev_b32 v5, 5, v1
  v_lshlrev_b32 v5, 6, v5
  v_lshl_add_u32 v5, v2, 4, v5
  s_lshl_b32 s58, s50, 6
  s_add_u32 s58, s58, 21495808
  s_mov_b32 exec_lo, 15
  s_mov_b32 exec_hi, 15
  buffer_store_dwordx4 v[44:47], v5, s[40:43], s58 offen sc1
  s_mov_b64 exec, -1
  buffer_load_dwordx4 v[88:91], v22, s[28:31], s6 offen
  s_add_u32 s6, s6, 27648
  buffer_load_dwordx4 v[92:95], v22, s[28:31], s6 offen
  s_add_u32 s6, s6, 27648
  buffer_load_dwordx4 v[96:99], v22, s[28:31], s6 offen
  s_add_u32 s6, s6, 27648
  buffer_load_dwordx4 v[100:103], v22, s[28:31], s6 offen
  s_add_u32 s6, s6, 27648
  buffer_load_dwordx4 v[104:107], v22, s[28:31], s6 offen
  s_add_u32 s6, s6, 27648
  buffer_load_dwordx4 v[108:111], v22, s[28:31], s6 offen
  s_add_u32 s6, s6, 27648
  buffer_load_dwordx4 v[112:115], v22, s[28:31], s6 offen
  s_add_u32 s6, s6, 27648
  buffer_load_dwordx4 v[116:119], v22, s[28:31], s6 offen
  s_add_u32 s6, s6, 27648
  buffer_load_dwordx4 v[120:123], v22, s[28:31], s6 offen
  s_add_u32 s6, s6, 27648
  buffer_load_dwordx4 v[124:127], v22, s[28:31], s6 offen
  s_add_u32 s6, s6, 27648
  buffer_load_dwordx4 v[128:131], v22, s[28:31], s6 offen
  s_add_u32 s6, s6, 27648
  buffer_load_dwordx4 v[132:135], v22, s[28:31], s6 offen
  s_add_u32 s6, s6, 27648
  s_mov_b32 s78, 0x00003f80
  s_mov_b32 s79, 0x3f800000
  v_mov_b32 v24, 0
  v_mov_b32 v25, 0
  v_mov_b32 v26, 0
  v_mov_b32 v27, 0
  v_mov_b32 v28, 0
  v_mov_b32 v29, 0
  v_mov_b32 v30, 0
  v_mov_b32 v31, 0
  v_mov_b32 v32, 0
  v_mov_b32 v33, 0
  v_mov_b32 v34, 0
  v_mov_b32 v35, 0
  v_mov_b32 v36, 0
  v_mov_b32 v37, 0
  v_mov_b32 v38, 0
  v_mov_b32 v39, 0
  buffer_load_dwordx4 v[136:139], v22, s[28:31], s47 offen
  s_add_u32 s47, s47, 27648
  s_waitcnt vmcnt(21)
  v_dot2_f32_bf16 v24, v56, s78, v24
  v_dot2_f32_bf16 v25, v56, s79, v25
  v_dot2_f32_bf16 v26, v57, s78, v26
  v_dot2_f32_bf16 v27, v57, s79, v27
  v_dot2_f32_bf16 v28, v58, s78, v28
  v_dot2_f32_bf16 v29, v58, s79, v29
  v_dot2_f32_bf16 v30, v59, s78, v30
  v_dot2_f32_bf16 v31, v59, s79, v31
  buffer_load_dwordx4 v[140:143], v22, s[28:31], s47 offen
  s_add_u32 s47, s47, 27648
  s_waitcnt vmcnt(21)
  v_dot2_f32_bf16 v24, v60, s78, v24
  v_dot2_f32_bf16 v25, v60, s79, v25
  v_dot2_f32_bf16 v26, v61, s78, v26
  v_dot2_f32_bf16 v27, v61, s79, v27
  v_dot2_f32_bf16 v28, v62, s78, v28
  v_dot2_f32_bf16 v29, v62, s79, v29
  v_dot2_f32_bf16 v30, v63, s78, v30
  v_dot2_f32_bf16 v31, v63, s79, v31
  buffer_load_dwordx4 v[144:147], v22, s[28:31], s47 offen
  s_add_u32 s47, s47, 27648
  s_waitcnt vmcnt(21)
  v_dot2_f32_bf16 v24, v64, s78, v24
  v_dot2_f32_bf16 v25, v64, s79, v25
  v_dot2_f32_bf16 v26, v65, s78, v26
  v_dot2_f32_bf16 v27, v65, s79, v27
  v_dot2_f32_bf16 v28, v66, s78, v28
  v_dot2_f32_bf16 v29, v66, s79, v29
  v_dot2_f32_bf16 v30, v67, s78, v30
  v_dot2_f32_bf16 v31, v67, s79, v31
  buffer_load_dwordx4 v[148:151], v22, s[28:31], s47 offen
  s_add_u32 s47, s47, 27648
  s_waitcnt vmcnt(21)
  v_dot2_f32_bf16 v24, v68, s78, v24
  v_dot2_f32_bf16 v25, v68, s79, v25
  v_dot2_f32_bf16 v26, v69, s78, v26
  v_dot2_f32_bf16 v27, v69, s79, v27
  v_dot2_f32_bf16 v28, v70, s78, v28
  v_dot2_f32_bf16 v29, v70, s79, v29
  v_dot2_f32_bf16 v30, v71, s78, v30
  v_dot2_f32_bf16 v31, v71, s79, v31
  buffer_load_dwordx4 v[152:155], v22, s[28:31], s47 offen
  s_add_u32 s47, s47, 27648
  s_waitcnt vmcnt(21)
  v_dot2_f32_bf16 v24, v72, s78, v24
  v_dot2_f32_bf16 v25, v72, s79, v25
  v_dot2_f32_bf16 v26, v73, s78, v26
  v_dot2_f32_bf16 v27, v73, s79, v27
  v_dot2_f32_bf16 v28, v74, s78, v28
  v_dot2_f32_bf16 v29, v74, s79, v29
  v_dot2_f32_bf16 v30, v75, s78, v30
  v_dot2_f32_bf16 v31, v75, s79, v31
  buffer_load_dwordx4 v[156:159], v22, s[28:31], s47 offen
  s_add_u32 s47, s47, 27648
  s_waitcnt vmcnt(21)
  v_dot2_f32_bf16 v24, v76, s78, v24
  v_dot2_f32_bf16 v25, v76, s79, v25
  v_dot2_f32_bf16 v26, v77, s78, v26
  v_dot2_f32_bf16 v27, v77, s79, v27
  v_dot2_f32_bf16 v28, v78, s78, v28
  v_dot2_f32_bf16 v29, v78, s79, v29
  v_dot2_f32_bf16 v30, v79, s78, v30
  v_dot2_f32_bf16 v31, v79, s79, v31
  buffer_load_dwordx4 v[160:163], v22, s[28:31], s47 offen
  s_add_u32 s47, s47, 27648
  s_waitcnt vmcnt(21)
  v_dot2_f32_bf16 v24, v80, s78, v24
  v_dot2_f32_bf16 v25, v80, s79, v25
  v_dot2_f32_bf16 v26, v81, s78, v26
  v_dot2_f32_bf16 v27, v81, s79, v27
  v_dot2_f32_bf16 v28, v82, s78, v28
  v_dot2_f32_bf16 v29, v82, s79, v29
  v_dot2_f32_bf16 v30, v83, s78, v30
  v_dot2_f32_bf16 v31, v83, s79, v31
  buffer_load_dwordx4 v[164:167], v22, s[28:31], s47 offen
  s_add_u32 s47, s47, 27648
  s_waitcnt vmcnt(21)
  v_dot2_f32_bf16 v24, v84, s78, v24
  v_dot2_f32_bf16 v25, v84, s79, v25
  v_dot2_f32_bf16 v26, v85, s78, v26
  v_dot2_f32_bf16 v27, v85, s79, v27
  v_dot2_f32_bf16 v28, v86, s78, v28
  v_dot2_f32_bf16 v29, v86, s79, v29
  v_dot2_f32_bf16 v30, v87, s78, v30
  v_dot2_f32_bf16 v31, v87, s79, v31
  buffer_load_dwordx4 v[168:171], v22, s[28:31], s47 offen
  s_add_u32 s47, s47, 27648
  s_waitcnt vmcnt(20)
  v_dot2_f32_bf16 v24, v88, s78, v24
  v_dot2_f32_bf16 v25, v88, s79, v25
  v_dot2_f32_bf16 v26, v89, s78, v26
  v_dot2_f32_bf16 v27, v89, s79, v27
  v_dot2_f32_bf16 v28, v90, s78, v28
  v_dot2_f32_bf16 v29, v90, s79, v29
  v_dot2_f32_bf16 v30, v91, s78, v30
  v_dot2_f32_bf16 v31, v91, s79, v31
  buffer_load_dwordx4 v[172:175], v22, s[28:31], s47 offen
  s_add_u32 s47, s47, 27648
  s_waitcnt vmcnt(20)
  v_dot2_f32_bf16 v24, v92, s78, v24
  v_dot2_f32_bf16 v25, v92, s79, v25
  v_dot2_f32_bf16 v26, v93, s78, v26
  v_dot2_f32_bf16 v27, v93, s79, v27
  v_dot2_f32_bf16 v28, v94, s78, v28
  v_dot2_f32_bf16 v29, v94, s79, v29
  v_dot2_f32_bf16 v30, v95, s78, v30
  v_dot2_f32_bf16 v31, v95, s79, v31
  buffer_load_dwordx4 v[176:179], v22, s[28:31], s47 offen
  s_add_u32 s47, s47, 27648
  s_waitcnt vmcnt(20)
  v_dot2_f32_bf16 v24, v96, s78, v24
  v_dot2_f32_bf16 v25, v96, s79, v25
  v_dot2_f32_bf16 v26, v97, s78, v26
  v_dot2_f32_bf16 v27, v97, s79, v27
  v_dot2_f32_bf16 v28, v98, s78, v28
  v_dot2_f32_bf16 v29, v98, s79, v29
  v_dot2_f32_bf16 v30, v99, s78, v30
  v_dot2_f32_bf16 v31, v99, s79, v31
  buffer_load_dwordx4 v[180:183], v22, s[28:31], s47 offen
  s_add_u32 s47, s47, 27648
  s_waitcnt vmcnt(20)
  v_dot2_f32_bf16 v24, v100, s78, v24
  v_dot2_f32_bf16 v25, v100, s79, v25
  v_dot2_f32_bf16 v26, v101, s78, v26
  v_dot2_f32_bf16 v27, v101, s79, v27
  v_dot2_f32_bf16 v28, v102, s78, v28
  v_dot2_f32_bf16 v29, v102, s79, v29
  v_dot2_f32_bf16 v30, v103, s78, v30
  v_dot2_f32_bf16 v31, v103, s79, v31
  buffer_load_dwordx4 v[184:187], v22, s[28:31], s47 offen
  s_add_u32 s47, s47, 27648
  s_waitcnt vmcnt(20)
  v_dot2_f32_bf16 v24, v104, s78, v24
  v_dot2_f32_bf16 v25, v104, s79, v25
  v_dot2_f32_bf16 v26, v105, s78, v26
  v_dot2_f32_bf16 v27, v105, s79, v27
  v_dot2_f32_bf16 v28, v106, s78, v28
  v_dot2_f32_bf16 v29, v106, s79, v29
  v_dot2_f32_bf16 v30, v107, s78, v30
  v_dot2_f32_bf16 v31, v107, s79, v31
  buffer_load_dwordx4 v[188:191], v22, s[28:31], s47 offen
  s_add_u32 s47, s47, 27648
  s_waitcnt vmcnt(20)
  v_dot2_f32_bf16 v24, v108, s78, v24
  v_dot2_f32_bf16 v25, v108, s79, v25
  v_dot2_f32_bf16 v26, v109, s78, v26
  v_dot2_f32_bf16 v27, v109, s79, v27
  v_dot2_f32_bf16 v28, v110, s78, v28
  v_dot2_f32_bf16 v29, v110, s79, v29
  v_dot2_f32_bf16 v30, v111, s78, v30
  v_dot2_f32_bf16 v31, v111, s79, v31
  buffer_load_dwordx4 v[192:195], v22, s[28:31], s47 offen
  s_add_u32 s47, s47, 27648
  s_waitcnt vmcnt(20)
  v_dot2_f32_bf16 v24, v112, s78, v24
  v_dot2_f32_bf16 v25, v112, s79, v25
  v_dot2_f32_bf16 v26, v113, s78, v26
  v_dot2_f32_bf16 v27, v113, s79, v27
  v_dot2_f32_bf16 v28, v114, s78, v28
  v_dot2_f32_bf16 v29, v114, s79, v29
  v_dot2_f32_bf16 v30, v115, s78, v30
  v_dot2_f32_bf16 v31, v115, s79, v31
  buffer_load_dwordx4 v[196:199], v22, s[28:31], s47 offen
  s_add_u32 s47, s47, 27648
  s_waitcnt vmcnt(20)
  v_dot2_f32_bf16 v24, v116, s78, v24
  v_dot2_f32_bf16 v25, v116, s79, v25
  v_dot2_f32_bf16 v26, v117, s78, v26
  v_dot2_f32_bf16 v27, v117, s79, v27
  v_dot2_f32_bf16 v28, v118, s78, v28
  v_dot2_f32_bf16 v29, v118, s79, v29
  v_dot2_f32_bf16 v30, v119, s78, v30
  v_dot2_f32_bf16 v31, v119, s79, v31
  buffer_load_dwordx4 v[200:203], v22, s[28:31], s47 offen
  s_add_u32 s47, s47, 27648
  s_waitcnt vmcnt(20)
  v_dot2_f32_bf16 v24, v120, s78, v24
  v_dot2_f32_bf16 v25, v120, s79, v25
  v_dot2_f32_bf16 v26, v121, s78, v26
  v_dot2_f32_bf16 v27, v121, s79, v27
  v_dot2_f32_bf16 v28, v122, s78, v28
  v_dot2_f32_bf16 v29, v122, s79, v29
  v_dot2_f32_bf16 v30, v123, s78, v30
  v_dot2_f32_bf16 v31, v123, s79, v31
  buffer_load_dwordx4 v[204:207], v22, s[28:31], s47 offen
  s_add_u32 s47, s47, 27648
  s_waitcnt vmcnt(20)
  v_dot2_f32_bf16 v24, v124, s78, v24
  v_dot2_f32_bf16 v25, v124, s79, v25
  v_dot2_f32_bf16 v26, v125, s78, v26
  v_dot2_f32_bf16 v27, v125, s79, v27
  v_dot2_f32_bf16 v28, v126, s78, v28
  v_dot2_f32_bf16 v29, v126, s79, v29
  v_dot2_f32_bf16 v30, v127, s78, v30
  v_dot2_f32_bf16 v31, v127, s79, v31
  buffer_load_dwordx4 v[208:211], v22, s[28:31], s47 offen
  s_add_u32 s47, s47, 27648
  s_waitcnt vmcnt(20)
  v_dot2_f32_bf16 v24, v128, s78, v24
  v_dot2_f32_bf16 v25, v128, s79, v25
  v_dot2_f32_bf16 v26, v129, s78, v26
  v_dot2_f32_bf16 v27, v129, s79, v27
  v_dot2_f32_bf16 v28, v130, s78, v28
  v_dot2_f32_bf16 v29, v130, s79, v29
  v_dot2_f32_bf16 v30, v131, s78, v30
  v_dot2_f32_bf16 v31, v131, s79, v31
  buffer_load_dwordx4 v[212:215], v22, s[28:31], s47 offen
  s_add_u32 s47, s47, 27648
  s_waitcnt vmcnt(20)
  v_dot2_f32_bf16 v24, v132, s78, v24
  v_dot2_f32_bf16 v25, v132, s79, v25
  v_dot2_f32_bf16 v26, v133, s78, v26
  v_dot2_f32_bf16 v27, v133, s79, v27
  v_dot2_f32_bf16 v28, v134, s78, v28
  v_dot2_f32_bf16 v29, v134, s79, v29
  v_dot2_f32_bf16 v30, v135, s78, v30
  v_dot2_f32_bf16 v31, v135, s79, v31
  s_lshr_b32 s58, s92, 1
  s_and_b32 s59, s92, 1
  v_lshlrev_b32 v21, 7, v1
  s_lshl_b32 s4, s92, 13
  s_lshl_b32 s61, s52, 17
  s_add_u32 s4, s4, s61
  s_add_u32 s4, s4, 28065792
  s_cmp_lt_u32 s52, 2
  s_cselect_b32 s4, s4, 0x40000000
  buffer_load_dword v244, v21, s[40:43], s4 offen
  s_mul_i32 s4, s58, 327680
  s_mul_i32 s59, s59, 3968
  s_add_u32 s4, s4, s59
  s_mul_i32 s61, s52, 81920
  s_add_u32 s4, s4, s61
  s_add_u32 s4, s4, 10485760
  v_lshlrev_b32 v5, 12, v1
  s_mov_b64 exec, 0xfffff
  buffer_load_dword v244, v5, s[40:43], s4 offen
  s_mov_b64 exec, -1
  v_lshrrev_b32 v5, 2, v1
  v_lshlrev_b32 v5, 12, v5
  v_and_b32 v6, 3, v1
  v_lshl_add_u32 v5, v6, 7, v5
  s_lshl_b32 s4, s58, 9
  s_add_u32 s4, s4, 28348416
  s_mov_b64 exec, 0xffffff
  buffer_load_dword v244, v5, s[40:43], s4 offen
  s_mov_b64 exec, -1
  s_mov_b32 s7, 21004288
  s_mul_i32 s68, s56, 20480
  s_mul_i32 s69, s57, 160
  s_add_u32 s68, s68, s69
  s_mov_b32 s69, 6554
  v_add_u32 v5, 0, v1
  v_mul_u32_u24 v6, s69, v5
  v_lshrrev_b32 v6, 16, v6
  v_lshlrev_b32 v5, 4, v5
  v_min_u32 v6, 15, v6
  v_mul_u32_u24 v6, 1120, v6
  v_add_u32 v239, v5, v6
  s_add_u32 m0, s5, 0
  s_nop 0
  buffer_load_dwordx4 v239, s[8:11], s68 offen lds
  v_add_u32 v5, 64, v1
  v_mul_u32_u24 v6, s69, v5
  v_lshrrev_b32 v6, 16, v6
  v_lshlrev_b32 v5, 4, v5
  v_min_u32 v6, 15, v6
  v_mul_u32_u24 v6, 1120, v6
  v_add_u32 v239, v5, v6
  s_add_u32 m0, s5, 1024
  s_nop 0
  buffer_load_dwordx4 v239, s[8:11], s68 offen lds
  v_add_u32 v5, 128, v1
  v_mul_u32_u24 v6, s69, v5
  v_lshrrev_b32 v6, 16, v6
  v_lshlrev_b32 v5, 4, v5
  v_min_u32 v6, 15, v6
  v_mul_u32_u24 v6, 1120, v6
  v_add_u32 v239, v5, v6
  s_add_u32 m0, s5, 2048
  s_nop 0
  buffer_load_dwordx4 v239, s[8:11], s68 offen lds
  s_waitcnt vmcnt(25)
  v_dot2_f32_bf16 v32, v136, s78, v32
  v_dot2_f32_bf16 v33, v136, s79, v33
  v_dot2_f32_bf16 v34, v137, s78, v34
  v_dot2_f32_bf16 v35, v137, s79, v35
  v_dot2_f32_bf16 v36, v138, s78, v36
  v_dot2_f32_bf16 v37, v138, s79, v37
  v_dot2_f32_bf16 v38, v139, s78, v38
  v_dot2_f32_bf16 v39, v139, s79, v39
  s_waitcnt vmcnt(24)
  v_dot2_f32_bf16 v32, v140, s78, v32
  v_dot2_f32_bf16 v33, v140, s79, v33
  v_dot2_f32_bf16 v34, v141, s78, v34
  v_dot2_f32_bf16 v35, v141, s79, v35
  v_dot2_f32_bf16 v36, v142, s78, v36
  v_dot2_f32_bf16 v37, v142, s79, v37
  v_dot2_f32_bf16 v38, v143, s78, v38
  v_dot2_f32_bf16 v39, v143, s79, v39
  s_waitcnt vmcnt(23)
  v_dot2_f32_bf16 v32, v144, s78, v32
  v_dot2_f32_bf16 v33, v144, s79, v33
  v_dot2_f32_bf16 v34, v145, s78, v34
  v_dot2_f32_bf16 v35, v145, s79, v35
  v_dot2_f32_bf16 v36, v146, s78, v36
  v_dot2_f32_bf16 v37, v146, s79, v37
  v_dot2_f32_bf16 v38, v147, s78, v38
  v_dot2_f32_bf16 v39, v147, s79, v39
  s_waitcnt vmcnt(22)
  v_dot2_f32_bf16 v32, v148, s78, v32
  v_dot2_f32_bf16 v33, v148, s79, v33
  v_dot2_f32_bf16 v34, v149, s78, v34
  v_dot2_f32_bf16 v35, v149, s79, v35
  v_dot2_f32_bf16 v36, v150, s78, v36
  v_dot2_f32_bf16 v37, v150, s79, v37
  v_dot2_f32_bf16 v38, v151, s78, v38
  v_dot2_f32_bf16 v39, v151, s79, v39
  s_waitcnt vmcnt(21)
  v_dot2_f32_bf16 v32, v152, s78, v32
  v_dot2_f32_bf16 v33, v152, s79, v33
  v_dot2_f32_bf16 v34, v153, s78, v34
  v_dot2_f32_bf16 v35, v153, s79, v35
  v_dot2_f32_bf16 v36, v154, s78, v36
  v_dot2_f32_bf16 v37, v154, s79, v37
  v_dot2_f32_bf16 v38, v155, s78, v38
  v_dot2_f32_bf16 v39, v155, s79, v39
  s_waitcnt vmcnt(20)
  v_dot2_f32_bf16 v32, v156, s78, v32
  v_dot2_f32_bf16 v33, v156, s79, v33
  v_dot2_f32_bf16 v34, v157, s78, v34
  v_dot2_f32_bf16 v35, v157, s79, v35
  v_dot2_f32_bf16 v36, v158, s78, v36
  v_dot2_f32_bf16 v37, v158, s79, v37
  v_dot2_f32_bf16 v38, v159, s78, v38
  v_dot2_f32_bf16 v39, v159, s79, v39
  s_waitcnt vmcnt(19)
  v_dot2_f32_bf16 v32, v160, s78, v32
  v_dot2_f32_bf16 v33, v160, s79, v33
  v_dot2_f32_bf16 v34, v161, s78, v34
  v_dot2_f32_bf16 v35, v161, s79, v35
  v_dot2_f32_bf16 v36, v162, s78, v36
  v_dot2_f32_bf16 v37, v162, s79, v37
  v_dot2_f32_bf16 v38, v163, s78, v38
  v_dot2_f32_bf16 v39, v163, s79, v39
  s_waitcnt vmcnt(18)
  v_dot2_f32_bf16 v32, v164, s78, v32
  v_dot2_f32_bf16 v33, v164, s79, v33
  v_dot2_f32_bf16 v34, v165, s78, v34
  v_dot2_f32_bf16 v35, v165, s79, v35
  v_dot2_f32_bf16 v36, v166, s78, v36
  v_dot2_f32_bf16 v37, v166, s79, v37
  v_dot2_f32_bf16 v38, v167, s78, v38
  v_dot2_f32_bf16 v39, v167, s79, v39
  s_waitcnt vmcnt(17)
  v_dot2_f32_bf16 v32, v168, s78, v32
  v_dot2_f32_bf16 v33, v168, s79, v33
  v_dot2_f32_bf16 v34, v169, s78, v34
  v_dot2_f32_bf16 v35, v169, s79, v35
  v_dot2_f32_bf16 v36, v170, s78, v36
  v_dot2_f32_bf16 v37, v170, s79, v37
  v_dot2_f32_bf16 v38, v171, s78, v38
  v_dot2_f32_bf16 v39, v171, s79, v39
  s_waitcnt vmcnt(16)
  v_dot2_f32_bf16 v32, v172, s78, v32
  v_dot2_f32_bf16 v33, v172, s79, v33
  v_dot2_f32_bf16 v34, v173, s78, v34
  v_dot2_f32_bf16 v35, v173, s79, v35
  v_dot2_f32_bf16 v36, v174, s78, v36
  v_dot2_f32_bf16 v37, v174, s79, v37
  v_dot2_f32_bf16 v38, v175, s78, v38
  v_dot2_f32_bf16 v39, v175, s79, v39
  s_waitcnt vmcnt(15)
  v_dot2_f32_bf16 v32, v176, s78, v32
  v_dot2_f32_bf16 v33, v176, s79, v33
  v_dot2_f32_bf16 v34, v177, s78, v34
  v_dot2_f32_bf16 v35, v177, s79, v35
  v_dot2_f32_bf16 v36, v178, s78, v36
  v_dot2_f32_bf16 v37, v178, s79, v37
  v_dot2_f32_bf16 v38, v179, s78, v38
  v_dot2_f32_bf16 v39, v179, s79, v39
  s_waitcnt vmcnt(14)
  v_dot2_f32_bf16 v32, v180, s78, v32
  v_dot2_f32_bf16 v33, v180, s79, v33
  v_dot2_f32_bf16 v34, v181, s78, v34
  v_dot2_f32_bf16 v35, v181, s79, v35
  v_dot2_f32_bf16 v36, v182, s78, v36
  v_dot2_f32_bf16 v37, v182, s79, v37
  v_dot2_f32_bf16 v38, v183, s78, v38
  v_dot2_f32_bf16 v39, v183, s79, v39
  s_waitcnt vmcnt(13)
  v_dot2_f32_bf16 v32, v184, s78, v32
  v_dot2_f32_bf16 v33, v184, s79, v33
  v_dot2_f32_bf16 v34, v185, s78, v34
  v_dot2_f32_bf16 v35, v185, s79, v35
  v_dot2_f32_bf16 v36, v186, s78, v36
  v_dot2_f32_bf16 v37, v186, s79, v37
  v_dot2_f32_bf16 v38, v187, s78, v38
  v_dot2_f32_bf16 v39, v187, s79, v39
  s_waitcnt vmcnt(12)
  v_dot2_f32_bf16 v32, v188, s78, v32
  v_dot2_f32_bf16 v33, v188, s79, v33
  v_dot2_f32_bf16 v34, v189, s78, v34
  v_dot2_f32_bf16 v35, v189, s79, v35
  v_dot2_f32_bf16 v36, v190, s78, v36
  v_dot2_f32_bf16 v37, v190, s79, v37
  v_dot2_f32_bf16 v38, v191, s78, v38
  v_dot2_f32_bf16 v39, v191, s79, v39
  s_waitcnt vmcnt(11)
  v_dot2_f32_bf16 v32, v192, s78, v32
  v_dot2_f32_bf16 v33, v192, s79, v33
  v_dot2_f32_bf16 v34, v193, s78, v34
  v_dot2_f32_bf16 v35, v193, s79, v35
  v_dot2_f32_bf16 v36, v194, s78, v36
  v_dot2_f32_bf16 v37, v194, s79, v37
  v_dot2_f32_bf16 v38, v195, s78, v38
  v_dot2_f32_bf16 v39, v195, s79, v39
  s_waitcnt vmcnt(10)
  v_dot2_f32_bf16 v32, v196, s78, v32
  v_dot2_f32_bf16 v33, v196, s79, v33
  v_dot2_f32_bf16 v34, v197, s78, v34
  v_dot2_f32_bf16 v35, v197, s79, v35
  v_dot2_f32_bf16 v36, v198, s78, v36
  v_dot2_f32_bf16 v37, v198, s79, v37
  v_dot2_f32_bf16 v38, v199, s78, v38
  v_dot2_f32_bf16 v39, v199, s79, v39
  s_waitcnt vmcnt(9)
  v_dot2_f32_bf16 v32, v200, s78, v32
  v_dot2_f32_bf16 v33, v200, s79, v33
  v_dot2_f32_bf16 v34, v201, s78, v34
  v_dot2_f32_bf16 v35, v201, s79, v35
  v_dot2_f32_bf16 v36, v202, s78, v36
  v_dot2_f32_bf16 v37, v202, s79, v37
  v_dot2_f32_bf16 v38, v203, s78, v38
  v_dot2_f32_bf16 v39, v203, s79, v39
  s_waitcnt vmcnt(8)
  v_dot2_f32_bf16 v32, v204, s78, v32
  v_dot2_f32_bf16 v33, v204, s79, v33
  v_dot2_f32_bf16 v34, v205, s78, v34
  v_dot2_f32_bf16 v35, v205, s79, v35
  v_dot2_f32_bf16 v36, v206, s78, v36
  v_dot2_f32_bf16 v37, v206, s79, v37
  v_dot2_f32_bf16 v38, v207, s78, v38
  v_dot2_f32_bf16 v39, v207, s79, v39
  s_waitcnt vmcnt(7)
  v_dot2_f32_bf16 v32, v208, s78, v32
  v_dot2_f32_bf16 v33, v208, s79, v33
  v_dot2_f32_bf16 v34, v209, s78, v34
  v_dot2_f32_bf16 v35, v209, s79, v35
  v_dot2_f32_bf16 v36, v210, s78, v36
  v_dot2_f32_bf16 v37, v210, s79, v37
  v_dot2_f32_bf16 v38, v211, s78, v38
  v_dot2_f32_bf16 v39, v211, s79, v39
  s_waitcnt vmcnt(6)
  v_dot2_f32_bf16 v32, v212, s78, v32
  v_dot2_f32_bf16 v33, v212, s79, v33
  v_dot2_f32_bf16 v34, v213, s78, v34
  v_dot2_f32_bf16 v35, v213, s79, v35
  v_dot2_f32_bf16 v36, v214, s78, v36
  v_dot2_f32_bf16 v37, v214, s79, v37
  v_dot2_f32_bf16 v38, v215, s78, v38
  v_dot2_f32_bf16 v39, v215, s79, v39
  s_nop 3
  s_lshl_b32 s59, s52, 11
  v_lshlrev_b32 v6, 5, v1
  v_add_u32 v6, s59, v6
  ds_write_b128 v6, v[24:27]
  ds_write_b128 v6, v[28:31] offset:16
  ds_write_b128 v6, v[32:35] offset:8192
  ds_write_b128 v6, v[36:39] offset:8208
  v_mul_u32_u24 v5, 160, v2
  v_lshl_add_u32 v5, v3, 3, v5
  v_add_u32 v239, s5, v5
  s_waitcnt vmcnt(0)
  ds_read_b64 a[0:1], v239 offset:0
  ds_read_b64 a[2:3], v239 offset:32
  ds_read_b64 a[4:5], v239 offset:64
  ds_read_b64 a[6:7], v239 offset:96
  ds_read_b64 a[8:9], v239 offset:128
  s_waitcnt lgkmcnt(0)
  s_barrier
  v_lshlrev_b32 v7, 2, v1
  s_mov_b32 s7, 35
  s_cmp_ge_u32 s52, 2
  s_cbranch_scc1 Lsp_a
  s_lshl_b32 s58, s52, 13
  v_add_u32 v6, s58, v7
  ds_read_b32 v56, v6 offset:0
  ds_read_b32 v57, v6 offset:256
  ds_read_b32 v58, v6 offset:512
  ds_read_b32 v59, v6 offset:768
  ds_read_b32 v60, v6 offset:1024
  ds_read_b32 v61, v6 offset:1280
  ds_read_b32 v62, v6 offset:1536
  ds_read_b32 v63, v6 offset:1792
  s_waitcnt lgkmcnt(0)
  ds_read_b32 v64, v6 offset:2048
  ds_read_b32 v65, v6 offset:2304
  ds_read_b32 v66, v6 offset:2560
  ds_read_b32 v67, v6 offset:2816
  ds_read_b32 v68, v6 offset:3072
  ds_read_b32 v69, v6 offset:3328
  ds_read_b32 v70, v6 offset:3584
  ds_read_b32 v71, v6 offset:3840
  s_waitcnt lgkmcnt(0)
  ds_read_b32 v72, v6 offset:4096
  ds_read_b32 v73, v6 offset:4352
  ds_read_b32 v74, v6 offset:4608
  ds_read_b32 v75, v6 offset:4864
  ds_read_b32 v76, v6 offset:5120
  ds_read_b32 v77, v6 offset:5376
  ds_read_b32 v78, v6 offset:5632
  ds_read_b32 v79, v6 offset:5888
  s_waitcnt lgkmcnt(0)
  ds_read_b32 v80, v6 offset:6144
  ds_read_b32 v81, v6 offset:6400
  ds_read_b32 v82, v6 offset:6656
  ds_read_b32 v83, v6 offset:6912
  ds_read_b32 v84, v6 offset:7168
  ds_read_b32 v85, v6 offset:7424
  ds_read_b32 v86, v6 offset:7680
  ds_read_b32 v87, v6 offset:7936
  s_waitcnt lgkmcnt(0)
  v_add_f32 v56, v56, v57
  v_add_f32 v56, v56, v58
  v_add_f32 v56, v56, v59
  v_add_f32 v56, v56, v60
  v_add_f32 v56, v56, v61
  v_add_f32 v56, v56, v62
  v_add_f32 v56, v56, v63
  v_add_f32 v56, v56, v64
  v_add_f32 v56, v56, v65
  v_add_f32 v56, v56, v66
  v_add_f32 v56, v56, v67
  v_add_f32 v56, v56, v68
  v_add_f32 v56, v56, v69
  v_add_f32 v56, v56, v70
  v_add_f32 v56, v56, v71
  v_add_f32 v56, v56, v72
  v_add_f32 v56, v56, v73
  v_add_f32 v56, v56, v74
  v_add_f32 v56, v56, v75
  v_add_f32 v56, v56, v76
  v_add_f32 v56, v56, v77
  v_add_f32 v56, v56, v78
  v_add_f32 v56, v56, v79
  v_add_f32 v56, v56, v80
  v_add_f32 v56, v56, v81
  v_add_f32 v56, v56, v82
  v_add_f32 v56, v56, v83
  v_add_f32 v56, v56, v84
  v_add_f32 v56, v56, v85
  v_add_f32 v56, v56, v86
  v_add_f32 v56, v56, v87
  s_lshl_b32 s58, s52, 4
  s_add_u32 s58, s58, s92
  s_lshl_b32 s59, s58, 8
  s_add_u32 s59, s59, 28332032
  s_add_u32 s7, s58, 8
  s_min_u32 s7, s7, 35
  s_cmp_lt_u32 s58, 27
  s_cselect_b32 s59, s59, 0x40000000
  buffer_store_dword v56, v7, s[40:43], s59 offen sc1
Lsp_a:
  s_barrier
  v_min_u32 v237, 4, v1
  v_lshlrev_b32 v237, 2, v237
  v_add_u32 v237, s52, v237
  v_add_u32 v237, 0, v237
  v_min_u32 v237, 113, v237
  v_lshlrev_b32 v237, 8, v237
  s_lshr_b32 s61, s57, 2
  s_lshl_b32 s61, s61, 7
  s_add_u32 s61, s61, 21004288
  v_add_u32 v237, s61, v237
  s_mov_b32 s48, 0
  s_nop 0
Lpoll_6:
  buffer_load_dword v240, v237, s[40:43], 0 offen sc1
  s_add_u32 s48, s48, 1
  s_cmp_gt_u32 s48, 0x40000
  s_cbranch_scc1 Lend
  s_waitcnt vmcnt(0)
  v_cmp_ne_u32 vcc, s3, v240
  s_nop 4
  s_cbranch_vccnz Lpoll_6
  s_mul_i32 s63, s57, 5120
  s_mul_i32 s46, s52, 40960
  s_add_u32 s46, s46, s63
  s_add_u32 s46, s46, 13107200
  s_add_u32 s47, s46, 0
  buffer_load_dwordx4 a[56:59], v4, s[40:43], s47 offen offset:0 sc1
  buffer_load_dwordx4 a[60:63], v4, s[40:43], s47 offen offset:1024 sc1
  buffer_load_dwordx4 a[64:67], v4, s[40:43], s47 offen offset:2048 sc1
  buffer_load_dwordx4 a[68:71], v4, s[40:43], s47 offen offset:3072 sc1
  s_add_u32 s47, s46, 4096
  buffer_load_dwordx4 a[72:75], v4, s[40:43], s47 offen offset:0 sc1
  s_add_u32 s47, s46, 163840
  buffer_load_dwordx4 a[76:79], v4, s[40:43], s47 offen offset:0 sc1
  buffer_load_dwordx4 a[80:83], v4, s[40:43], s47 offen offset:1024 sc1
  buffer_load_dwordx4 a[84:87], v4, s[40:43], s47 offen offset:2048 sc1
  buffer_load_dwordx4 a[88:91], v4, s[40:43], s47 offen offset:3072 sc1
  s_add_u32 s47, s46, 167936
  buffer_load_dwordx4 a[92:95], v4, s[40:43], s47 offen offset:0 sc1
  s_add_u32 s47, s46, 327680
  buffer_load_dwordx4 a[96:99], v4, s[40:43], s47 offen offset:0 sc1
  buffer_load_dwordx4 a[100:103], v4, s[40:43], s47 offen offset:1024 sc1
  buffer_load_dwordx4 a[104:107], v4, s[40:43], s47 offen offset:2048 sc1
  buffer_load_dwordx4 a[108:111], v4, s[40:43], s47 offen offset:3072 sc1
  s_add_u32 s47, s46, 331776
  buffer_load_dwordx4 a[112:115], v4, s[40:43], s47 offen offset:0 sc1
  s_add_u32 s47, s46, 491520
  buffer_load_dwordx4 a[116:119], v4, s[40:43], s47 offen offset:0 sc1
  buffer_load_dwordx4 a[120:123], v4, s[40:43], s47 offen offset:1024 sc1
  buffer_load_dwordx4 a[124:127], v4, s[40:43], s47 offen offset:2048 sc1
  buffer_load_dwordx4 a[128:131], v4, s[40:43], s47 offen offset:3072 sc1
  s_add_u32 s47, s46, 495616
  buffer_load_dwordx4 a[132:135], v4, s[40:43], s47 offen offset:0 sc1
  s_add_u32 s47, s46, 655360
  buffer_load_dwordx4 a[136:139], v4, s[40:43], s47 offen offset:0 sc1
  buffer_load_dwordx4 a[140:143], v4, s[40:43], s47 offen offset:1024 sc1
  buffer_load_dwordx4 a[144:147], v4, s[40:43], s47 offen offset:2048 sc1
  buffer_load_dwordx4 a[148:151], v4, s[40:43], s47 offen offset:3072 sc1
  s_add_u32 s47, s46, 659456
  buffer_load_dwordx4 a[152:155], v4, s[40:43], s47 offen offset:0 sc1
  s_cmp_lt_u32 s52, 2
  s_cbranch_scc1 Lsp_skip
  s_cmp_eq_u32 s52, 2
  s_cbranch_scc1 Lsp_w1
  s_cmp_lg_u32 s92, 15
  s_cbranch_scc1 Lsp_skip
  s_mov_b32 s4, 21004288
  s_mov_b32 s48, 0
Lpoll_7:
  buffer_load_dword v240, v21, s[40:43], s4 offen sc1
  s_add_u32 s48, s48, 1
  s_cmp_gt_u32 s48, 0x40000
  s_cbranch_scc1 Lend
  s_waitcnt vmcnt(0)
  v_cmp_ne_u32 vcc, s3, v240
  s_nop 4
  s_cbranch_vccnz Lpoll_7
  s_mov_b32 s4, 21012480
  s_mov_b32 s48, 0
Lpoll_8:
  buffer_load_dword v240, v21, s[40:43], s4 offen sc1
  s_add_u32 s48, s48, 1
  s_cmp_gt_u32 s48, 0x40000
  s_cbranch_scc1 Lend
  s_waitcnt vmcnt(0)
  v_cmp_ne_u32 vcc, s3, v240
  s_nop 4
  s_cbranch_vccnz Lpoll_8
  s_mov_b32 s4, 21020672
  s_mov_b32 s48, 0
Lpoll_9:
  buffer_load_dword v240, v21, s[40:43], s4 offen sc1
  s_add_u32 s48, s48, 1
  s_cmp_gt_u32 s48, 0x40000
  s_cbranch_scc1 Lend
  s_waitcnt vmcnt(0)
  v_cmp_ne_u32 vcc, s3, v240
  s_nop 4
  s_cbranch_vccnz Lpoll_9
  s_mov_b32 s4, 21028864
  s_mov_b32 s48, 0
Lpoll_10:
  buffer_load_dword v240, v21, s[40:43], s4 offen sc1
  s_add_u32 s48, s48, 1
  s_cmp_gt_u32 s48, 0x40000
  s_cbranch_scc1 Lend
  s_waitcnt vmcnt(0)
  v_cmp_ne_u32 vcc, s3, v240
  s_nop 4
  s_cbranch_vccnz Lpoll_10
  s_mov_b32 s58, 21209088
  v_mov_b32 v240, s3
  v_mov_b32 v241, s51
  v_mov_b32 v242, s3
  v_mov_b32 v243, s51
  s_mov_b64 exec, 0xff
  buffer_store_dwordx4 v[240:243], v4, s[40:43], s58 offen sc1
  s_mov_b64 exec, -1
  s_nop 0
  s_branch Lsp_skip
Lsp_w1:
  s_cmp_ge_u32 s92, 8
  s_cbranch_scc1 Lsp_skip
  v_min_u32 v6, 19, v1
  v_lshlrev_b32 v6, 8, v6
  s_lshr_b32 s4, s92, 2
  s_lshl_b32 s4, s4, 7
  s_add_u32 s4, s4, 21009408
  s_mov_b32 s48, 0
Lpoll_11:
  buffer_load_dword v240, v6, s[40:43], s4 offen sc1
  s_add_u32 s48, s48, 1
  s_cmp_gt_u32 s48, 0x40000
  s_cbranch_scc1 Lend
  s_waitcnt vmcnt(0)
  v_cmp_ne_u32 vcc, s3, v240
  s_nop 4
  s_cbranch_vccnz Lpoll_11
  v_lshlrev_b32 v7, 3, v1
  s_lshl_b32 s60, s92, 9
  s_add_u32 s58, s60, 28327936
  s_add_u32 s60, s60, 20185088
  s_mov_b32 s7, s92
  buffer_load_dwordx2 v[56:57], v7, s[40:43], s60 offen sc1
  s_add_u32 s60, s60, 4096
  buffer_load_dwordx2 v[58:59], v7, s[40:43], s60 offen sc1
  s_add_u32 s60, s60, 4096
  buffer_load_dwordx2 v[60:61], v7, s[40:43], s60 offen sc1
  s_add_u32 s60, s60, 4096
  buffer_load_dwordx2 v[62:63], v7, s[40:43], s60 offen sc1
  s_add_u32 s60, s60, 4096
  buffer_load_dwordx2 v[64:65], v7, s[40:43], s60 offen sc1
  s_add_u32 s60, s60, 4096
  buffer_load_dwordx2 v[66:67], v7, s[40:43], s60 offen sc1
  s_add_u32 s60, s60, 4096
  buffer_load_dwordx2 v[68:69], v7, s[40:43], s60 offen sc1
  s_add_u32 s60, s60, 4096
  buffer_load_dwordx2 v[70:71], v7, s[40:43], s60 offen sc1
  s_add_u32 s60, s60, 4096
  buffer_load_dwordx2 v[72:73], v7, s[40:43], s60 offen sc1
  s_add_u32 s60, s60, 4096
  buffer_load_dwordx2 v[74:75], v7, s[40:43], s60 offen sc1
  s_add_u32 s60, s60, 4096
  buffer_load_dwordx2 v[76:77], v7, s[40:43], s60 offen sc1
  s_add_u32 s60, s60, 4096
  buffer_load_dwordx2 v[78:79], v7, s[40:43], s60 offen sc1
  s_add_u32 s60, s60, 4096
  buffer_load_dwordx2 v[80:81], v7, s[40:43], s60 offen sc1
  s_add_u32 s60, s60, 4096
  buffer_load_dwordx2 v[82:83], v7, s[40:43], s60 offen sc1
  s_add_u32 s60, s60, 4096
  buffer_load_dwordx2 v[84:85], v7, s[40:43], s60 offen sc1
  s_add_u32 s60, s60, 4096
  buffer_load_dwordx2 v[86:87], v7, s[40:43], s60 offen sc1
  s_add_u32 s60, s60, 4096
  buffer_load_dwordx2 v[88:89], v7, s[40:43], s60 offen sc1
  s_add_u32 s60, s60, 4096
  buffer_load_dwordx2 v[90:91], v7, s[40:43], s60 offen sc1
  s_add_u32 s60, s60, 4096
  buffer_load_dwordx2 v[92:93], v7, s[40:43], s60 offen sc1
  s_add_u32 s60, s60, 4096
  buffer_load_dwordx2 v[94:95], v7, s[40:43], s60 offen sc1
  s_add_u32 s60, s60, 4096
  s_waitcnt vmcnt(0)
  v_pk_add_f32 v[56:57], v[56:57], v[58:59]
  v_pk_add_f32 v[56:57], v[56:57], v[60:61]
  v_pk_add_f32 v[56:57], v[56:57], v[62:63]
  v_pk_add_f32 v[56:57], v[56:57], v[64:65]
  v_pk_add_f32 v[56:57], v[56:57], v[66:67]
  v_pk_add_f32 v[56:57], v[56:57], v[68:69]
  v_pk_add_f32 v[56:57], v[56:57], v[70:71]
  v_pk_add_f32 v[56:57], v[56:57], v[72:73]
  v_pk_add_f32 v[56:57], v[56:57], v[74:75]
  v_pk_add_f32 v[56:57], v[56:57], v[76:77]
  v_pk_add_f32 v[56:57], v[56:57], v[78:79]
  v_pk_add_f32 v[56:57], v[56:57], v[80:81]
  v_pk_add_f32 v[56:57], v[56:57], v[82:83]
  v_pk_add_f32 v[56:57], v[56:57], v[84:85]
  v_pk_add_f32 v[56:57], v[56:57], v[86:87]
  v_pk_add_f32 v[56:57], v[56:57], v[88:89]
  v_pk_add_f32 v[56:57], v[56:57], v[90:91]
  v_pk_add_f32 v[56:57], v[56:57], v[92:93]
  v_pk_add_f32 v[56:57], v[56:57], v[94:95]
  buffer_store_dwordx2 v[56:57], v7, s[40:43], s58 offen sc1
  s_nop 0
Lsp_skip:
  s_lshr_b32 s58, s54, 1
  s_mul_i32 s4, s58, 5
  s_and_b32 s59, s54, 1
  s_lshl_b32 s59, s59, 1
  s_add_u32 s4, s4, s59
  v_and_b32 v5, 31, v1
  v_lshlrev_b32 v5, 4, v5
  v_lshrrev_b32 v6, 5, v1
  v_lshl_add_u32 v6, v6, 12, v5
  s_mul_i32 s60, s53, 1310720
  s_lshl_b32 s61, s52, 10
  s_add_u32 s60, s60, s61
  s_mul_i32 s58, s58, 20480
  s_add_u32 s60, s60, s58
  s_mul_i32 s58, s59, 6144
  s_add_u32 s58, s58, s60
  v_add_u32 v254, s58, v6
  s_lshl_b32 s58, s59, 2
  s_add_u32 s58, s58, s60
  s_add_u32 s58, s58, 8192
  v_add_u32 v255, s58, v5
  v_and_b32 v5, 31, v1
  v_lshrrev_b32 v6, 5, v1
  v_lshlrev_b32 v6, 2, v6
  v_sub_u32 v5, v5, v6
  v_cmp_le_i32 s[64:65], 0, v5
  v_cmp_le_i32 s[66:67], 1, v5
  v_cmp_le_i32 s[68:69], 2, v5
  v_cmp_le_i32 s[70:71], 3, v5
  v_cmp_le_i32 s[72:73], 8, v5
  v_cmp_le_i32 s[74:75], 9, v5
  v_cmp_le_i32 s[76:77], 10, v5
  v_cmp_le_i32 s[78:79], 11, v5
  v_cmp_le_i32 s[80:81], 16, v5
  v_cmp_le_i32 s[82:83], 17, v5
  v_cmp_le_i32 s[84:85], 18, v5
  v_cmp_le_i32 s[86:87], 19, v5
  v_cmp_le_i32 s[88:89], 24, v5
  v_cmp_le_i32 s[90:91], 25, v5
  v_cmp_le_i32 s[98:99], 26, v5
  v_cmp_le_i32 s[100:101], 27, v5
  v_mov_b32 v6, 0xffff
  v_mov_b32 v7, 0xffff0000
  v_cndmask_b32 v24, 0, v6, s[64:65]
  v_cndmask_b32 v8, 0, v7, s[66:67]
  v_or_b32 v24, v24, v8
  v_cndmask_b32 v25, 0, v6, s[68:69]
  v_cndmask_b32 v8, 0, v7, s[70:71]
  v_or_b32 v25, v25, v8
  v_cndmask_b32 v26, 0, v6, s[72:73]
  v_cndmask_b32 v8, 0, v7, s[74:75]
  v_or_b32 v26, v26, v8
  v_cndmask_b32 v27, 0, v6, s[76:77]
  v_cndmask_b32 v8, 0, v7, s[78:79]
  v_or_b32 v27, v27, v8
  v_cndmask_b32 v28, 0, v6, s[80:81]
  v_cndmask_b32 v8, 0, v7, s[82:83]
  v_or_b32 v28, v28, v8
  v_cndmask_b32 v29, 0, v6, s[84:85]
  v_cndmask_b32 v8, 0, v7, s[86:87]
  v_or_b32 v29, v29, v8
  v_cndmask_b32 v30, 0, v6, s[88:89]
  v_cndmask_b32 v8, 0, v7, s[90:91]
  v_or_b32 v30, v30, v8
  v_cndmask_b32 v31, 0, v6, s[98:99]
  v_cndmask_b32 v8, 0, v7, s[100:101]
  v_or_b32 v31, v31, v8
  v_and_b32 v5, 31, v1
  v_lshrrev_b32 v6, 5, v1
  s_lshl_b32 s58, s52, 10
  v_lshl_add_u32 v5, v5, 4, s58
  v_lshl_add_u32 v252, v6, 13, v5
  v_mul_u32_u24 v7, 32960, v6
  v_add_u32 v246, v5, v7
  v_add_u32 v246, 16384, v246
  v_lshl_add_u32 v33, v6, 12, v5
  v_add_u32 v34, 8192, v5
  v_and_b32 v5, 1, v3
  v_and_b32 v7, 3, v1
  v_lshl_add_u32 v5, v5, 2, v7
  s_and_b32 s59, s54, 1
  v_add_u32 v7, s59, v5
  v_cmp_lt_u32 vcc, 4, v5
  s_nop 1
  v_cndmask_b32 v7, v7, 6, vcc
  v_lshrrev_b32 v8, 1, v7
  v_mul_u32_u24 v8, 8256, v8
  v_and_b32 v7, 1, v7
  v_lshl_add_u32 v8, v7, 3, v8
  v_lshrrev_b32 v7, 2, v2
  v_lshl_add_u32 v7, v6, 2, v7
  v_lshl_add_u32 v8, v7, 4, v8
  s_add_u32 s58, s58, 24576
  v_add_u32 v253, s58, v8
  s_mul_i32 s5, s53, 1310720
  s_lshl_b32 s58, s4, 12
  s_add_u32 s5, s5, s58
  s_and_b32 s58, s52, 1
  s_lshl_b32 s58, s58, 11
  s_add_u32 s58, s58, s5
  s_sub_u32 s59, s58, 1310720
  s_cmp_eq_u32 s53, 0
  s_cselect_b32 s59, 2147483648, s59
  s_cmp_lt_u32 s52, 2
  s_cselect_b32 s58, s59, s58
  v_and_b32 v5, 32, v1
  v_lshl_add_u32 v5, v5, 4, v4
  v_add_u32 v32, s58, v5
  s_lshl_b32 s58, s52, 11
  v_add_u32 v20, s58, v5
  s_lshl_b32 s58, s53, 1
  s_lshr_b32 s59, s52, 1
  s_add_u32 s59, s59, s58
  s_lshl_b32 s59, s59, 4
  s_add_u32 s58, s58, s52
  s_sub_u32 s58, s58, 2
  s_max_i32 s58, s58, 0
  s_lshl_b32 s58, s58, 4
  v_and_b32 v5, 1, v1
  v_lshl_add_u32 v5, v5, 1, s4
  v_lshrrev_b32 v5, 4, v5
  v_bfe_u32 v6, v1, 1, 1
  v_mul_u32_u24 v6, 5, v6
  v_add3_u32 v6, v6, v5, 5
  v_add_u32 v6, s58, v6
  v_add_u32 v5, s59, v5
  v_cmp_gt_u32 vcc, 4, v1
  s_nop 1
  v_cndmask_b32 v5, v5, v6, vcc
  v_lshlrev_b32 v35, 7, v5
  s_lshl_b32 s58, s52, 11
  v_add_u32 v36, s58, v4
  s_lshl_b32 s58, s53, 1
  s_add_u32 s58, s58, s52
  s_mov_b32 s59, 0x3f803f80
  s_cmp_lt_u32 s58, 2
  s_cselect_b32 s59, 0xf149f149, s59
  v_mov_b32 v8, s59
  v_mov_b32 v9, s59
  v_mov_b32 v10, s59
  v_mov_b32 v11, s59
  v_min_u32 v237, 4, v1
  v_lshlrev_b32 v237, 2, v237
  v_add_u32 v237, s52, v237
  v_add_u32 v237, 20, v237
  v_min_u32 v237, 113, v237
  v_lshlrev_b32 v237, 8, v237
  s_lshr_b32 s61, s57, 2
  s_lshl_b32 s61, s61, 7
  s_add_u32 s61, s61, 21004288
  v_add_u32 v237, s61, v237
  s_mov_b32 s48, 0
  s_nop 0
Lpoll_12:
  buffer_load_dword v240, v237, s[40:43], 0 offen sc1
  s_add_u32 s48, s48, 1
  s_cmp_gt_u32 s48, 0x40000
  s_cbranch_scc1 Lend
  s_waitcnt vmcnt(0)
  v_cmp_ne_u32 vcc, s3, v240
  s_nop 4
  s_cbranch_vccnz Lpoll_12
  s_lshl_b32 s58, s7, 7
  s_add_u32 s58, s58, 21200896
  v_mov_b32 v240, s3
  v_mov_b32 v241, s51
  v_mov_b32 v242, s3
  v_mov_b32 v243, s51
  s_mov_b64 exec, 0xff
  buffer_store_dwordx4 v[240:243], v4, s[40:43], s58 offen sc1
  s_mov_b64 exec, -1
  s_nop 0
  s_mul_i32 s46, s52, 40960
  s_add_u32 s46, s46, s63
  s_add_u32 s46, s46, 13926400
  s_add_u32 s47, s46, 0
  buffer_load_dwordx4 a[156:159], v4, s[40:43], s47 offen offset:0 sc1
  buffer_load_dwordx4 a[160:163], v4, s[40:43], s47 offen offset:1024 sc1
  buffer_load_dwordx4 a[164:167], v4, s[40:43], s47 offen offset:2048 sc1
  buffer_load_dwordx4 a[168:171], v4, s[40:43], s47 offen offset:3072 sc1
  s_add_u32 s47, s46, 4096
  buffer_load_dwordx4 a[172:175], v4, s[40:43], s47 offen offset:0 sc1
  s_movk_i32 s6, 255
Lg1_end:
  ds_write_b128 v36, v[8:11] offset:49344
  ds_write_b128 v36, v[8:11] offset:50368
  s_nop 0
  v_and_b32 v6, 31, v1
  v_lshrrev_b32 v7, 3, v6
  s_lshr_b32 s62, s53, 1
  s_lshl_b32 s62, s62, 2
  v_add_u32 v7, s62, v7
  v_and_b32 v6, 7, v6
  s_and_b32 s62, s53, 1
  s_lshl_b32 s62, s62, 3
  v_add_u32 v6, s62, v6
  v_cmp_eq_u32 vcc, 15, v6
  v_mad_u32_u24 v6, v7, 15, v6
  v_add_u32 v7, 240, v7
  v_cndmask_b32 v6, v6, v7, vcc
  v_lshlrev_b32 v6, 7, v6
  v_add_u32 v21, 21004288, v6
  buffer_load_dwordx2 v[18:19], v21, s[40:43], 0 offen sc1
  s_lshl_b32 s58, s54, 2
  s_add_u32 s58, s58, s52
  s_lshl_b32 s59, s53, 7
  s_add_u32 s59, s59, s58
  s_lshl_b32 s59, s59, 7
  s_add_u32 s59, s59, 28065792
  v_mov_b32 v5, s59
  s_add_u32 s59, s59, 131072
  v_writelane_b32 v5, s59, 1
  s_min_u32 s58, s58, 23
  s_lshr_b32 s59, s58, 2
  s_lshl_b32 s59, s59, 12
  s_and_b32 s58, s58, 3
  s_lshl_b32 s58, s58, 7
  s_add_u32 s59, s59, s58
  s_lshl_b32 s58, s53, 9
  s_add_u32 s59, s59, s58
  s_add_u32 s59, s59, 28348416
  v_writelane_b32 v5, s59, 2
  s_mov_b64 exec, 7
  buffer_load_dword v244, v5, s[40:43], 0 offen sc1
  s_mov_b64 exec, -1
  s_add_u32 s47, s46, 163840
  buffer_load_dwordx4 a[176:179], v4, s[40:43], s47 offen offset:0 sc1
  buffer_load_dwordx4 a[180:183], v4, s[40:43], s47 offen offset:1024 sc1
  buffer_load_dwordx4 a[184:187], v4, s[40:43], s47 offen offset:2048 sc1
  buffer_load_dwordx4 a[188:191], v4, s[40:43], s47 offen offset:3072 sc1
  s_add_u32 s47, s46, 167936
  buffer_load_dwordx4 a[192:195], v4, s[40:43], s47 offen offset:0 sc1
  s_add_u32 s47, s46, 327680
  buffer_load_dwordx4 a[196:199], v4, s[40:43], s47 offen offset:0 sc1
  buffer_load_dwordx4 a[200:203], v4, s[40:43], s47 offen offset:1024 sc1
  buffer_load_dwordx4 a[204:207], v4, s[40:43], s47 offen offset:2048 sc1
  buffer_load_dwordx4 a[208:211], v4, s[40:43], s47 offen offset:3072 sc1
  s_add_u32 s47, s46, 331776
  buffer_load_dwordx4 a[212:215], v4, s[40:43], s47 offen offset:0 sc1
  s_add_u32 s47, s46, 491520
  buffer_load_dwordx4 a[216:219], v4, s[40:43], s47 offen offset:0 sc1
  buffer_load_dwordx4 a[220:223], v4, s[40:43], s47 offen offset:1024 sc1
  buffer_load_dwordx4 a[224:227], v4, s[40:43], s47 offen offset:2048 sc1
  buffer_load_dwordx4 a[228:231], v4, s[40:43], s47 offen offset:3072 sc1
  s_add_u32 s47, s46, 495616
  buffer_load_dwordx4 a[232:235], v4, s[40:43], s47 offen offset:0 sc1
  s_add_u32 s47, s46, 655360
  buffer_load_dwordx4 a[236:239], v4, s[40:43], s47 offen offset:0 sc1
  buffer_load_dwordx4 a[240:243], v4, s[40:43], s47 offen offset:1024 sc1
  buffer_load_dwordx4 a[244:247], v4, s[40:43], s47 offen offset:2048 sc1
  buffer_load_dwordx4 a[248:251], v4, s[40:43], s47 offen offset:3072 sc1
  s_add_u32 s47, s46, 659456
  buffer_load_dwordx4 a[252:255], v4, s[40:43], s47 offen offset:0 sc1
  s_mov_b32 s58, 20971520
  s_mov_b32 s48, 0
Lpoll_13:
  buffer_load_dword v240, v35, s[40:43], s58 offen sc1
  s_add_u32 s48, s48, 1
  s_cmp_gt_u32 s48, 0x40000
  s_cbranch_scc1 Lend
  s_waitcnt vmcnt(0)
  v_cmp_ne_u32 vcc, s3, v240
  s_nop 4
  s_cbranch_vccnz Lpoll_13
  s_mov_b32 s60, 327680
  buffer_load_dwordx4 v[64:67], v32, s[40:43], s60 offen offset:0 sc1
  s_mov_b32 s60, 331776
  buffer_load_dwordx4 v[68:71], v32, s[40:43], s60 offen offset:0 sc1
  s_mov_b32 s60, 335872
  buffer_load_dwordx4 v[72:75], v32, s[40:43], s60 offen offset:0 sc1
  buffer_load_dwordx4 v[224:227], v33, s[40:43], s5 offen offset:0 sc1
  buffer_load_dwordx4 v[228:231], v34, s[40:43], s5 offen offset:0 sc1
  buffer_load_dwordx4 v[232:235], v33, s[40:43], s5 offen offset:512 sc1
  buffer_load_dwordx4 v[236:239], v34, s[40:43], s5 offen offset:512 sc1
  s_mov_b32 s60, 327680
  buffer_load_dwordx4 v[208:211], v32, s[40:43], s60 offen offset:512 sc1
  s_mov_b32 s60, 331776
  buffer_load_dwordx4 v[212:215], v32, s[40:43], s60 offen offset:512 sc1
  s_mov_b32 s60, 335872
  buffer_load_dwordx4 v[216:219], v32, s[40:43], s60 offen offset:512 sc1
  s_mov_b32 s60, 655360
  buffer_load_dwordx4 a[32:35], v32, s[40:43], s60 offen offset:0 sc1
  s_mov_b32 s60, 659456
  buffer_load_dwordx4 a[40:43], v32, s[40:43], s60 offen offset:0 sc1
  v_cmp_ne_u32 vcc, s3, v18
  s_nop 4
  s_cbranch_vccz Lgrp_ok
  s_mov_b32 s48, 0
Lpoll_14:
  buffer_load_dwordx2 v[240:241], v21, s[40:43], 0 offen sc1
  s_add_u32 s48, s48, 1
  s_cmp_gt_u32 s48, 0x40000
  s_cbranch_scc1 Lend
  s_waitcnt vmcnt(0)
  v_cmp_ne_u32 vcc, s3, v240
  s_nop 4
  s_cbranch_vccnz Lpoll_14
  v_mov_b32 v19, v241
  s_nop 1
Lgrp_ok:
  v_cmp_ne_u32 vcc, s51, v19
  s_nop 1
  s_cmp_eq_u64 vcc, 0
  s_cselect_b32 s55, 1, 0
  v_min_u32 v21, 4, v1
  v_lshlrev_b32 v21, 2, v21
  v_add_u32 v21, s52, v21
  v_add_u32 v21, 40, v21
  v_min_u32 v21, 113, v21
  v_lshlrev_b32 v21, 8, v21
  s_lshr_b32 s61, s57, 2
  s_lshl_b32 s61, s61, 7
  s_add_u32 s61, s61, 21004288
  v_add_u32 v21, s61, v21
  s_bfe_u32 s62, s54, 0x10003
  s_mul_i32 s62, s62, 27
  s_add_u32 s62, s62, s52
  s_add_u32 s62, s62, 60
  v_and_b32 v5, 7, v1
  v_min_u32 v5, 6, v5
  v_lshl_add_u32 v5, v5, 2, s62
  v_min_u32 v5, 113, v5
  v_lshl_add_u32 v5, v5, 8, s61
  v_cmp_lt_u32 vcc, 7, v1
  s_nop 1
  v_cndmask_b32 v21, v21, v5, vcc
  s_and_b32 s63, s54, 15
  s_mul_i32 s63, s63, 7
  s_min_u32 s63, s63, 101
  s_lshl_b32 s63, s63, 5
  s_mul_i32 s46, s52, 13824
  s_add_u32 s46, s46, s63
  s_mul_i32 s50, s52, 896
  v_mul_u32_u24 v5, 147, v1
  v_lshrrev_b32 v5, 11, v5
  v_mul_u32_u24 v5, 3232, v5
  v_add_u32 v22, v5, v4
  v_accvgpr_read_b32 v8, a0
  v_accvgpr_read_b32 v9, a1
  v_accvgpr_read_b32 v10, a2
  v_accvgpr_read_b32 v11, a3
  v_accvgpr_read_b32 v12, a4
  v_accvgpr_read_b32 v13, a5
  v_accvgpr_read_b32 v14, a6
  v_accvgpr_read_b32 v15, a7
  v_accvgpr_read_b32 v16, a8
  v_accvgpr_read_b32 v17, a9
  s_waitcnt vmcnt(11)
  ds_write_b128 v20, v[64:67] offset:0
  s_waitcnt vmcnt(10)
  ds_write_b128 v20, v[68:71] offset:8192
  s_waitcnt vmcnt(9)
  ds_write_b128 v20, v[72:75] offset:16384
  s_waitcnt vmcnt(5)
  s_mov_b32 exec_lo, 0
  v_mov_b32 v228, 0x3f80
  v_mov_b32 v229, 0
  v_mov_b32 v230, 0
  v_mov_b32 v231, 0
  v_mov_b32 v236, 0x3f80
  v_mov_b32 v237, 0
  v_mov_b32 v238, 0
  v_mov_b32 v239, 0
  s_and_b32 s58, s54, 1
  s_cmp_eq_u32 s58, 0
  s_cselect_b32 s94, -1, 0
  s_mov_b32 s95, 0
  s_mov_b64 exec, s[94:95]
  v_mov_b32 v230, 0
  v_mov_b32 v231, 0
  v_mov_b32 v238, 0
  v_mov_b32 v239, 0
  s_not_b32 s94, s94
  s_mov_b64 exec, s[94:95]
  v_mov_b32 v224, 0
  v_mov_b32 v225, 0
  v_mov_b32 v232, 0
  v_mov_b32 v233, 0
  s_mov_b64 exec, -1
  s_mov_b32 s60, 663552
  buffer_load_dwordx4 a[48:51], v32, s[40:43], s60 offen offset:0 sc1
  s_mov_b32 s60, 655360
  buffer_load_dwordx4 a[36:39], v32, s[40:43], s60 offen offset:512 sc1
  s_mov_b32 s60, 659456
  buffer_load_dwordx4 a[44:47], v32, s[40:43], s60 offen offset:512 sc1
  s_mov_b32 s60, 663552
  buffer_load_dwordx4 a[52:55], v32, s[40:43], s60 offen offset:512 sc1
  s_waitcnt lgkmcnt(0)
  s_barrier
  ds_read_b128 a[0:3], v252 offset:0
  ds_read_b128 a[4:7], v246 offset:0
  ds_read_b128 a[8:11], v252 offset:4096
  ds_read_b128 a[12:15], v246 offset:4096
  ds_read_b128 a[16:19], v252 offset:1024
  ds_read_b128 a[20:23], v246 offset:1024
  ds_read_b128 a[24:27], v252 offset:2048
  ds_read_b128 a[28:31], v246 offset:2048
  s_waitcnt lgkmcnt(6)
  v_mfma_f32_32x32x16_bf16 v[64:79], a[0:3], v[224:227], 0
  v_mfma_f32_32x32x16_bf16 v[64:79], a[4:7], v[228:231], v[64:79]
  ds_read_b128 a[0:3], v252 offset:3072
  ds_read_b128 a[4:7], v246 offset:3072
  s_waitcnt lgkmcnt(6)
  v_mfma_f32_32x32x16_bf16 v[80:95], a[8:11], v[224:227], 0
  v_mfma_f32_32x32x16_bf16 v[80:95], a[12:15], v[228:231], v[80:95]
  v_mfma_f32_32x32x16_bf16 v[96:111], a[8:11], v[232:235], 0
  v_mfma_f32_32x32x16_bf16 v[96:111], a[12:15], v[236:239], v[96:111]
  s_nop 9
  v_cndmask_b32 v80, v64, v80, s[64:65]
  v_cndmask_b32 v81, v65, v81, s[66:67]
  v_cndmask_b32 v82, v66, v82, s[68:69]
  v_cndmask_b32 v83, v67, v83, s[70:71]
  v_cndmask_b32 v84, v68, v84, s[72:73]
  v_cndmask_b32 v85, v69, v85, s[74:75]
  v_cndmask_b32 v86, v70, v86, s[76:77]
  v_cndmask_b32 v87, v71, v87, s[78:79]
  v_cndmask_b32 v88, v72, v88, s[80:81]
  v_cndmask_b32 v89, v73, v89, s[82:83]
  v_cndmask_b32 v90, v74, v90, s[84:85]
  v_cndmask_b32 v91, v75, v91, s[86:87]
  v_cndmask_b32 v92, v76, v92, s[88:89]
  v_cndmask_b32 v93, v77, v93, s[90:91]
  v_cndmask_b32 v94, v78, v94, s[98:99]
  v_cndmask_b32 v95, v79, v95, s[100:101]
  v_exp_f32 v80, v80
  s_waitcnt lgkmcnt(4)
  v_mfma_f32_32x32x16_bf16 v[112:127], a[16:19], v[224:227], 0
  buffer_load_dword v23, v21, s[40:43], 0 offen sc1
  s_add_u32 m0, s50, 61440
  s_add_u32 s47, s46, 0
  buffer_load_dwordx4 v22, s[28:31], s47 offen lds
  v_exp_f32 v81, v81
  v_exp_f32 v82, v82
  v_exp_f32 v83, v83
  v_exp_f32 v84, v84
  v_exp_f32 v85, v85
  v_exp_f32 v86, v86
  v_exp_f32 v87, v87
  v_exp_f32 v88, v88
  v_exp_f32 v89, v89
  v_exp_f32 v90, v90
  v_exp_f32 v91, v91
  v_exp_f32 v92, v92
  v_exp_f32 v93, v93
  v_exp_f32 v94, v94
  v_exp_f32 v95, v95
  v_cvt_pk_bf16_f32 v160, v80, v81
  v_cvt_pk_bf16_f32 v161, v82, v83
  v_cvt_pk_bf16_f32 v162, v84, v85
  v_cvt_pk_bf16_f32 v163, v86, v87
  v_cvt_pk_bf16_f32 v164, v88, v89
  v_cvt_pk_bf16_f32 v165, v90, v91
  v_mfma_f32_32x32x16_bf16 v[112:127], a[20:23], v[228:231], v[112:127]
  v_cvt_pk_bf16_f32 v166, v92, v93
  v_cvt_pk_bf16_f32 v167, v94, v95
  v_bfi_b32 v168, v24, 0, v160
  v_bfi_b32 v169, v25, 0, v161
  v_bfi_b32 v170, v26, 0, v162
  v_bfi_b32 v171, v27, 0, v163
  v_bfi_b32 v172, v28, 0, v164
  v_bfi_b32 v173, v29, 0, v165
  v_bfi_b32 v174, v30, 0, v166
  v_bfi_b32 v175, v31, 0, v167
  v_and_b32 v160, v24, v160
  v_and_b32 v161, v25, v161
  v_and_b32 v162, v26, v162
  v_and_b32 v163, v27, v163
  v_and_b32 v164, v28, v164
  v_and_b32 v165, v29, v165
  v_and_b32 v166, v30, v166
  v_and_b32 v167, v31, v167
  v_exp_f32 v96, v96
  v_exp_f32 v97, v97
  v_exp_f32 v98, v98
  v_exp_f32 v99, v99
  v_exp_f32 v100, v100
  v_mfma_f32_32x32x16_bf16 v[128:143], a[16:19], v[232:235], 0
  s_add_u32 m0, s50, 65024
  s_add_u32 s47, s46, 55296
  buffer_load_dwordx4 v22, s[28:31], s47 offen lds
  v_exp_f32 v101, v101
  v_exp_f32 v102, v102
  v_exp_f32 v103, v103
  v_exp_f32 v104, v104
  v_exp_f32 v105, v105
  v_exp_f32 v106, v106
  v_exp_f32 v107, v107
  v_exp_f32 v108, v108
  v_exp_f32 v109, v109
  v_exp_f32 v110, v110
  v_mfma_f32_32x32x16_bf16 v[128:143], a[20:23], v[236:239], v[128:143]
  s_add_u32 m0, s50, 68608
  s_add_u32 s47, s46, 110592
  buffer_load_dwordx4 v22, s[28:31], s47 offen lds
  v_exp_f32 v111, v111
  v_cvt_pk_bf16_f32 v176, v96, v97
  v_cvt_pk_bf16_f32 v177, v98, v99
  v_cvt_pk_bf16_f32 v178, v100, v101
  v_cvt_pk_bf16_f32 v179, v102, v103
  v_cvt_pk_bf16_f32 v180, v104, v105
  v_cvt_pk_bf16_f32 v181, v106, v107
  v_cvt_pk_bf16_f32 v182, v108, v109
  v_cvt_pk_bf16_f32 v183, v110, v111
  v_exp_f32 v112, v112
  v_exp_f32 v113, v113
  v_exp_f32 v114, v114
  v_exp_f32 v115, v115
  v_exp_f32 v116, v116
  s_waitcnt lgkmcnt(2)
  v_mfma_f32_32x32x16_bf16 v[144:159], a[24:27], v[224:227], 0
  v_exp_f32 v117, v117
  v_exp_f32 v118, v118
  v_exp_f32 v119, v119
  v_exp_f32 v120, v120
  v_exp_f32 v121, v121
  v_exp_f32 v122, v122
  v_exp_f32 v123, v123
  v_exp_f32 v124, v124
  v_exp_f32 v125, v125
  v_exp_f32 v126, v126
  v_mfma_f32_32x32x16_bf16 v[144:159], a[28:31], v[228:231], v[144:159]
  s_add_u32 m0, s50, 72192
  s_add_u32 s47, s46, 165888
  buffer_load_dwordx4 v22, s[28:31], s47 offen lds
  v_exp_f32 v127, v127
  v_cvt_pk_bf16_f32 v184, v112, v113
  v_cvt_pk_bf16_f32 v185, v114, v115
  v_cvt_pk_bf16_f32 v186, v116, v117
  v_cvt_pk_bf16_f32 v187, v118, v119
  v_cvt_pk_bf16_f32 v188, v120, v121
  v_cvt_pk_bf16_f32 v189, v122, v123
  v_cvt_pk_bf16_f32 v190, v124, v125
  v_cvt_pk_bf16_f32 v191, v126, v127
  v_exp_f32 v128, v128
  v_exp_f32 v129, v129
  v_exp_f32 v130, v130
  v_exp_f32 v131, v131
  v_exp_f32 v132, v132
  v_mfma_f32_32x32x16_bf16 v[64:79], a[24:27], v[232:235], 0
  s_add_u32 m0, s50, 75776
  s_add_u32 s47, s46, 221184
  buffer_load_dwordx4 v22, s[28:31], s47 offen lds
  v_exp_f32 v133, v133
  v_exp_f32 v134, v134
  v_exp_f32 v135, v135
  v_exp_f32 v136, v136
  v_exp_f32 v137, v137
  v_exp_f32 v138, v138
  v_exp_f32 v139, v139
  v_exp_f32 v140, v140
  v_exp_f32 v141, v141
  v_exp_f32 v142, v142
  v_mfma_f32_32x32x16_bf16 v[64:79], a[28:31], v[236:239], v[64:79]
  v_exp_f32 v143, v143
  v_cvt_pk_bf16_f32 v192, v128, v129
  v_cvt_pk_bf16_f32 v193, v130, v131
  v_cvt_pk_bf16_f32 v194, v132, v133
  v_cvt_pk_bf16_f32 v195, v134, v135
  v_cvt_pk_bf16_f32 v196, v136, v137
  v_cvt_pk_bf16_f32 v197, v138, v139
  v_cvt_pk_bf16_f32 v198, v140, v141
  v_cvt_pk_bf16_f32 v199, v142, v143
  s_waitcnt vmcnt(14)
  ds_write_b128 v20, v[208:211] offset:512
  s_waitcnt vmcnt(13)
  ds_write_b128 v20, v[212:215] offset:8704
  s_waitcnt vmcnt(12)
  ds_write_b128 v20, v[216:219] offset:16896
  s_waitcnt vmcnt(11)
  ds_write_b128 v20, a[32:35] offset:24576
  s_waitcnt vmcnt(10)
  ds_write_b128 v20, a[40:43] offset:32832
  s_waitcnt vmcnt(9)
  ds_write_b128 v20, a[48:51] offset:41088
  s_waitcnt vmcnt(8)
  ds_write_b128 v20, a[36:39] offset:25088
  s_waitcnt vmcnt(7)
  ds_write_b128 v20, a[44:47] offset:33344
  s_waitcnt vmcnt(6)
  ds_write_b128 v20, a[52:55] offset:41600
  v_exp_f32 v144, v144
  v_exp_f32 v145, v145
  v_exp_f32 v146, v146
  v_exp_f32 v147, v147
  v_exp_f32 v148, v148
  s_waitcnt lgkmcnt(9)
  v_mfma_f32_32x32x16_bf16 v[80:95], a[0:3], v[224:227], 0
  s_add_u32 m0, s50, 79360
  s_add_u32 s47, s46, 276480
  buffer_load_dwordx4 v22, s[28:31], s47 offen lds
  v_exp_f32 v149, v149
  v_exp_f32 v150, v150
  v_exp_f32 v151, v151
  v_exp_f32 v152, v152
  v_exp_f32 v153, v153
  v_exp_f32 v154, v154
  v_exp_f32 v155, v155
  v_exp_f32 v156, v156
  v_exp_f32 v157, v157
  v_exp_f32 v158, v158
  v_mfma_f32_32x32x16_bf16 v[80:95], a[4:7], v[228:231], v[80:95]
  s_add_u32 m0, s50, 82944
  s_add_u32 s47, s46, 331776
  buffer_load_dwordx4 v22, s[28:31], s47 offen lds
  v_exp_f32 v159, v159
  v_cvt_pk_bf16_f32 v200, v144, v145
  v_cvt_pk_bf16_f32 v201, v146, v147
  v_cvt_pk_bf16_f32 v202, v148, v149
  v_cvt_pk_bf16_f32 v203, v150, v151
  v_cvt_pk_bf16_f32 v204, v152, v153
  v_cvt_pk_bf16_f32 v205, v154, v155
  v_cvt_pk_bf16_f32 v206, v156, v157
  v_cvt_pk_bf16_f32 v207, v158, v159
  s_waitcnt lgkmcnt(0)
  s_barrier
  s_lshl_b32 s58, s2, 7
  s_add_u32 s58, s58, 21037056
  s_cmp_lg_u32 s52, 0
  s_cbranch_scc1 Lfk
  v_mov_b32 v240, s3
  v_mov_b32 v241, s51
  v_mov_b32 v242, s3
  v_mov_b32 v243, s51
  s_mov_b64 exec, 0xff
  buffer_store_dwordx4 v[240:243], v4, s[40:43], s58 offen sc1
  s_mov_b64 exec, -1
  s_nop 0
Lfk:
  ds_read_b128 a[8:11], v252 offset:4608
  ds_read_b128 a[12:15], v246 offset:4608
  ds_read_b128 a[16:19], v252 offset:512
  ds_read_b128 a[20:23], v246 offset:512
  ds_read_b128 a[24:27], v252 offset:1536
  ds_read_b128 a[28:31], v246 offset:1536
  v_exp_f32 v64, v64
  v_exp_f32 v65, v65
  v_exp_f32 v66, v66
  v_exp_f32 v67, v67
  v_exp_f32 v68, v68
  v_mfma_f32_32x32x16_bf16 v[96:111], a[0:3], v[232:235], 0
  ds_read_b64_tr_b16 a[32:33], v253 offset:0
  v_exp_f32 v69, v69
  v_exp_f32 v70, v70
  v_exp_f32 v71, v71
  v_exp_f32 v72, v72
  v_exp_f32 v73, v73
  v_exp_f32 v74, v74
  v_exp_f32 v75, v75
  v_exp_f32 v76, v76
  v_exp_f32 v77, v77
  v_exp_f32 v78, v78
  v_mfma_f32_32x32x16_bf16 v[96:111], a[4:7], v[236:239], v[96:111]
  ds_read_b128 a[0:3], v252 offset:2560
  ds_read_b128 a[4:7], v246 offset:2560
  ds_read_b64_tr_b16 a[34:35], v253 offset:128
  v_exp_f32 v79, v79
  v_cvt_pk_bf16_f32 v208, v64, v65
  v_cvt_pk_bf16_f32 v209, v66, v67
  v_cvt_pk_bf16_f32 v210, v68, v69
  v_cvt_pk_bf16_f32 v211, v70, v71
  v_cvt_pk_bf16_f32 v212, v72, v73
  v_cvt_pk_bf16_f32 v213, v74, v75
  v_cvt_pk_bf16_f32 v214, v76, v77
  v_cvt_pk_bf16_f32 v215, v78, v79
  v_exp_f32 v80, v80
  v_exp_f32 v81, v81
  s_waitcnt lgkmcnt(6)
  v_mfma_f32_32x32x16_bf16 v[112:127], a[16:19], v[232:235], 0
  s_add_u32 m0, s50, 86528
  s_add_u32 s47, s46, 387072
  buffer_load_dwordx4 v22, s[28:31], s47 offen lds
  ds_read_b64_tr_b16 a[36:37], v253 offset:256
  v_exp_f32 v82, v82
  v_exp_f32 v83, v83
  ds_read_b64_tr_b16 a[38:39], v253 offset:384
  s_waitcnt lgkmcnt(0)
  v_mfma_f32_32x32x16_bf16 v[32:47], a[32:35], v[168:171], 0
  ds_read_b64_tr_b16 a[40:41], v253 offset:4096
  v_exp_f32 v84, v84
  v_exp_f32 v85, v85
  v_exp_f32 v86, v86
  v_mfma_f32_32x32x16_bf16 v[112:127], a[20:23], v[236:239], v[112:127]
  ds_read_b64_tr_b16 a[42:43], v253 offset:4224
  v_exp_f32 v87, v87
  v_exp_f32 v88, v88
  v_mfma_f32_32x32x16_bf16 v[32:47], a[36:39], v[172:175], v[32:47]
  s_add_u32 m0, s50, 90112
  s_add_u32 s47, s46, 442368
  buffer_load_dwordx4 v22, s[28:31], s47 offen lds
  ds_read_b64_tr_b16 a[44:45], v253 offset:4352
  v_exp_f32 v89, v89
  v_exp_f32 v90, v90
  v_exp_f32 v91, v91
  v_mfma_f32_32x32x16_bf16 v[128:143], a[8:11], v[232:235], 0
  ds_read_b64_tr_b16 a[46:47], v253 offset:4480
  v_exp_f32 v92, v92
  v_exp_f32 v93, v93
  s_waitcnt lgkmcnt(0)
  v_mfma_f32_32x32x16_bf16 v[32:47], a[40:43], v[160:163], v[32:47]
  ds_read_b64_tr_b16 a[48:49], v253 offset:1024
  v_exp_f32 v94, v94
  v_exp_f32 v95, v95
  v_cvt_pk_bf16_f32 v216, v80, v81
  v_mfma_f32_32x32x16_bf16 v[128:143], a[12:15], v[236:239], v[128:143]
  ds_read_b128 a[8:11], v252 offset:3584
  ds_read_b128 a[12:15], v246 offset:3584
  s_add_u32 m0, s50, 93696
  s_add_u32 s47, s46, 497664
  buffer_load_dwordx4 v22, s[28:31], s47 offen lds
  ds_read_b64_tr_b16 a[50:51], v253 offset:1152
  v_cvt_pk_bf16_f32 v217, v82, v83
  v_cvt_pk_bf16_f32 v218, v84, v85
  v_cvt_pk_bf16_f32 v219, v86, v87
  v_cvt_pk_bf16_f32 v220, v88, v89
  v_cvt_pk_bf16_f32 v221, v90, v91
  v_mfma_f32_32x32x16_bf16 v[32:47], a[44:47], v[164:167], v[32:47]
  ds_read_b64_tr_b16 a[52:53], v253 offset:1280
  v_cvt_pk_bf16_f32 v222, v92, v93
  v_cvt_pk_bf16_f32 v223, v94, v95
  v_exp_f32 v96, v96
  v_exp_f32 v97, v97
  v_mfma_f32_32x32x16_bf16 v[144:159], a[16:19], v[224:227], 0
  ds_read_b64_tr_b16 a[54:55], v253 offset:1408
  v_exp_f32 v98, v98
  v_exp_f32 v99, v99
  v_exp_f32 v100, v100
  v_mfma_f32_32x32x16_bf16 v[48:63], a[40:43], v[176:179], 0
  s_add_u32 m0, s50, 97280
  s_add_u32 s47, s46, 552960
  buffer_load_dwordx4 v22, s[28:31], s47 offen lds
  ds_read_b64_tr_b16 a[32:33], v253 offset:2048
  v_exp_f32 v101, v101
  v_exp_f32 v102, v102
  v_exp_f32 v103, v103
  v_exp_f32 v104, v104
  v_mfma_f32_32x32x16_bf16 v[48:63], a[44:47], v[180:183], v[48:63]
  ds_read_b64_tr_b16 a[34:35], v253 offset:2176
  v_exp_f32 v105, v105
  v_exp_f32 v106, v106
  v_exp_f32 v107, v107
  v_mfma_f32_32x32x16_bf16 v[144:159], a[20:23], v[228:231], v[144:159]
  ds_read_b64_tr_b16 a[36:37], v253 offset:2304
  v_exp_f32 v108, v108
  v_exp_f32 v109, v109
  v_exp_f32 v110, v110
  s_waitcnt lgkmcnt(3)
  v_mfma_f32_32x32x16_bf16 v[32:47], a[48:51], v[184:187], v[32:47]
  s_add_u32 m0, s50, 100864
  s_add_u32 s47, s46, 608256
  buffer_load_dwordx4 v22, s[28:31], s47 offen lds
  ds_read_b64_tr_b16 a[38:39], v253 offset:2432
  v_exp_f32 v111, v111
  v_cvt_pk_bf16_f32 v160, v96, v97
  v_cvt_pk_bf16_f32 v161, v98, v99
  v_cvt_pk_bf16_f32 v162, v100, v101
  v_cvt_pk_bf16_f32 v163, v102, v103
  v_cvt_pk_bf16_f32 v164, v104, v105
  v_mfma_f32_32x32x16_bf16 v[32:47], a[52:55], v[188:191], v[32:47]
  ds_read_b64_tr_b16 a[40:41], v253 offset:3072
  v_cvt_pk_bf16_f32 v165, v106, v107
  v_cvt_pk_bf16_f32 v166, v108, v109
  v_cvt_pk_bf16_f32 v167, v110, v111
  v_cndmask_b32 v128, v112, v128, s[64:65]
  v_cndmask_b32 v129, v113, v129, s[66:67]
  v_cndmask_b32 v130, v114, v130, s[68:69]
  v_cndmask_b32 v131, v115, v131, s[70:71]
  v_cndmask_b32 v132, v116, v132, s[72:73]
  v_cndmask_b32 v133, v117, v133, s[74:75]
  v_mfma_f32_32x32x16_bf16 v[64:79], a[24:27], v[224:227], 0
  ds_read_b64_tr_b16 a[42:43], v253 offset:3200
  v_cndmask_b32 v134, v118, v134, s[76:77]
  v_cndmask_b32 v135, v119, v135, s[78:79]
  v_cndmask_b32 v136, v120, v136, s[80:81]
  v_cndmask_b32 v137, v121, v137, s[82:83]
  v_cndmask_b32 v138, v122, v138, s[84:85]
  v_cndmask_b32 v139, v123, v139, s[86:87]
  v_cndmask_b32 v140, v124, v140, s[88:89]
  v_cndmask_b32 v141, v125, v141, s[90:91]
  v_cndmask_b32 v142, v126, v142, s[98:99]
  v_cndmask_b32 v143, v127, v143, s[100:101]
  v_exp_f32 v128, v128
  v_mfma_f32_32x32x16_bf16 v[48:63], a[48:51], v[192:195], v[48:63]
  s_add_u32 m0, s50, 104448
  s_add_u32 s47, s46, 663552
  buffer_load_dwordx4 v22, s[28:31], s47 offen lds
  ds_read_b64_tr_b16 a[44:45], v253 offset:3328
  v_exp_f32 v129, v129
  v_exp_f32 v130, v130
  v_exp_f32 v131, v131
  v_exp_f32 v132, v132
  v_exp_f32 v133, v133
  v_exp_f32 v134, v134
  v_mfma_f32_32x32x16_bf16 v[48:63], a[52:55], v[196:199], v[48:63]
  ds_read_b64_tr_b16 a[46:47], v253 offset:3456
  v_exp_f32 v135, v135
  v_exp_f32 v136, v136
  v_exp_f32 v137, v137
  v_exp_f32 v138, v138
  v_exp_f32 v139, v139
  v_exp_f32 v140, v140
  v_mfma_f32_32x32x16_bf16 v[64:79], a[28:31], v[228:231], v[64:79]
  ds_read_b64_tr_b16 a[48:49], v253 offset:4608
  v_exp_f32 v141, v141
  v_exp_f32 v142, v142
  v_exp_f32 v143, v143
  v_cvt_pk_bf16_f32 v168, v128, v129
  v_cvt_pk_bf16_f32 v169, v130, v131
  v_cvt_pk_bf16_f32 v170, v132, v133
  v_cvt_pk_bf16_f32 v171, v134, v135
  v_cvt_pk_bf16_f32 v172, v136, v137
  v_cvt_pk_bf16_f32 v173, v138, v139
  s_waitcnt lgkmcnt(5)
  v_mfma_f32_32x32x16_bf16 v[32:47], a[32:35], v[200:203], v[32:47]
  s_add_u32 m0, s50, 108032
  s_add_u32 s47, s46, 718848
  buffer_load_dwordx4 v22, s[28:31], s47 offen lds
  ds_read_b64_tr_b16 a[50:51], v253 offset:4736
  v_cvt_pk_bf16_f32 v174, v140, v141
  v_cvt_pk_bf16_f32 v175, v142, v143
  v_bfi_b32 v176, v24, 0, v168
  v_bfi_b32 v177, v25, 0, v169
  v_bfi_b32 v178, v26, 0, v170
  v_bfi_b32 v179, v27, 0, v171
  v_bfi_b32 v180, v28, 0, v172
  v_bfi_b32 v181, v29, 0, v173
  v_bfi_b32 v182, v30, 0, v174
  v_bfi_b32 v183, v31, 0, v175
  v_and_b32 v168, v24, v168
  v_and_b32 v169, v25, v169
  v_mfma_f32_32x32x16_bf16 v[32:47], a[36:39], v[204:207], v[32:47]
  ds_read_b64_tr_b16 a[52:53], v253 offset:4864
  v_and_b32 v170, v26, v170
  v_and_b32 v171, v27, v171
  v_and_b32 v172, v28, v172
  v_and_b32 v173, v29, v173
  v_and_b32 v174, v30, v174
  v_and_b32 v175, v31, v175
  v_exp_f32 v144, v144
  v_exp_f32 v145, v145
  v_mfma_f32_32x32x16_bf16 v[80:95], a[24:27], v[232:235], 0
  ds_read_b64_tr_b16 a[54:55], v253 offset:4992
  v_exp_f32 v146, v146
  v_exp_f32 v147, v147
  v_exp_f32 v148, v148
  v_mfma_f32_32x32x16_bf16 v[48:63], a[32:35], v[208:211], v[48:63]
  s_add_u32 m0, s50, 111616
  s_add_u32 s47, s46, 774144
  buffer_load_dwordx4 v22, s[28:31], s47 offen lds
  v_exp_f32 v149, v149
  v_exp_f32 v150, v150
  v_exp_f32 v151, v151
  v_exp_f32 v152, v152
  v_mfma_f32_32x32x16_bf16 v[48:63], a[36:39], v[212:215], v[48:63]
  ds_read_b64_tr_b16 a[32:33], v253 offset:512
  v_exp_f32 v153, v153
  v_exp_f32 v154, v154
  v_exp_f32 v155, v155
  v_mfma_f32_32x32x16_bf16 v[80:95], a[28:31], v[236:239], v[80:95]
  s_add_u32 m0, s50, 115200
  s_add_u32 s47, s46, 829440
  buffer_load_dwordx4 v22, s[28:31], s47 offen lds
  ds_read_b64_tr_b16 a[34:35], v253 offset:640
  v_exp_f32 v156, v156
  v_exp_f32 v157, v157
  v_exp_f32 v158, v158
  s_waitcnt lgkmcnt(6)
  v_mfma_f32_32x32x16_bf16 v[32:47], a[40:43], v[216:219], v[32:47]
  ds_read_b64_tr_b16 a[36:37], v253 offset:768
  v_exp_f32 v159, v159
  v_cvt_pk_bf16_f32 v184, v144, v145
  v_cvt_pk_bf16_f32 v185, v146, v147
  v_cvt_pk_bf16_f32 v186, v148, v149
  v_cvt_pk_bf16_f32 v187, v150, v151
  v_cvt_pk_bf16_f32 v188, v152, v153
  v_mfma_f32_32x32x16_bf16 v[32:47], a[44:47], v[220:223], v[32:47]
  ds_read_b64_tr_b16 a[38:39], v253 offset:896
  v_cvt_pk_bf16_f32 v189, v154, v155
  v_cvt_pk_bf16_f32 v190, v156, v157
  v_cvt_pk_bf16_f32 v191, v158, v159
  v_exp_f32 v64, v64
  v_exp_f32 v65, v65
  v_mfma_f32_32x32x16_bf16 v[96:111], a[0:3], v[224:227], 0
  s_add_u32 m0, s50, 118784
  s_add_u32 s47, s46, 884736
  buffer_load_dwordx4 v22, s[28:31], s47 offen lds
  v_exp_f32 v66, v66
  v_exp_f32 v67, v67
  v_mfma_f32_32x32x16_bf16 v[48:63], a[40:43], v[160:163], v[48:63]
  s_add_u32 m0, s50, 122368
  s_add_u32 s47, s46, 940032
  buffer_load_dwordx4 v22, s[28:31], s47 offen lds
  v_exp_f32 v68, v68
  v_exp_f32 v69, v69
  v_exp_f32 v70, v70
  v_mfma_f32_32x32x16_bf16 v[48:63], a[44:47], v[164:167], v[48:63]
  ds_read_b64_tr_b16 a[40:41], v253 offset:1536
  v_exp_f32 v71, v71
  v_exp_f32 v72, v72
  s_waitcnt lgkmcnt(1)
  v_mfma_f32_32x32x16_bf16 v[48:63], a[32:35], v[176:179], v[48:63]
  ds_read_b64_tr_b16 a[42:43], v253 offset:1664
  v_exp_f32 v73, v73
  v_exp_f32 v74, v74
  v_exp_f32 v75, v75
  v_mfma_f32_32x32x16_bf16 v[96:111], a[4:7], v[228:231], v[96:111]
  s_add_u32 m0, s50, 125952
  s_add_u32 s47, s46, 995328
  buffer_load_dwordx4 v22, s[28:31], s47 offen lds
  ds_read_b64_tr_b16 a[44:45], v253 offset:1792
  v_exp_f32 v76, v76
  v_exp_f32 v77, v77
  v_mfma_f32_32x32x16_bf16 v[48:63], a[36:39], v[180:183], v[48:63]
  ds_read_b64_tr_b16 a[46:47], v253 offset:1920
  v_exp_f32 v78, v78
  v_exp_f32 v79, v79
  v_cvt_pk_bf16_f32 v192, v64, v65
  v_mfma_f32_32x32x16_bf16 v[48:63], a[48:51], v[168:171], v[48:63]
  s_add_u32 m0, s50, 129536
  s_add_u32 s47, s46, 1050624
  buffer_load_dwordx4 v22, s[28:31], s47 offen lds
  v_cvt_pk_bf16_f32 v193, v66, v67
  v_cvt_pk_bf16_f32 v194, v68, v69
  v_cvt_pk_bf16_f32 v195, v70, v71
  v_cvt_pk_bf16_f32 v196, v72, v73
  v_cvt_pk_bf16_f32 v197, v74, v75
  v_mfma_f32_32x32x16_bf16 v[48:63], a[52:55], v[172:175], v[48:63]
  ds_read_b64_tr_b16 a[48:49], v253 offset:2560
  v_cvt_pk_bf16_f32 v198, v76, v77
  v_cvt_pk_bf16_f32 v199, v78, v79
  v_exp_f32 v80, v80
  v_exp_f32 v81, v81
  v_mfma_f32_32x32x16_bf16 v[112:127], a[0:3], v[232:235], 0
  ds_read_b64_tr_b16 a[50:51], v253 offset:2688
  v_exp_f32 v82, v82
  v_exp_f32 v83, v83
  v_exp_f32 v84, v84
  v_mfma_f32_32x32x16_bf16 v[32:47], a[32:35], v[184:187], v[32:47]
  s_add_u32 m0, s50, 133120
  s_add_u32 s47, s46, 1105920
  buffer_load_dwordx4 v22, s[28:31], s47 offen lds
  ds_read_b64_tr_b16 a[52:53], v253 offset:2816
  v_exp_f32 v85, v85
  v_exp_f32 v86, v86
  v_exp_f32 v87, v87
  v_exp_f32 v88, v88
  v_mfma_f32_32x32x16_bf16 v[32:47], a[36:39], v[188:191], v[32:47]
  ds_read_b64_tr_b16 a[54:55], v253 offset:2944
  v_exp_f32 v89, v89
  v_exp_f32 v90, v90
  v_exp_f32 v91, v91
  v_mfma_f32_32x32x16_bf16 v[112:127], a[4:7], v[236:239], v[112:127]
  ds_read_b64_tr_b16 a[32:33], v253 offset:3584
  v_exp_f32 v92, v92
  v_exp_f32 v93, v93
  v_exp_f32 v94, v94
  s_waitcnt lgkmcnt(5)
  v_mfma_f32_32x32x16_bf16 v[32:47], a[40:43], v[192:195], v[32:47]
  s_add_u32 m0, s50, 136704
  s_add_u32 s47, s46, 1161216
  buffer_load_dwordx4 v22, s[28:31], s47 offen lds
  ds_read_b64_tr_b16 a[34:35], v253 offset:3712
  v_exp_f32 v95, v95
  v_cvt_pk_bf16_f32 v200, v80, v81
  v_cvt_pk_bf16_f32 v201, v82, v83
  v_cvt_pk_bf16_f32 v202, v84, v85
  v_cvt_pk_bf16_f32 v203, v86, v87
  v_cvt_pk_bf16_f32 v204, v88, v89
  v_mfma_f32_32x32x16_bf16 v[32:47], a[44:47], v[196:199], v[32:47]
  ds_read_b64_tr_b16 a[36:37], v253 offset:3840
  v_cvt_pk_bf16_f32 v205, v90, v91
  v_cvt_pk_bf16_f32 v206, v92, v93
  v_cvt_pk_bf16_f32 v207, v94, v95
  v_exp_f32 v96, v96
  v_exp_f32 v97, v97
  v_exp_f32 v98, v98
  v_mfma_f32_32x32x16_bf16 v[128:143], a[8:11], v[224:227], 0
  ds_read_b64_tr_b16 a[38:39], v253 offset:3968
  v_exp_f32 v99, v99
  v_exp_f32 v100, v100
  v_exp_f32 v101, v101
  v_exp_f32 v102, v102
  v_exp_f32 v103, v103
  v_mfma_f32_32x32x16_bf16 v[48:63], a[40:43], v[200:203], v[48:63]
  s_add_u32 m0, s50, 140288
  s_add_u32 s47, s46, 1216512
  buffer_load_dwordx4 v22, s[28:31], s47 offen lds
  v_exp_f32 v104, v104
  v_exp_f32 v105, v105
  v_exp_f32 v106, v106
  v_exp_f32 v107, v107
  v_exp_f32 v108, v108
  v_mfma_f32_32x32x16_bf16 v[128:143], a[12:15], v[228:231], v[128:143]
  s_add_u32 m0, s50, 143872
  s_add_u32 s47, s46, 1271808
  buffer_load_dwordx4 v22, s[28:31], s47 offen lds
  v_exp_f32 v109, v109
  v_exp_f32 v110, v110
  v_exp_f32 v111, v111
  v_cvt_pk_bf16_f32 v208, v96, v97
  v_cvt_pk_bf16_f32 v209, v98, v99
  v_cvt_pk_bf16_f32 v210, v100, v101
  v_mfma_f32_32x32x16_bf16 v[48:63], a[44:47], v[204:207], v[48:63]
  v_cvt_pk_bf16_f32 v211, v102, v103
  v_cvt_pk_bf16_f32 v212, v104, v105
  v_cvt_pk_bf16_f32 v213, v106, v107
  v_cvt_pk_bf16_f32 v214, v108, v109
  v_cvt_pk_bf16_f32 v215, v110, v111
  v_exp_f32 v112, v112
  v_exp_f32 v113, v113
  v_exp_f32 v114, v114
  v_mfma_f32_32x32x16_bf16 v[144:159], a[8:11], v[232:235], 0
  v_exp_f32 v115, v115
  v_exp_f32 v116, v116
  v_exp_f32 v117, v117
  v_exp_f32 v118, v118
  v_exp_f32 v119, v119
  s_waitcnt lgkmcnt(4)
  v_mfma_f32_32x32x16_bf16 v[32:47], a[48:51], v[208:211], v[32:47]
  v_exp_f32 v120, v120
  v_exp_f32 v121, v121
  v_exp_f32 v122, v122
  v_exp_f32 v123, v123
  v_exp_f32 v124, v124
  v_mfma_f32_32x32x16_bf16 v[144:159], a[12:15], v[236:239], v[144:159]
  v_exp_f32 v125, v125
  v_exp_f32 v126, v126
  v_exp_f32 v127, v127
  v_cvt_pk_bf16_f32 v216, v112, v113
  v_cvt_pk_bf16_f32 v217, v114, v115
  v_cvt_pk_bf16_f32 v218, v116, v117
  v_mfma_f32_32x32x16_bf16 v[32:47], a[52:55], v[212:215], v[32:47]
  v_cvt_pk_bf16_f32 v219, v118, v119
  v_cvt_pk_bf16_f32 v220, v120, v121
  v_cvt_pk_bf16_f32 v221, v122, v123
  v_cvt_pk_bf16_f32 v222, v124, v125
  v_cvt_pk_bf16_f32 v223, v126, v127
  v_exp_f32 v128, v128
  v_exp_f32 v129, v129
  v_exp_f32 v130, v130
  v_exp_f32 v131, v131
  v_exp_f32 v132, v132
  v_mfma_f32_32x32x16_bf16 v[48:63], a[48:51], v[216:219], v[48:63]
  v_exp_f32 v133, v133
  v_exp_f32 v134, v134
  v_exp_f32 v135, v135
  v_exp_f32 v136, v136
  v_exp_f32 v137, v137
  v_exp_f32 v138, v138
  v_exp_f32 v139, v139
  v_exp_f32 v140, v140
  v_exp_f32 v141, v141
  v_exp_f32 v142, v142
  v_mfma_f32_32x32x16_bf16 v[48:63], a[52:55], v[220:223], v[48:63]
  v_exp_f32 v143, v143
  v_cvt_pk_bf16_f32 v160, v128, v129
  v_cvt_pk_bf16_f32 v161, v130, v131
  v_cvt_pk_bf16_f32 v162, v132, v133
  v_cvt_pk_bf16_f32 v163, v134, v135
  v_cvt_pk_bf16_f32 v164, v136, v137
  v_cvt_pk_bf16_f32 v165, v138, v139
  v_cvt_pk_bf16_f32 v166, v140, v141
  v_cvt_pk_bf16_f32 v167, v142, v143
  v_exp_f32 v144, v144
  v_exp_f32 v145, v145
  v_exp_f32 v146, v146
  v_exp_f32 v147, v147
  v_exp_f32 v148, v148
  s_waitcnt lgkmcnt(0)
  v_mfma_f32_32x32x16_bf16 v[32:47], a[32:35], v[160:163], v[32:47]
  v_exp_f32 v149, v149
  v_exp_f32 v150, v150
  v_exp_f32 v151, v151
  v_exp_f32 v152, v152
  v_exp_f32 v153, v153
  v_exp_f32 v154, v154
  v_exp_f32 v155, v155
  v_exp_f32 v156, v156
  v_exp_f32 v157, v157
  v_exp_f32 v158, v158
  v_mfma_f32_32x32x16_bf16 v[32:47], a[36:39], v[164:167], v[32:47]
  v_exp_f32 v159, v159
  v_cvt_pk_bf16_f32 v168, v144, v145
  v_cvt_pk_bf16_f32 v169, v146, v147
  v_cvt_pk_bf16_f32 v170, v148, v149
  v_cvt_pk_bf16_f32 v171, v150, v151
  v_cvt_pk_bf16_f32 v172, v152, v153
  v_cvt_pk_bf16_f32 v173, v154, v155
  v_cvt_pk_bf16_f32 v174, v156, v157
  v_cvt_pk_bf16_f32 v175, v158, v159
  v_mfma_f32_32x32x16_bf16 v[48:63], a[32:35], v[168:171], v[48:63]
  s_nop 0
  v_mfma_f32_32x32x16_bf16 v[48:63], a[36:39], v[172:175], v[48:63]
  v_mov_b32 v18, 0x2b800000
  v_mov_b32 v19, 0x53800000
  v_cmp_nlt_f32 vcc, v18, v44
  s_nop 8
  v_cmp_nlt_f32 s[94:95], v18, v60
  s_nop 0
  s_or_b64 s[92:93], vcc, s[94:95]
  v_cmp_ngt_f32 vcc, v19, v44
  v_cmp_ngt_f32 s[94:95], v19, v60
  s_or_b64 s[92:93], s[92:93], vcc
  s_or_b64 s[92:93], s[92:93], s[94:95]
  s_cmp_lg_u64 s[92:93], 0
  s_cbranch_scc1 Latt_fb
  s_nop 0
Latt_fin:
  v_rcp_f32 v64, v44
  s_nop 0
  v_mov_b32 v65, v64
  v_pk_mul_f32 v[32:33], v[32:33], v[64:65]
  v_pk_mul_f32 v[34:35], v[34:35], v[64:65]
  v_pk_mul_f32 v[36:37], v[36:37], v[64:65]
  v_pk_mul_f32 v[38:39], v[38:39], v[64:65]
  v_pk_mul_f32 v[40:41], v[40:41], v[64:65]
  v_pk_mul_f32 v[42:43], v[42:43], v[64:65]
  v_cvt_pk_bf16_f32 v68, v32, v33
  v_cvt_pk_bf16_f32 v69, v34, v35
  v_cvt_pk_bf16_f32 v70, v36, v37
  v_cvt_pk_bf16_f32 v71, v38, v39
  v_cvt_pk_bf16_f32 v72, v40, v41
  v_cvt_pk_bf16_f32 v73, v42, v43
  v_rcp_f32 v80, v60
  s_nop 0
  v_mov_b32 v81, v80
  v_pk_mul_f32 v[48:49], v[48:49], v[80:81]
  v_pk_mul_f32 v[50:51], v[50:51], v[80:81]
  v_pk_mul_f32 v[52:53], v[52:53], v[80:81]
  v_pk_mul_f32 v[54:55], v[54:55], v[80:81]
  v_pk_mul_f32 v[56:57], v[56:57], v[80:81]
  v_pk_mul_f32 v[58:59], v[58:59], v[80:81]
  v_cvt_pk_bf16_f32 v84, v48, v49
  v_cvt_pk_bf16_f32 v85, v50, v51
  v_cvt_pk_bf16_f32 v86, v52, v53
  v_cvt_pk_bf16_f32 v87, v54, v55
  v_cvt_pk_bf16_f32 v88, v56, v57
  v_cvt_pk_bf16_f32 v89, v58, v59
  s_cmp_eq_u32 s55, 0
  s_cbranch_scc1 Lsafe_15
  buffer_store_dwordx4 v[68:71], v254, s[40:43], 0 offen
  buffer_store_dwordx4 v[84:87], v254, s[40:43], 0 offen offset:512
  s_mov_b32 exec_hi, 0
  buffer_store_dwordx2 v[72:73], v255, s[40:43], 0 offen
  buffer_store_dwordx2 v[88:89], v255, s[40:43], 0 offen offset:512
  s_mov_b64 exec, -1
  s_branch Ljoin_16
Lsafe_15:
  buffer_store_dwordx4 v[68:71], v254, s[40:43], 0 offen sc1
  buffer_store_dwordx4 v[84:87], v254, s[40:43], 0 offen offset:512 sc1
  s_mov_b32 exec_hi, 0
  buffer_store_dwordx2 v[72:73], v255, s[40:43], 0 offen sc1
  buffer_store_dwordx2 v[88:89], v255, s[40:43], 0 offen offset:512 sc1
  s_mov_b64 exec, -1
Ljoin_16:
  s_lshl_b32 s58, s53, 2
  s_add_u32 s58, s58, s52
  s_lshl_b32 s58, s58, 5
  s_add_u32 s58, s58, s54
  s_lshl_b32 s58, s58, 2
  s_add_u32 s58, s58, 28348416
  s_waitcnt vmcnt(0)
  v_mov_b32 v6, s3
  s_mov_b64 exec, 1
  s_cmp_eq_u32 s55, 0
  s_cbranch_scc1 Lsafe_17
  buffer_store_dword v6, v251, s[40:43], s58 offen
  s_branch Ljoin_18
Lsafe_17:
  buffer_store_dword v6, v251, s[40:43], s58 offen sc1
Ljoin_18:
  s_mov_b64 exec, -1
  v_cmp_ne_u32 vcc, s3, v23
  s_nop 4
  s_cbranch_vccz Luok_19
  s_mov_b32 s48, 0
Lpoll_20:
  buffer_load_dword v240, v21, s[40:43], 0 offen sc1
  s_add_u32 s48, s48, 1
  s_cmp_gt_u32 s48, 0x40000
  s_cbranch_scc1 Lend
  s_waitcnt vmcnt(0)
  v_cmp_ne_u32 vcc, s3, v240
  s_nop 4
  s_cbranch_vccnz Lpoll_20
Luok_19:
  s_lshr_b32 s58, s57, 1
  s_mul_i32 s59, s58, 5
  s_and_b32 s60, s57, 1
  s_lshl_b32 s64, s60, 1
  s_add_u32 s64, s64, s59
  s_lshl_b32 s64, s64, 14
  s_lshl_b32 s65, s59, 14
  s_lshl_b32 s60, s60, 3
  s_add_u32 s65, s65, s60
  s_add_u32 s65, s65, 65536
  s_lshl_b32 s66, s56, 10
  s_lshl_b32 s58, s58, 8
  s_add_u32 s66, s66, s58
  s_add_u32 s66, s66, s60
  s_lshl_b32 s67, s56, 3
  s_add_u32 s67, s67, s57
  s_lshl_b32 s67, s67, 2
  s_mov_b32 s68, 0xffff
  s_mov_b32 s69, 0xffff
  v_lshrrev_b32 v252, 1, v3
  v_lshlrev_b32 v252, 2, v252
  v_lshl_add_u32 v252, v2, 4, v252
  s_mul_i32 s58, s52, 15360
  v_add_u32 v219, s58, v4
  s_mul_i32 s58, s52, 16128
  s_add_u32 s80, s44, s58
  s_lshl_b32 s58, s52, 12
  s_add_u32 s81, s80, s58
  s_mul_i32 s45, s52, 61440
  s_sub_u32 s45, s45, 245760
  v_lshrrev_b32 v5, 1, v3
  v_lshl_add_u32 v56, v5, 12, v248
  v_lshl_add_u32 v57, v3, 14, v248
  v_add_u32 v57, 8192, v57
  s_and_b32 s58, s56, 12
  s_cmp_eq_u32 s58, 0
  s_cselect_b32 s58, 0, 3
  s_xor_b32 s58, s58, s52
  s_cmp_eq_u32 s58, 0
  s_cselect_b32 s58, 3, s58
  s_cmp_eq_u32 s58, 1
  s_cselect_b32 s59, 2, 1
  s_xor_b32 s60, s58, s59
  s_mov_b32 s85, s52
  s_xor_b32 s82, s52, s59
  s_mul_i32 s61, s82, 15360
  s_mul_i32 s62, s59, 5120
  s_add_u32 s61, s61, s62
  s_sub_u32 s61, s61, 5120
  v_add_u32 v253, s61, v4
  s_xor_b32 s83, s52, s60
  s_mul_i32 s61, s83, 15360
  s_mul_i32 s62, s60, 5120
  s_add_u32 s61, s61, s62
  s_sub_u32 s61, s61, 5120
  v_add_u32 v254, s61, v4
  s_xor_b32 s84, s52, s58
  s_mul_i32 s61, s84, 15360
  s_mul_i32 s62, s58, 5120
  s_add_u32 s61, s61, s62
  s_sub_u32 s61, s61, 5120
  v_add_u32 v255, s61, v4
  v_lshlrev_b32 v64, 16, v8
  v_and_b32 v65, 0xffff0000, v8
  v_lshlrev_b32 v66, 16, v9
  v_and_b32 v67, 0xffff0000, v9
  v_lshlrev_b32 v68, 16, v10
  v_and_b32 v69, 0xffff0000, v10
  v_lshlrev_b32 v70, 16, v11
  v_and_b32 v71, 0xffff0000, v11
  v_lshlrev_b32 v72, 16, v12
  v_and_b32 v73, 0xffff0000, v12
  v_lshlrev_b32 v74, 16, v13
  v_and_b32 v75, 0xffff0000, v13
  v_lshlrev_b32 v76, 16, v14
  v_and_b32 v77, 0xffff0000, v14
  v_lshlrev_b32 v78, 16, v15
  v_and_b32 v79, 0xffff0000, v15
  v_lshlrev_b32 v80, 16, v16
  v_and_b32 v81, 0xffff0000, v16
  v_lshlrev_b32 v82, 16, v17
  v_and_b32 v83, 0xffff0000, v17
  v_and_b32 v6, 31, v1
  v_lshlrev_b32 v6, 2, v6
  s_lshr_b32 s58, s56, 2
  s_lshl_b32 s58, s58, 7
  s_add_u32 s58, s58, 28348416
  s_and_b32 s92, s54, 15
  s_mul_i32 s93, s92, 7
  s_min_u32 s93, s93, 101
  s_barrier
  s_mov_b32 s48, 0
Lpoll_21:
  buffer_load_dword v240, v6, s[40:43], s58 offen sc1
  s_add_u32 s48, s48, 1
  s_cmp_gt_u32 s48, 0x40000
  s_cbranch_scc1 Lend
  s_waitcnt vmcnt(0)
  v_cmp_ne_u32 vcc, s3, v240
  s_nop 4
  s_cbranch_vccnz Lpoll_21
  s_mul_i32 s78, s82, 256
  s_add_u32 s78, s78, s81
  buffer_load_dwordx4 v[100:103], v56, s[40:43], s78 offen sc1
  s_add_u32 s78, s78, 81920
  buffer_load_dwordx4 v[104:107], v56, s[40:43], s78 offen sc1
  s_add_u32 s78, s78, 81920
  buffer_load_dwordx4 v[108:111], v56, s[40:43], s78 offen sc1
  s_add_u32 s78, s78, 81920
  buffer_load_dwordx4 v[112:115], v56, s[40:43], s78 offen sc1
  s_add_u32 s78, s78, s45
  buffer_load_dwordx4 v[116:119], v57, s[40:43], s78 offen sc1
  s_mul_i32 s78, s83, 256
  s_add_u32 s78, s78, s81
  buffer_load_dwordx4 v[120:123], v56, s[40:43], s78 offen sc1
  s_waitcnt vmcnt(5)
  v_mfma_f32_16x16x32_bf16 v[8:11], a[56:59], v[100:103], 0
  s_add_u32 s78, s78, 81920
  v_and_b32 v58, 31, v1
  v_mfma_f32_16x16x32_bf16 v[12:15], a[60:63], v[100:103], 0
  v_lshlrev_b32 v58, 10, v58
  buffer_load_dwordx4 v[124:127], v56, s[40:43], s78 offen sc1
  v_mfma_f32_16x16x32_bf16 v[16:19], a[64:67], v[100:103], 0
  s_add_u32 s61, s53, 1
  s_min_u32 s61, s61, 7
  v_mfma_f32_16x16x32_bf16 v[20:23], a[68:71], v[100:103], 0
  s_add_u32 s78, s78, 81920
  s_lshl_b32 s61, s61, 7
  v_mfma_f32_16x16x32_bf16 v[24:27], a[72:75], v[100:103], 0
  s_add_u32 s61, s61, 21037056
  buffer_load_dwordx4 v[128:131], v56, s[40:43], s78 offen sc1
  s_waitcnt vmcnt(6)
  v_mfma_f32_16x16x32_bf16 v[8:11], a[76:79], v[104:107], v[8:11]
  v_add_u32 v58, s61, v58
  s_lshr_b32 s61, s93, 2
  v_mfma_f32_16x16x32_bf16 v[12:15], a[80:83], v[104:107], v[12:15]
  s_add_u32 s78, s78, 81920
  s_add_u32 s61, s61, 7
  v_mfma_f32_16x16x32_bf16 v[16:19], a[84:87], v[104:107], v[16:19]
  v_and_b32 v5, 3, v1
  buffer_load_dwordx4 v[132:135], v56, s[40:43], s78 offen sc1
  v_mfma_f32_16x16x32_bf16 v[20:23], a[88:91], v[104:107], v[20:23]
  v_add_u32 v7, s61, v5
  v_min_u32 v7, 34, v7
  v_mfma_f32_16x16x32_bf16 v[24:27], a[92:95], v[104:107], v[24:27]
  s_add_u32 s78, s78, s45
  v_mov_b32 v6, s57
  s_waitcnt vmcnt(6)
  v_mfma_f32_16x16x32_bf16 v[8:11], a[96:99], v[108:111], v[8:11]
  v_cmp_eq_u32 vcc, 0, v5
  buffer_load_dwordx4 v[136:139], v57, s[40:43], s78 offen sc1
  v_mfma_f32_16x16x32_bf16 v[12:15], a[100:103], v[108:111], v[12:15]
  v_cndmask_b32 v7, v7, v6, vcc
  v_lshlrev_b32 v7, 7, v7
  v_mfma_f32_16x16x32_bf16 v[16:19], a[104:107], v[108:111], v[16:19]
  s_mul_i32 s78, s84, 256
  v_add_u32 v7, 21200896, v7
  v_mfma_f32_16x16x32_bf16 v[20:23], a[108:111], v[108:111], v[20:23]
  v_cmp_gt_u32 vcc, 32, v1
  s_add_u32 s78, s78, s81
  v_mfma_f32_16x16x32_bf16 v[24:27], a[112:115], v[108:111], v[24:27]
  v_cndmask_b32 v58, v7, v58, vcc
  s_and_b32 s59, s56, 0x7c
  s_waitcnt vmcnt(6)
  v_mfma_f32_16x16x32_bf16 v[8:11], a[116:119], v[112:115], v[8:11]
  buffer_load_dwordx4 v[140:143], v56, s[40:43], s78 offen sc1
  v_lshrrev_b32 v5, 3, v1
  v_mfma_f32_16x16x32_bf16 v[12:15], a[120:123], v[112:115], v[12:15]
  v_and_b32 v6, 3, v5
  s_add_u32 s78, s78, 81920
  v_mfma_f32_16x16x32_bf16 v[16:19], a[124:127], v[112:115], v[16:19]
  v_cmp_eq_u32 vcc, 4, v5
  s_nop 1
  v_cndmask_b32 v6, v6, -1, vcc
  v_mfma_f32_16x16x32_bf16 v[20:23], a[128:131], v[112:115], v[20:23]
  buffer_load_dwordx4 v[144:147], v56, s[40:43], s78 offen sc1
  v_cmp_eq_u32 vcc, 5, v5
  v_mfma_f32_16x16x32_bf16 v[24:27], a[132:135], v[112:115], v[24:27]
  s_nop 0
  v_cndmask_b32 v6, v6, 4, vcc
  s_add_u32 s78, s78, 81920
  s_waitcnt vmcnt(7)
  v_mfma_f32_16x16x32_bf16 v[8:11], a[136:139], v[116:119], v[8:11]
  v_add_u32 v6, s59, v6
  v_mov_b32 v7, s56
  v_mfma_f32_16x16x32_bf16 v[12:15], a[140:143], v[116:119], v[12:15]
  buffer_load_dwordx4 v[148:151], v56, s[40:43], s78 offen sc1
  v_xor_b32 v5, s56, v6
  v_mfma_f32_16x16x32_bf16 v[16:19], a[144:147], v[116:119], v[16:19]
  v_cmp_lt_u32 vcc, 15, v5
  s_add_u32 s78, s78, 81920
  v_mfma_f32_16x16x32_bf16 v[20:23], a[148:151], v[116:119], v[20:23]
  v_cndmask_b32 v6, v6, v7, vcc
  v_lshlrev_b32 v6, 5, v6
  v_mfma_f32_16x16x32_bf16 v[24:27], a[152:155], v[116:119], v[24:27]
  buffer_load_dwordx4 v[152:155], v56, s[40:43], s78 offen sc1
  v_and_b32 v5, 7, v1
  s_waitcnt vmcnt(8)
  v_mfma_f32_16x16x32_bf16 v[28:31], a[56:59], v[120:123], 0
  v_lshl_add_u32 v60, v5, 2, v6
  s_add_u32 s78, s78, s45
  v_mfma_f32_16x16x32_bf16 v[32:35], a[60:63], v[120:123], 0
  v_add_u32 v60, 28352512, v60
  s_mul_i32 s63, s57, 5120
  v_mfma_f32_16x16x32_bf16 v[36:39], a[64:67], v[120:123], 0
  ds_write_b128 v253, v[8:11] offset:0
  v_mfma_f32_16x16x32_bf16 v[40:43], a[68:71], v[120:123], 0
  buffer_load_dwordx4 v[156:159], v57, s[40:43], s78 offen sc1
  s_mul_i32 s46, s52, 40960
  v_mfma_f32_16x16x32_bf16 v[44:47], a[72:75], v[120:123], 0
  s_add_u32 s46, s46, s63
  s_mul_i32 s78, s85, 256
  s_waitcnt vmcnt(8)
  v_mfma_f32_16x16x32_bf16 v[28:31], a[76:79], v[124:127], v[28:31]
  ds_write_b128 v253, v[12:15] offset:1024
  v_mfma_f32_16x16x32_bf16 v[32:35], a[80:83], v[124:127], v[32:35]
  s_add_u32 s46, s46, 14745600
  s_mul_i32 s60, s53, -983040
  v_mfma_f32_16x16x32_bf16 v[36:39], a[84:87], v[124:127], v[36:39]
  s_add_u32 s78, s78, s81
  s_add_u32 s60, s60, 9830400
  v_mfma_f32_16x16x32_bf16 v[40:43], a[88:91], v[124:127], v[40:43]
  ds_write_b128 v253, v[16:19] offset:2048
  v_mfma_f32_16x16x32_bf16 v[44:47], a[92:95], v[124:127], v[44:47]
  s_lshr_b32 s59, s56, 2
  buffer_load_dwordx4 v[160:163], v56, s[40:43], s78 offen sc1
  s_waitcnt vmcnt(8)
  v_mfma_f32_16x16x32_bf16 v[28:31], a[96:99], v[128:131], v[28:31]
  s_add_u32 s59, s59, 1
  s_and_b32 s59, s59, 30
  v_mfma_f32_16x16x32_bf16 v[32:35], a[100:103], v[128:131], v[32:35]
  ds_write_b128 v253, v[20:23] offset:3072
  v_mfma_f32_16x16x32_bf16 v[36:39], a[104:107], v[128:131], v[36:39]
  s_add_u32 s78, s78, 81920
  s_min_u32 s59, s59, 1
  v_mfma_f32_16x16x32_bf16 v[40:43], a[108:111], v[128:131], v[40:43]
  s_xor_b32 s59, s59, 1
  buffer_load_dwordx4 v[164:167], v56, s[40:43], s78 offen sc1
  v_mfma_f32_16x16x32_bf16 v[44:47], a[112:115], v[128:131], v[44:47]
  ds_write_b128 v253, v[24:27] offset:4096
  s_waitcnt vmcnt(8)
  v_mfma_f32_16x16x32_bf16 v[28:31], a[116:119], v[132:135], v[28:31]
  s_lshl_b32 s59, s59, 31
  s_or_b32 s60, s60, s59
  v_mfma_f32_16x16x32_bf16 v[32:35], a[120:123], v[132:135], v[32:35]
  s_add_u32 s78, s78, 81920
  v_add_u32 v61, s60, v248
  v_mfma_f32_16x16x32_bf16 v[36:39], a[124:127], v[132:135], v[36:39]
  s_and_b32 s79, s56, 12
  buffer_load_dwordx4 v[168:171], v56, s[40:43], s78 offen sc1
  v_mfma_f32_16x16x32_bf16 v[40:43], a[128:131], v[132:135], v[40:43]
  s_add_u32 s59, s52, 0
  s_mul_i32 s59, s59, 52
  v_mfma_f32_16x16x32_bf16 v[44:47], a[132:135], v[132:135], v[44:47]
  s_add_u32 s78, s78, 81920
  s_lshr_b32 s59, s59, 8
  s_waitcnt vmcnt(8)
  v_mfma_f32_16x16x32_bf16 v[28:31], a[136:139], v[136:139], v[28:31]
  s_lshr_b32 s62, s59, 1
  buffer_load_dwordx4 v[172:175], v56, s[40:43], s78 offen sc1
  v_mfma_f32_16x16x32_bf16 v[32:35], a[140:143], v[136:139], v[32:35]
  s_add_u32 s62, s62, 1
  s_and_b32 s59, s59, 1
  v_mfma_f32_16x16x32_bf16 v[36:39], a[144:147], v[136:139], v[36:39]
  s_add_u32 s78, s78, s45
  s_mul_i32 s59, s59, s62
  v_mfma_f32_16x16x32_bf16 v[40:43], a[148:151], v[136:139], v[40:43]
  s_lshl_b32 s59, s59, 1
  buffer_load_dwordx4 v[176:179], v57, s[40:43], s78 offen sc1
  v_mfma_f32_16x16x32_bf16 v[44:47], a[152:155], v[136:139], v[44:47]
  s_sub_u32 s86, s59, s62
  s_add_u32 s59, s52, 4
  s_waitcnt vmcnt(9)
  v_mfma_f32_16x16x32_bf16 v[8:11], a[56:59], v[140:143], 0
  buffer_load_dword v59, v58, s[40:43], 0 offen sc1
  s_add_u32 s47, s46, 0
  v_mfma_f32_16x16x32_bf16 v[12:15], a[60:63], v[140:143], 0
  s_mul_i32 s59, s59, 52
  s_lshr_b32 s59, s59, 8
  v_mfma_f32_16x16x32_bf16 v[16:19], a[64:67], v[140:143], 0
  ds_write_b128 v254, v[28:31] offset:0
  v_mfma_f32_16x16x32_bf16 v[20:23], a[68:71], v[140:143], 0
  buffer_load_dwordx4 a[0:3], v4, s[40:43], s47 offen offset:0 sc1
  s_lshr_b32 s62, s59, 1
  v_mfma_f32_16x16x32_bf16 v[24:27], a[72:75], v[140:143], 0
  s_add_u32 s62, s62, 1
  buffer_load_dwordx4 a[4:7], v4, s[40:43], s47 offen offset:1024 sc1
  s_waitcnt vmcnt(11)
  v_mfma_f32_16x16x32_bf16 v[8:11], a[76:79], v[144:147], v[8:11]
  ds_write_b128 v254, v[32:35] offset:1024
  v_mfma_f32_16x16x32_bf16 v[12:15], a[80:83], v[144:147], v[12:15]
  s_and_b32 s59, s59, 1
  s_mul_i32 s59, s59, s62
  v_mfma_f32_16x16x32_bf16 v[16:19], a[84:87], v[144:147], v[16:19]
  buffer_load_dwordx4 a[8:11], v4, s[40:43], s47 offen offset:2048 sc1
  s_lshl_b32 s59, s59, 1
  v_mfma_f32_16x16x32_bf16 v[20:23], a[88:91], v[144:147], v[20:23]
  ds_write_b128 v254, v[36:39] offset:2048
  v_mfma_f32_16x16x32_bf16 v[24:27], a[92:95], v[144:147], v[24:27]
  s_sub_u32 s87, s59, s62
  buffer_load_dwordx4 a[12:15], v4, s[40:43], s47 offen offset:3072 sc1
  s_waitcnt vmcnt(12)
  v_mfma_f32_16x16x32_bf16 v[8:11], a[96:99], v[148:151], v[8:11]
  s_add_u32 s59, s52, 8
  s_mul_i32 s59, s59, 52
  v_mfma_f32_16x16x32_bf16 v[12:15], a[100:103], v[148:151], v[12:15]
  ds_write_b128 v254, v[40:43] offset:3072
  v_mfma_f32_16x16x32_bf16 v[16:19], a[104:107], v[148:151], v[16:19]
  s_add_u32 s47, s46, 4096
  s_lshr_b32 s59, s59, 8
  v_mfma_f32_16x16x32_bf16 v[20:23], a[108:111], v[148:151], v[20:23]
  s_lshr_b32 s62, s59, 1
  buffer_load_dwordx4 a[16:19], v4, s[40:43], s47 offen offset:0 sc1
  v_mfma_f32_16x16x32_bf16 v[24:27], a[112:115], v[148:151], v[24:27]
  ds_write_b128 v254, v[44:47] offset:4096
  s_waitcnt vmcnt(12)
  v_mfma_f32_16x16x32_bf16 v[8:11], a[116:119], v[152:155], v[8:11]
  s_add_u32 s62, s62, 1
  s_and_b32 s59, s59, 1
  v_mfma_f32_16x16x32_bf16 v[12:15], a[120:123], v[152:155], v[12:15]
  s_add_u32 s47, s46, 163840
  s_mul_i32 s59, s59, s62
  v_mfma_f32_16x16x32_bf16 v[16:19], a[124:127], v[152:155], v[16:19]
  s_lshl_b32 s59, s59, 1
  buffer_load_dwordx4 a[20:23], v4, s[40:43], s47 offen offset:0 sc1
  v_mfma_f32_16x16x32_bf16 v[20:23], a[128:131], v[152:155], v[20:23]
  s_sub_u32 s88, s59, s62
  s_add_u32 s59, s52, 12
  v_mfma_f32_16x16x32_bf16 v[24:27], a[132:135], v[152:155], v[24:27]
  buffer_load_dwordx4 a[24:27], v4, s[40:43], s47 offen offset:1024 sc1
  s_mul_i32 s59, s59, 52
  s_waitcnt vmcnt(13)
  v_mfma_f32_16x16x32_bf16 v[8:11], a[136:139], v[156:159], v[8:11]
  s_lshr_b32 s59, s59, 8
  s_lshr_b32 s62, s59, 1
  v_mfma_f32_16x16x32_bf16 v[12:15], a[140:143], v[156:159], v[12:15]
  s_add_u32 s62, s62, 1
  s_and_b32 s59, s59, 1
  v_mfma_f32_16x16x32_bf16 v[16:19], a[144:147], v[156:159], v[16:19]
  s_mul_i32 s59, s59, s62
  s_lshl_b32 s59, s59, 1
  v_mfma_f32_16x16x32_bf16 v[20:23], a[148:151], v[156:159], v[20:23]
  s_sub_u32 s89, s59, s62
  s_add_u32 s59, s52, 16
  v_mfma_f32_16x16x32_bf16 v[24:27], a[152:155], v[156:159], v[24:27]
  s_mul_i32 s59, s59, 52
  s_lshr_b32 s59, s59, 8
  s_waitcnt vmcnt(12)
  v_mfma_f32_16x16x32_bf16 v[64:67], a[56:59], v[160:163], v[64:67]
  s_lshr_b32 s62, s59, 1
  s_add_u32 s62, s62, 1
  v_mfma_f32_16x16x32_bf16 v[68:71], a[60:63], v[160:163], v[68:71]
  s_and_b32 s59, s59, 1
  s_mul_i32 s59, s59, s62
  v_mfma_f32_16x16x32_bf16 v[72:75], a[64:67], v[160:163], v[72:75]
  ds_write_b128 v255, v[8:11] offset:0
  v_mfma_f32_16x16x32_bf16 v[76:79], a[68:71], v[160:163], v[76:79]
  s_lshl_b32 s59, s59, 1
  s_sub_u32 s90, s59, s62
  v_mfma_f32_16x16x32_bf16 v[80:83], a[72:75], v[160:163], v[80:83]
  s_add_u32 s59, s79, s82
  s_lshl_b32 s59, s59, 4
  s_waitcnt vmcnt(11)
  v_mfma_f32_16x16x32_bf16 v[64:67], a[76:79], v[164:167], v[64:67]
  ds_write_b128 v255, v[12:15] offset:1024
  v_mfma_f32_16x16x32_bf16 v[68:71], a[80:83], v[164:167], v[68:71]
  v_add_u32 v5, s59, v2
  v_add_u32 v6, s86, v5
  v_mfma_f32_16x16x32_bf16 v[72:75], a[84:87], v[164:167], v[72:75]
  v_cmp_lt_u32 vcc, 255, v6
  s_nop 1
  v_cndmask_b32 v180, v248, v61, vcc
  v_mfma_f32_16x16x32_bf16 v[76:79], a[88:91], v[164:167], v[76:79]
  ds_write_b128 v255, v[16:19] offset:2048
  v_mfma_f32_16x16x32_bf16 v[80:83], a[92:95], v[164:167], v[80:83]
  v_add_u32 v6, s87, v5
  v_cmp_lt_u32 vcc, 255, v6
  s_waitcnt vmcnt(10)
  v_mfma_f32_16x16x32_bf16 v[64:67], a[96:99], v[168:171], v[64:67]
  v_cndmask_b32 v181, v248, v61, vcc
  v_add_u32 v6, s88, v5
  v_mfma_f32_16x16x32_bf16 v[68:71], a[100:103], v[168:171], v[68:71]
  ds_write_b128 v255, v[20:23] offset:3072
  v_mfma_f32_16x16x32_bf16 v[72:75], a[104:107], v[168:171], v[72:75]
  v_cmp_lt_u32 vcc, 255, v6
  s_nop 1
  v_cndmask_b32 v182, v248, v61, vcc
  v_mfma_f32_16x16x32_bf16 v[76:79], a[108:111], v[168:171], v[76:79]
  v_add_u32 v6, s89, v5
  v_cmp_lt_u32 vcc, 255, v6
  v_mfma_f32_16x16x32_bf16 v[80:83], a[112:115], v[168:171], v[80:83]
  ds_write_b128 v255, v[24:27] offset:4096
  s_waitcnt vmcnt(9)
  v_mfma_f32_16x16x32_bf16 v[64:67], a[116:119], v[172:175], v[64:67]
  v_cndmask_b32 v183, v248, v61, vcc
  v_add_u32 v6, s90, v5
  v_mfma_f32_16x16x32_bf16 v[68:71], a[120:123], v[172:175], v[68:71]
  v_cmp_lt_u32 vcc, 255, v6
  s_nop 1
  v_cndmask_b32 v184, v248, v61, vcc
  v_mfma_f32_16x16x32_bf16 v[72:75], a[124:127], v[172:175], v[72:75]
  s_waitcnt lgkmcnt(0)
  s_barrier
  ds_read_b128 v[100:103], v219 offset:0
  v_mfma_f32_16x16x32_bf16 v[76:79], a[128:131], v[172:175], v[76:79]
  ds_read_b128 v[104:107], v219 offset:1024
  v_mfma_f32_16x16x32_bf16 v[80:83], a[132:135], v[172:175], v[80:83]
  ds_read_b128 v[108:111], v219 offset:2048
  s_waitcnt vmcnt(8)
  v_mfma_f32_16x16x32_bf16 v[64:67], a[136:139], v[176:179], v[64:67]
  ds_read_b128 v[112:115], v219 offset:3072
  v_mfma_f32_16x16x32_bf16 v[68:71], a[140:143], v[176:179], v[68:71]
  ds_read_b128 v[116:119], v219 offset:4096
  v_mfma_f32_16x16x32_bf16 v[72:75], a[144:147], v[176:179], v[72:75]
  ds_read_b128 v[120:123], v219 offset:5120
  v_mfma_f32_16x16x32_bf16 v[76:79], a[148:151], v[176:179], v[76:79]
  ds_read_b128 v[124:127], v219 offset:6144
  v_mfma_f32_16x16x32_bf16 v[80:83], a[152:155], v[176:179], v[80:83]
  ds_read_b128 v[128:131], v219 offset:7168
  ds_read_b128 v[132:135], v219 offset:8192
  ds_read_b128 v[136:139], v219 offset:9216
  ds_read_b128 v[140:143], v219 offset:10240
  ds_read_b128 v[144:147], v219 offset:11264
  ds_read_b128 v[148:151], v219 offset:12288
  ds_read_b128 v[152:155], v219 offset:13312
  ds_read_b128 v[156:159], v219 offset:14336
  s_add_u32 s59, s79, s83
  s_lshl_b32 s59, s59, 4
  v_add_u32 v5, s59, v2
  v_add_u32 v6, s86, v5
  v_cmp_lt_u32 vcc, 255, v6
  s_nop 1
  v_cndmask_b32 v185, v248, v61, vcc
  v_add_u32 v6, s87, v5
  v_cmp_lt_u32 vcc, 255, v6
  s_nop 1
  v_cndmask_b32 v186, v248, v61, vcc
  v_add_u32 v6, s88, v5
  v_cmp_lt_u32 vcc, 255, v6
  s_nop 1
  v_cndmask_b32 v187, v248, v61, vcc
  v_add_u32 v6, s89, v5
  v_cmp_lt_u32 vcc, 255, v6
  s_nop 1
  v_cndmask_b32 v188, v248, v61, vcc
  v_add_u32 v6, s90, v5
  v_cmp_lt_u32 vcc, 255, v6
  s_nop 1
  v_cndmask_b32 v189, v248, v61, vcc
  s_waitcnt lgkmcnt(10)
  v_pk_add_f32 v[64:65], v[64:65], v[100:101]
  v_pk_add_f32 v[66:67], v[66:67], v[102:103]
  v_pk_add_f32 v[68:69], v[68:69], v[104:105]
  v_pk_add_f32 v[70:71], v[70:71], v[106:107]
  v_pk_add_f32 v[72:73], v[72:73], v[108:109]
  v_pk_add_f32 v[74:75], v[74:75], v[110:111]
  v_pk_add_f32 v[76:77], v[76:77], v[112:113]
  v_pk_add_f32 v[78:79], v[78:79], v[114:115]
  v_pk_add_f32 v[80:81], v[80:81], v[116:117]
  v_pk_add_f32 v[82:83], v[82:83], v[118:119]
  s_waitcnt lgkmcnt(5)
  v_pk_add_f32 v[64:65], v[64:65], v[120:121]
  v_pk_add_f32 v[66:67], v[66:67], v[122:123]
  v_pk_add_f32 v[68:69], v[68:69], v[124:125]
  v_pk_add_f32 v[70:71], v[70:71], v[126:127]
  v_pk_add_f32 v[72:73], v[72:73], v[128:129]
  v_pk_add_f32 v[74:75], v[74:75], v[130:131]
  v_pk_add_f32 v[76:77], v[76:77], v[132:133]
  v_pk_add_f32 v[78:79], v[78:79], v[134:135]
  v_pk_add_f32 v[80:81], v[80:81], v[136:137]
  v_pk_add_f32 v[82:83], v[82:83], v[138:139]
  s_waitcnt lgkmcnt(0)
  v_pk_add_f32 v[64:65], v[64:65], v[140:141]
  v_pk_add_f32 v[66:67], v[66:67], v[142:143]
  v_pk_add_f32 v[68:69], v[68:69], v[144:145]
  v_pk_add_f32 v[70:71], v[70:71], v[146:147]
  v_pk_add_f32 v[72:73], v[72:73], v[148:149]
  v_pk_add_f32 v[74:75], v[74:75], v[150:151]
  v_pk_add_f32 v[76:77], v[76:77], v[152:153]
  v_pk_add_f32 v[78:79], v[78:79], v[154:155]
  v_pk_add_f32 v[80:81], v[80:81], v[156:157]
  v_pk_add_f32 v[82:83], v[82:83], v[158:159]
  v_cvt_pk_bf16_f32 v84, v64, v65
  v_cvt_pk_bf16_f32 v85, v66, v67
  v_cvt_pk_bf16_f32 v86, v68, v69
  v_cvt_pk_bf16_f32 v87, v70, v71
  v_cvt_pk_bf16_f32 v88, v72, v73
  v_cvt_pk_bf16_f32 v89, v74, v75
  v_cvt_pk_bf16_f32 v90, v76, v77
  v_cvt_pk_bf16_f32 v91, v78, v79
  v_cvt_pk_bf16_f32 v92, v80, v81
  v_cvt_pk_bf16_f32 v93, v82, v83
  s_waitcnt vmcnt(7)
  v_cmp_ne_u32 vcc, s3, v59
  s_nop 4
  s_cbranch_vccz Luok_22
  s_mov_b32 s48, 0
Lpoll_23:
  buffer_load_dword v240, v58, s[40:43], 0 offen sc1
  s_add_u32 s48, s48, 1
  s_cmp_gt_u32 s48, 0x40000
  s_cbranch_scc1 Lend
  s_waitcnt vmcnt(0)
  v_cmp_ne_u32 vcc, s3, v240
  s_nop 4
  s_cbranch_vccnz Lpoll_23
Luok_22:
  s_add_u32 s63, s44, 327680
  s_add_u32 s62, s63, s64
  s_add_u32 s63, s63, s65
  s_add_u32 s61, s62, 16384
  s_cmp_eq_u32 s55, 0
  s_cbranch_scc1 Lsafe_24
  buffer_store_dwordx4 v[84:87], v248, s[40:43], s62 offen
  buffer_store_dwordx4 v[88:91], v248, s[40:43], s61 offen
  buffer_store_dwordx2 v[92:93], v248, s[40:43], s63 offen
  s_branch Ljoin_25
Lsafe_24:
  buffer_store_dwordx4 v[84:87], v248, s[40:43], s62 offen sc1
  buffer_store_dwordx4 v[88:91], v248, s[40:43], s61 offen sc1
  buffer_store_dwordx2 v[92:93], v248, s[40:43], s63 offen sc1
Ljoin_25:
  v_lshlrev_b32 v220, 16, v84
  v_and_b32 v221, 0xffff0000, v84
  v_lshlrev_b32 v222, 16, v85
  v_and_b32 v223, 0xffff0000, v85
  v_lshlrev_b32 v224, 16, v86
  v_and_b32 v225, 0xffff0000, v86
  v_lshlrev_b32 v226, 16, v87
  v_and_b32 v227, 0xffff0000, v87
  v_lshlrev_b32 v228, 16, v88
  v_and_b32 v229, 0xffff0000, v88
  v_lshlrev_b32 v230, 16, v89
  v_and_b32 v231, 0xffff0000, v89
  v_lshlrev_b32 v232, 16, v90
  v_and_b32 v233, 0xffff0000, v90
  v_lshlrev_b32 v234, 16, v91
  v_and_b32 v235, 0xffff0000, v91
  v_lshlrev_b32 v236, 16, v92
  v_and_b32 v237, 0xffff0000, v92
  v_lshlrev_b32 v238, 16, v93
  v_and_b32 v239, 0xffff0000, v93
  v_pk_add_f32 v[48:49], v[220:221], v[222:223]
  v_pk_mul_f32 v[50:51], v[220:221], v[220:221]
  v_pk_fma_f32 v[50:51], v[222:223], v[222:223], v[50:51]
  v_pk_add_f32 v[48:49], v[48:49], v[224:225]
  v_pk_fma_f32 v[50:51], v[224:225], v[224:225], v[50:51]
  v_pk_add_f32 v[48:49], v[48:49], v[226:227]
  v_pk_fma_f32 v[50:51], v[226:227], v[226:227], v[50:51]
  v_pk_add_f32 v[48:49], v[48:49], v[228:229]
  v_pk_fma_f32 v[50:51], v[228:229], v[228:229], v[50:51]
  v_pk_add_f32 v[48:49], v[48:49], v[230:231]
  v_pk_fma_f32 v[50:51], v[230:231], v[230:231], v[50:51]
  v_pk_add_f32 v[48:49], v[48:49], v[232:233]
  v_pk_fma_f32 v[50:51], v[232:233], v[232:233], v[50:51]
  v_pk_add_f32 v[48:49], v[48:49], v[234:235]
  v_pk_fma_f32 v[50:51], v[234:235], v[234:235], v[50:51]
  v_pk_add_f32 v[48:49], v[48:49], v[236:237]
  v_pk_fma_f32 v[50:51], v[236:237], v[236:237], v[50:51]
  v_pk_add_f32 v[48:49], v[48:49], v[238:239]
  v_pk_fma_f32 v[50:51], v[238:239], v[238:239], v[50:51]
  v_add_f32 v48, v48, v49
  v_add_f32 v49, v50, v51
  s_nop 1
  v_permlane32_swap_b32 v48, v49
  v_add_f32 v48, v48, v49
  v_mov_b32 v49, v48
  s_nop 1
  v_permlane16_swap_b32 v48, v49
  v_add_f32 v48, v48, v49
  s_add_u32 s61, s66, 28065792
  s_mov_b64 exec, s[68:69]
  s_cmp_eq_u32 s55, 0
  s_cbranch_scc1 Lsafe_26
  buffer_store_dword v48, v252, s[40:43], s61 offen
  s_branch Ljoin_27
Lsafe_26:
  buffer_store_dword v48, v252, s[40:43], s61 offen sc1
Ljoin_27:
  s_mov_b64 exec, -1
  s_waitcnt vmcnt(0)
  s_add_u32 s58, s67, 28352512
  v_mov_b32 v6, s3
  s_mov_b64 exec, 1
  s_cmp_eq_u32 s55, 0
  s_cbranch_scc1 Lsafe_28
  buffer_store_dword v6, v251, s[40:43], s58 offen
  s_branch Ljoin_29
Lsafe_28:
  buffer_store_dword v6, v251, s[40:43], s58 offen sc1
Ljoin_29:
  s_mov_b64 exec, -1
  buffer_load_dwordx4 a[28:31], v4, s[40:43], s47 offen offset:2048 sc1
  buffer_load_dwordx4 a[32:35], v4, s[40:43], s47 offen offset:3072 sc1
  s_add_u32 s47, s46, 167936
  buffer_load_dwordx4 a[36:39], v4, s[40:43], s47 offen offset:0 sc1
  s_lshl_b32 s58, s56, 10
  s_add_u32 s58, s58, 28065792
  s_mov_b32 s48, 0
Lpoll_30:
  buffer_load_dword v240, v60, s[40:43], 0 offen sc1
  s_add_u32 s48, s48, 1
  s_cmp_gt_u32 s48, 0x40000
  s_cbranch_scc1 Lend
  s_waitcnt vmcnt(0)
  v_cmp_ne_u32 vcc, s3, v240
  s_nop 4
  s_cbranch_vccnz Lpoll_30
  s_mul_i32 s78, s82, 256
  s_add_u32 s78, s78, s80
  s_add_u32 s78, s78, 327680
  buffer_load_dwordx4 v[100:103], v248, s[40:43], s78 offen sc1
  s_add_u32 s78, s78, 65536
  buffer_load_dwordx4 v[104:107], v248, s[40:43], s78 offen sc1
  s_add_u32 s78, s78, 65536
  buffer_load_dwordx4 v[108:111], v248, s[40:43], s78 offen sc1
  s_add_u32 s78, s78, 65536
  buffer_load_dwordx4 v[112:115], v248, s[40:43], s78 offen sc1
  s_add_u32 s78, s78, 65536
  buffer_load_dwordx4 v[116:119], v248, s[40:43], s78 offen sc1
  s_mul_i32 s78, s83, 256
  s_add_u32 s78, s78, s80
  s_add_u32 s78, s78, 327680
  buffer_load_dwordx4 v[120:123], v248, s[40:43], s78 offen sc1
  buffer_load_dwordx4 v[54:57], v4, s[40:43], s58 offen sc1
  s_waitcnt vmcnt(6)
  v_mfma_f32_16x16x32_bf16 v[8:11], a[156:159], v[100:103], 0
  s_add_u32 s78, s78, 65536
  s_add_u32 s59, s79, s84
  v_mfma_f32_16x16x32_bf16 v[12:15], a[160:163], v[100:103], 0
  s_lshl_b32 s59, s59, 4
  buffer_load_dwordx4 v[124:127], v248, s[40:43], s78 offen sc1
  v_mfma_f32_16x16x32_bf16 v[16:19], a[164:167], v[100:103], 0
  v_add_u32 v5, s59, v2
  v_add_u32 v6, s86, v5
  v_mfma_f32_16x16x32_bf16 v[20:23], a[168:171], v[100:103], 0
  s_add_u32 s78, s78, 65536
  v_cmp_lt_u32 vcc, 255, v6
  v_mfma_f32_16x16x32_bf16 v[24:27], a[172:175], v[100:103], 0
  buffer_load_dwordx4 v[128:131], v248, s[40:43], s78 offen sc1
  v_cndmask_b32 v190, v248, v61, vcc
  s_waitcnt vmcnt(7)
  v_mfma_f32_16x16x32_bf16 v[8:11], a[176:179], v[104:107], v[8:11]
  v_add_u32 v6, s87, v5
  s_add_u32 s78, s78, 65536
  v_mfma_f32_16x16x32_bf16 v[12:15], a[180:183], v[104:107], v[12:15]
  v_cmp_lt_u32 vcc, 255, v6
  s_nop 1
  v_cndmask_b32 v191, v248, v61, vcc
  v_mfma_f32_16x16x32_bf16 v[16:19], a[184:187], v[104:107], v[16:19]
  buffer_load_dwordx4 v[132:135], v248, s[40:43], s78 offen sc1
  v_add_u32 v6, s88, v5
  v_mfma_f32_16x16x32_bf16 v[20:23], a[188:191], v[104:107], v[20:23]
  s_add_u32 s78, s78, 65536
  v_cmp_lt_u32 vcc, 255, v6
  v_mfma_f32_16x16x32_bf16 v[24:27], a[192:195], v[104:107], v[24:27]
  s_nop 0
  v_cndmask_b32 v192, v248, v61, vcc
  buffer_load_dwordx4 v[136:139], v248, s[40:43], s78 offen sc1
  s_waitcnt vmcnt(8)
  v_mfma_f32_16x16x32_bf16 v[8:11], a[196:199], v[108:111], v[8:11]
  v_add_u32 v6, s89, v5
  v_cmp_lt_u32 vcc, 255, v6
  v_mfma_f32_16x16x32_bf16 v[12:15], a[200:203], v[108:111], v[12:15]
  s_mul_i32 s78, s84, 256
  v_cndmask_b32 v193, v248, v61, vcc
  v_mfma_f32_16x16x32_bf16 v[16:19], a[204:207], v[108:111], v[16:19]
  s_add_u32 s78, s78, s80
  s_add_u32 s78, s78, 327680
  v_add_u32 v6, s90, v5
  v_mfma_f32_16x16x32_bf16 v[20:23], a[208:211], v[108:111], v[20:23]
  v_cmp_lt_u32 vcc, 255, v6
  buffer_load_dwordx4 v[140:143], v248, s[40:43], s78 offen sc1
  v_mfma_f32_16x16x32_bf16 v[24:27], a[212:215], v[108:111], v[24:27]
  v_cndmask_b32 v194, v248, v61, vcc
  s_add_u32 s59, s79, s85
  s_waitcnt vmcnt(8)
  v_mfma_f32_16x16x32_bf16 v[8:11], a[216:219], v[112:115], v[8:11]
  s_add_u32 s78, s78, 65536
  s_lshl_b32 s59, s59, 4
  v_mfma_f32_16x16x32_bf16 v[12:15], a[220:223], v[112:115], v[12:15]
  buffer_load_dwordx4 v[144:147], v248, s[40:43], s78 offen sc1
  v_add_u32 v5, s59, v2
  v_mfma_f32_16x16x32_bf16 v[16:19], a[224:227], v[112:115], v[16:19]
  v_add_u32 v6, s86, v5
  s_add_u32 s78, s78, 65536
  v_mfma_f32_16x16x32_bf16 v[20:23], a[228:231], v[112:115], v[20:23]
  v_cmp_lt_u32 vcc, 255, v6
  s_nop 1
  v_cndmask_b32 v195, v248, v61, vcc
  v_mfma_f32_16x16x32_bf16 v[24:27], a[232:235], v[112:115], v[24:27]
  buffer_load_dwordx4 v[148:151], v248, s[40:43], s78 offen sc1
  v_add_u32 v6, s87, v5
  s_waitcnt vmcnt(9)
  v_mfma_f32_16x16x32_bf16 v[8:11], a[236:239], v[116:119], v[8:11]
  s_add_u32 s78, s78, 65536
  v_cmp_lt_u32 vcc, 255, v6
  v_mfma_f32_16x16x32_bf16 v[12:15], a[240:243], v[116:119], v[12:15]
  s_nop 0
  v_cndmask_b32 v196, v248, v61, vcc
  buffer_load_dwordx4 v[152:155], v248, s[40:43], s78 offen sc1
  v_mfma_f32_16x16x32_bf16 v[16:19], a[244:247], v[116:119], v[16:19]
  v_add_u32 v6, s88, v5
  v_cmp_lt_u32 vcc, 255, v6
  v_mfma_f32_16x16x32_bf16 v[20:23], a[248:251], v[116:119], v[20:23]
  s_add_u32 s78, s78, 65536
  v_cndmask_b32 v197, v248, v61, vcc
  v_mfma_f32_16x16x32_bf16 v[24:27], a[252:255], v[116:119], v[24:27]
  buffer_load_dwordx4 v[156:159], v248, s[40:43], s78 offen sc1
  v_add_u32 v6, s89, v5
  s_waitcnt vmcnt(10)
  v_mfma_f32_16x16x32_bf16 v[28:31], a[156:159], v[120:123], 0
  v_cmp_lt_u32 vcc, 255, v6
  s_mul_i32 s78, s85, 256
  v_mfma_f32_16x16x32_bf16 v[32:35], a[160:163], v[120:123], 0
  v_cndmask_b32 v198, v248, v61, vcc
  v_add_u32 v6, s90, v5
  v_mfma_f32_16x16x32_bf16 v[36:39], a[164:167], v[120:123], 0
  ds_write_b128 v253, v[8:11] offset:0
  v_mfma_f32_16x16x32_bf16 v[40:43], a[168:171], v[120:123], 0
  s_add_u32 s78, s78, s80
  s_add_u32 s78, s78, 327680
  v_cmp_lt_u32 vcc, 255, v6
  v_mfma_f32_16x16x32_bf16 v[44:47], a[172:175], v[120:123], 0
  buffer_load_dwordx4 v[160:163], v248, s[40:43], s78 offen sc1
  v_cndmask_b32 v199, v248, v61, vcc
  s_waitcnt vmcnt(9)
  v_mfma_f32_16x16x32_bf16 v[28:31], a[176:179], v[124:127], v[28:31]
  ds_write_b128 v253, v[12:15] offset:1024
  v_mfma_f32_16x16x32_bf16 v[32:35], a[180:183], v[124:127], v[32:35]
  s_add_u32 s78, s78, 65536
  v_mfma_f32_16x16x32_bf16 v[36:39], a[184:187], v[124:127], v[36:39]
  v_add_f32 v54, v54, v56
  v_add_f32 v55, v55, v57
  v_mfma_f32_16x16x32_bf16 v[40:43], a[188:191], v[124:127], v[40:43]
  ds_write_b128 v253, v[16:19] offset:2048
  v_mfma_f32_16x16x32_bf16 v[44:47], a[192:195], v[124:127], v[44:47]
  buffer_load_dwordx4 v[164:167], v248, s[40:43], s78 offen sc1
  v_permlane32_swap_b32 v54, v55
  s_waitcnt vmcnt(9)
  v_mfma_f32_16x16x32_bf16 v[28:31], a[196:199], v[128:131], v[28:31]
  s_add_u32 s78, s78, 65536
  v_add_f32 v54, v54, v55
  v_mfma_f32_16x16x32_bf16 v[32:35], a[200:203], v[128:131], v[32:35]
  ds_write_b128 v253, v[20:23] offset:3072
  v_mfma_f32_16x16x32_bf16 v[36:39], a[204:207], v[128:131], v[36:39]
  v_mov_b32 v55, v54
  buffer_load_dwordx4 v[168:171], v248, s[40:43], s78 offen sc1
  v_mfma_f32_16x16x32_bf16 v[40:43], a[208:211], v[128:131], v[40:43]
  v_permlane16_swap_b32 v54, v55
  v_add_f32 v54, v54, v55
  v_mfma_f32_16x16x32_bf16 v[44:47], a[212:215], v[128:131], v[44:47]
  ds_write_b128 v253, v[24:27] offset:4096
  s_waitcnt vmcnt(9)
  v_mfma_f32_16x16x32_bf16 v[28:31], a[216:219], v[132:135], v[28:31]
  s_add_u32 s78, s78, 65536
  v_mov_b32 v55, v54
  v_mfma_f32_16x16x32_bf16 v[32:35], a[220:223], v[132:135], v[32:35]
  buffer_load_dwordx4 v[172:175], v248, s[40:43], s78 offen sc1
  v_permlane32_swap_b32 v54, v55
  v_mfma_f32_16x16x32_bf16 v[36:39], a[224:227], v[132:135], v[36:39]
  v_mul_f32 v246, 0x3acccccd, v54
  s_add_u32 s78, s78, 65536
  v_mfma_f32_16x16x32_bf16 v[40:43], a[228:231], v[132:135], v[40:43]
  v_mul_f32 v58, 0x3acccccd, v55
  v_fma_f32 v58, -v246, v246, v58
  v_mfma_f32_16x16x32_bf16 v[44:47], a[232:235], v[132:135], v[44:47]
  buffer_load_dwordx4 v[176:179], v248, s[40:43], s78 offen sc1
  v_max_f32 v58, 0, v58
  s_waitcnt vmcnt(10)
  v_mfma_f32_16x16x32_bf16 v[28:31], a[236:239], v[136:139], v[28:31]
  s_lshl_b32 s91, s57, 9
  v_add_f32 v59, 0x3727c5ac, v58
  v_mfma_f32_16x16x32_bf16 v[32:35], a[240:243], v[136:139], v[32:35]
  v_rsq_f32 v247, v59
  s_add_u32 s91, s91, 28327936
  v_mfma_f32_16x16x32_bf16 v[36:39], a[244:247], v[136:139], v[36:39]
  v_mul_f32 v59, v247, v247
  v_lshlrev_b32 v63, 4, v3
  v_mfma_f32_16x16x32_bf16 v[40:43], a[248:251], v[136:139], v[40:43]
  v_mul_f32 v59, v59, v58
  buffer_load_dwordx4 v[84:87], v63, s[40:43], s91 offen offset:0 sc1
  v_mfma_f32_16x16x32_bf16 v[44:47], a[252:255], v[136:139], v[44:47]
  v_add_f32 v59, 0x3727c5ac, v59
  buffer_load_dwordx4 v[88:91], v63, s[40:43], s91 offen offset:64 sc1
  s_waitcnt vmcnt(11)
  v_mfma_f32_16x16x32_bf16 v[8:11], a[156:159], v[140:143], 0
  v_rsq_f32 v59, v59
  buffer_load_dwordx4 v[92:95], v63, s[40:43], s91 offen offset:128 sc1
  v_mfma_f32_16x16x32_bf16 v[12:15], a[160:163], v[140:143], 0
  v_mul_f32 v59, v59, v247
  buffer_load_dwordx4 v[96:99], v63, s[40:43], s91 offen offset:192 sc1
  v_mfma_f32_16x16x32_bf16 v[16:19], a[164:167], v[140:143], 0
  ds_write_b128 v254, v[28:31] offset:0
  v_mfma_f32_16x16x32_bf16 v[20:23], a[168:171], v[140:143], 0
  v_sub_f32 v54, 0, v246
  buffer_load_dwordx4 v[48:51], v63, s[40:43], s91 offen offset:256 sc1
  v_mfma_f32_16x16x32_bf16 v[24:27], a[172:175], v[140:143], 0
  v_sub_f32 v55, 0, v246
  s_add_u32 s47, s46, 327680
  s_waitcnt vmcnt(13)
  v_mfma_f32_16x16x32_bf16 v[8:11], a[176:179], v[144:147], v[8:11]
  ds_write_b128 v254, v[32:35] offset:1024
  v_mfma_f32_16x16x32_bf16 v[12:15], a[180:183], v[144:147], v[12:15]
  v_mul_f32 v200, 0xc0135761, v59
  buffer_load_dwordx4 a[40:43], v4, s[40:43], s47 offen offset:0 sc1
  v_mfma_f32_16x16x32_bf16 v[16:19], a[184:187], v[144:147], v[16:19]
  v_mul_f32 v202, v59, v59
  v_rcp_f32 v204, v59
  v_mfma_f32_16x16x32_bf16 v[20:23], a[188:191], v[144:147], v[20:23]
  ds_write_b128 v254, v[36:39] offset:2048
  v_mfma_f32_16x16x32_bf16 v[24:27], a[192:195], v[144:147], v[24:27]
  buffer_load_dwordx4 a[44:47], v4, s[40:43], s47 offen offset:1024 sc1
  v_mul_f32 v202, v202, v59
  s_waitcnt vmcnt(14)
  v_mfma_f32_16x16x32_bf16 v[8:11], a[196:199], v[148:151], v[8:11]
  buffer_load_dwordx4 a[48:51], v4, s[40:43], s47 offen offset:2048 sc1
  v_mul_f32 v202, 0xbdd2d3e8, v202
  v_mfma_f32_16x16x32_bf16 v[12:15], a[200:203], v[148:151], v[12:15]
  ds_write_b128 v254, v[40:43] offset:3072
  v_mfma_f32_16x16x32_bf16 v[16:19], a[204:207], v[148:151], v[16:19]
  buffer_load_dwordx4 a[52:55], v4, s[40:43], s47 offen offset:3072 sc1
  v_mov_b32 v201, v200
  v_mfma_f32_16x16x32_bf16 v[20:23], a[208:211], v[148:151], v[20:23]
  s_add_u32 s47, s46, 331776
  v_mov_b32 v203, v202
  v_mfma_f32_16x16x32_bf16 v[24:27], a[212:215], v[148:151], v[24:27]
  ds_write_b128 v254, v[44:47] offset:4096
  s_waitcnt vmcnt(15)
  v_mfma_f32_16x16x32_bf16 v[8:11], a[216:219], v[152:155], v[8:11]
  buffer_load_dwordx4 a[56:59], v4, s[40:43], s47 offen offset:0 sc1
  v_mov_b32 v205, v204
  v_mfma_f32_16x16x32_bf16 v[12:15], a[220:223], v[152:155], v[12:15]
  s_add_u32 s47, s46, 491520
  s_lshl_b32 s58, s54, 2
  s_add_u32 s58, s58, s52
  s_mul_i32 s58, s58, 1792
  s_mul_i32 s59, s53, 1310720
  s_add_u32 s58, s58, s59
  s_add_u32 s58, s58, 983040
  v_lshlrev_b32 v5, 7, v1
  s_mov_b64 exec, 0x3fff
  buffer_load_dword v244, v5, s[40:43], s58 offen sc1
  s_mov_b64 exec, -1
  v_mfma_f32_16x16x32_bf16 v[16:19], a[224:227], v[152:155], v[16:19]
  buffer_load_dwordx4 a[60:63], v4, s[40:43], s47 offen offset:0 sc1
  s_lshr_b32 s59, s57, 2
  v_mfma_f32_16x16x32_bf16 v[20:23], a[228:231], v[152:155], v[20:23]
  buffer_load_dwordx4 a[64:67], v4, s[40:43], s47 offen offset:1024 sc1
  s_add_u32 s59, s59, 1
  v_mfma_f32_16x16x32_bf16 v[24:27], a[232:235], v[152:155], v[24:27]
  s_bfe_u32 s60, s57, 0x10001
  s_mul_i32 s60, s60, s59
  s_waitcnt vmcnt(18)
  v_mfma_f32_16x16x32_bf16 v[8:11], a[236:239], v[156:159], v[8:11]
  s_lshl_b32 s60, s60, 1
  s_sub_u32 s59, s59, s60
  v_mfma_f32_16x16x32_bf16 v[12:15], a[240:243], v[156:159], v[12:15]
  v_add_u32 v5, s59, v2
  s_lshl_b32 s59, s59, 4
  v_mfma_f32_16x16x32_bf16 v[16:19], a[244:247], v[156:159], v[16:19]
  s_add_u32 s59, s59, 64
  v_add_u32 v7, s59, v248
  v_mfma_f32_16x16x32_bf16 v[20:23], a[248:251], v[156:159], v[20:23]
  s_and_b32 s60, s56, 15
  s_lshl_b32 s60, s60, 4
  v_mfma_f32_16x16x32_bf16 v[24:27], a[252:255], v[156:159], v[24:27]
  v_add_u32 v5, s60, v5
  v_mov_b32 v207, 2147483648
  s_waitcnt vmcnt(17)
  v_mfma_f32_16x16x32_bf16 v[64:67], a[156:159], v[160:163], 0
  v_cmp_gt_u32 vcc, 256, v5
  s_nop 1
  v_cndmask_b32 v206, v207, v7, vcc
  v_mfma_f32_16x16x32_bf16 v[68:71], a[160:163], v[160:163], 0
  v_cndmask_b32 v207, v7, v207, vcc
  s_lshl_b32 s60, s53, 8
  v_mfma_f32_16x16x32_bf16 v[72:75], a[164:167], v[160:163], 0
  ds_write_b128 v255, v[8:11] offset:0
  v_mfma_f32_16x16x32_bf16 v[76:79], a[168:171], v[160:163], 0
  v_add_u32 v5, s60, v5
  v_mov_b32 v7, 2147483648
  v_mfma_f32_16x16x32_bf16 v[80:83], a[172:175], v[160:163], 0
  v_cmp_lt_u32 vcc, 2047, v5
  s_nop 1
  v_cndmask_b32 v207, v207, v7, vcc
  s_waitcnt vmcnt(16)
  v_mfma_f32_16x16x32_bf16 v[64:67], a[176:179], v[164:167], v[64:67]
  ds_write_b128 v255, v[12:15] offset:1024
  v_mfma_f32_16x16x32_bf16 v[68:71], a[180:183], v[164:167], v[68:71]
  v_mfma_f32_16x16x32_bf16 v[72:75], a[184:187], v[164:167], v[72:75]
  v_mfma_f32_16x16x32_bf16 v[76:79], a[188:191], v[164:167], v[76:79]
  ds_write_b128 v255, v[16:19] offset:2048
  v_mfma_f32_16x16x32_bf16 v[80:83], a[192:195], v[164:167], v[80:83]
  s_waitcnt vmcnt(15)
  v_mfma_f32_16x16x32_bf16 v[64:67], a[196:199], v[168:171], v[64:67]
  v_mfma_f32_16x16x32_bf16 v[68:71], a[200:203], v[168:171], v[68:71]
  ds_write_b128 v255, v[20:23] offset:3072
  v_mfma_f32_16x16x32_bf16 v[72:75], a[204:207], v[168:171], v[72:75]
  v_mfma_f32_16x16x32_bf16 v[76:79], a[208:211], v[168:171], v[76:79]
  v_mfma_f32_16x16x32_bf16 v[80:83], a[212:215], v[168:171], v[80:83]
  ds_write_b128 v255, v[24:27] offset:4096
  s_waitcnt vmcnt(14)
  v_mfma_f32_16x16x32_bf16 v[64:67], a[216:219], v[172:175], v[64:67]
  v_mfma_f32_16x16x32_bf16 v[68:71], a[220:223], v[172:175], v[68:71]
  v_mfma_f32_16x16x32_bf16 v[72:75], a[224:227], v[172:175], v[72:75]
  s_waitcnt lgkmcnt(0)
  s_barrier
  ds_read_b128 v[100:103], v219 offset:0
  v_mfma_f32_16x16x32_bf16 v[76:79], a[228:231], v[172:175], v[76:79]
  ds_read_b128 v[104:107], v219 offset:1024
  v_mfma_f32_16x16x32_bf16 v[80:83], a[232:235], v[172:175], v[80:83]
  ds_read_b128 v[108:111], v219 offset:2048
  s_waitcnt vmcnt(13)
  v_mfma_f32_16x16x32_bf16 v[64:67], a[236:239], v[176:179], v[64:67]
  ds_read_b128 v[112:115], v219 offset:3072
  v_mfma_f32_16x16x32_bf16 v[68:71], a[240:243], v[176:179], v[68:71]
  ds_read_b128 v[116:119], v219 offset:4096
  v_mfma_f32_16x16x32_bf16 v[72:75], a[244:247], v[176:179], v[72:75]
  ds_read_b128 v[120:123], v219 offset:5120
  v_mfma_f32_16x16x32_bf16 v[76:79], a[248:251], v[176:179], v[76:79]
  ds_read_b128 v[124:127], v219 offset:6144
  v_mfma_f32_16x16x32_bf16 v[80:83], a[252:255], v[176:179], v[80:83]
  ds_read_b128 v[128:131], v219 offset:7168
  ds_read_b128 v[132:135], v219 offset:8192
  ds_read_b128 v[136:139], v219 offset:9216
  ds_read_b128 v[140:143], v219 offset:10240
  ds_read_b128 v[144:147], v219 offset:11264
  ds_read_b128 v[148:151], v219 offset:12288
  ds_read_b128 v[152:155], v219 offset:13312
  ds_read_b128 v[156:159], v219 offset:14336
  s_waitcnt lgkmcnt(10)
  v_pk_add_f32 v[64:65], v[64:65], v[100:101]
  v_pk_add_f32 v[66:67], v[66:67], v[102:103]
  v_pk_add_f32 v[68:69], v[68:69], v[104:105]
  v_pk_add_f32 v[70:71], v[70:71], v[106:107]
  v_pk_add_f32 v[72:73], v[72:73], v[108:109]
  v_pk_add_f32 v[74:75], v[74:75], v[110:111]
  v_pk_add_f32 v[76:77], v[76:77], v[112:113]
  v_pk_add_f32 v[78:79], v[78:79], v[114:115]
  v_pk_add_f32 v[80:81], v[80:81], v[116:117]
  v_pk_add_f32 v[82:83], v[82:83], v[118:119]
  s_waitcnt lgkmcnt(5)
  v_pk_add_f32 v[64:65], v[64:65], v[120:121]
  v_pk_add_f32 v[66:67], v[66:67], v[122:123]
  v_pk_add_f32 v[68:69], v[68:69], v[124:125]
  v_pk_add_f32 v[70:71], v[70:71], v[126:127]
  v_pk_add_f32 v[72:73], v[72:73], v[128:129]
  v_pk_add_f32 v[74:75], v[74:75], v[130:131]
  v_pk_add_f32 v[76:77], v[76:77], v[132:133]
  v_pk_add_f32 v[78:79], v[78:79], v[134:135]
  v_pk_add_f32 v[80:81], v[80:81], v[136:137]
  v_pk_add_f32 v[82:83], v[82:83], v[138:139]
  s_waitcnt lgkmcnt(0)
  v_pk_add_f32 v[64:65], v[64:65], v[140:141]
  v_pk_add_f32 v[66:67], v[66:67], v[142:143]
  v_pk_add_f32 v[68:69], v[68:69], v[144:145]
  v_pk_add_f32 v[70:71], v[70:71], v[146:147]
  v_pk_add_f32 v[72:73], v[72:73], v[148:149]
  v_pk_add_f32 v[74:75], v[74:75], v[150:151]
  v_pk_add_f32 v[76:77], v[76:77], v[152:153]
  v_pk_add_f32 v[78:79], v[78:79], v[154:155]
  v_pk_add_f32 v[80:81], v[80:81], v[156:157]
  v_pk_add_f32 v[82:83], v[82:83], v[158:159]
  s_waitcnt vmcnt(8)
  v_pk_fma_f32 v[64:65], v[54:55], v[84:85], v[64:65]
  v_pk_fma_f32 v[66:67], v[54:55], v[86:87], v[66:67]
  v_pk_fma_f32 v[68:69], v[54:55], v[88:89], v[68:69]
  v_pk_fma_f32 v[70:71], v[54:55], v[90:91], v[70:71]
  v_pk_fma_f32 v[72:73], v[54:55], v[92:93], v[72:73]
  v_pk_fma_f32 v[74:75], v[54:55], v[94:95], v[74:75]
  v_pk_fma_f32 v[76:77], v[54:55], v[96:97], v[76:77]
  v_pk_fma_f32 v[78:79], v[54:55], v[98:99], v[78:79]
  v_pk_fma_f32 v[80:81], v[54:55], v[48:49], v[80:81]
  v_pk_fma_f32 v[82:83], v[54:55], v[50:51], v[82:83]
  v_pk_mul_f32 v[100:101], v[64:65], v[64:65]
  v_pk_mul_f32 v[102:103], v[66:67], v[66:67]
  v_pk_mul_f32 v[104:105], v[68:69], v[68:69]
  v_pk_mul_f32 v[106:107], v[70:71], v[70:71]
  v_pk_mul_f32 v[108:109], v[72:73], v[72:73]
  v_pk_mul_f32 v[110:111], v[74:75], v[74:75]
  v_pk_mul_f32 v[112:113], v[76:77], v[76:77]
  v_pk_mul_f32 v[114:115], v[78:79], v[78:79]
  v_pk_mul_f32 v[116:117], v[80:81], v[80:81]
  v_pk_mul_f32 v[118:119], v[82:83], v[82:83]
  v_pk_fma_f32 v[100:101], v[100:101], v[202:203], v[200:201]
  v_pk_fma_f32 v[102:103], v[102:103], v[202:203], v[200:201]
  v_pk_fma_f32 v[104:105], v[104:105], v[202:203], v[200:201]
  v_pk_fma_f32 v[106:107], v[106:107], v[202:203], v[200:201]
  v_pk_fma_f32 v[108:109], v[108:109], v[202:203], v[200:201]
  v_pk_fma_f32 v[110:111], v[110:111], v[202:203], v[200:201]
  v_pk_fma_f32 v[112:113], v[112:113], v[202:203], v[200:201]
  v_pk_fma_f32 v[114:115], v[114:115], v[202:203], v[200:201]
  v_pk_fma_f32 v[116:117], v[116:117], v[202:203], v[200:201]
  v_pk_fma_f32 v[118:119], v[118:119], v[202:203], v[200:201]
  v_pk_mul_f32 v[100:101], v[100:101], v[64:65]
  v_pk_mul_f32 v[102:103], v[102:103], v[66:67]
  v_pk_mul_f32 v[104:105], v[104:105], v[68:69]
  v_pk_mul_f32 v[106:107], v[106:107], v[70:71]
  v_pk_mul_f32 v[108:109], v[108:109], v[72:73]
  v_pk_mul_f32 v[110:111], v[110:111], v[74:75]
  v_pk_mul_f32 v[112:113], v[112:113], v[76:77]
  v_pk_mul_f32 v[114:115], v[114:115], v[78:79]
  v_pk_mul_f32 v[116:117], v[116:117], v[80:81]
  v_pk_mul_f32 v[118:119], v[118:119], v[82:83]
  v_exp_f32 v100, v100
  v_exp_f32 v101, v101
  v_exp_f32 v102, v102
  v_exp_f32 v103, v103
  v_exp_f32 v104, v104
  v_exp_f32 v105, v105
  v_exp_f32 v106, v106
  v_exp_f32 v107, v107
  v_exp_f32 v108, v108
  v_exp_f32 v109, v109
  v_exp_f32 v110, v110
  v_exp_f32 v111, v111
  v_exp_f32 v112, v112
  v_exp_f32 v113, v113
  v_exp_f32 v114, v114
  v_exp_f32 v115, v115
  v_exp_f32 v116, v116
  v_exp_f32 v117, v117
  v_exp_f32 v118, v118
  v_exp_f32 v119, v119
  v_pk_fma_f32 v[100:101], v[100:101], v[204:205], v[204:205]
  v_pk_fma_f32 v[102:103], v[102:103], v[204:205], v[204:205]
  v_pk_fma_f32 v[104:105], v[104:105], v[204:205], v[204:205]
  v_pk_fma_f32 v[106:107], v[106:107], v[204:205], v[204:205]
  v_pk_fma_f32 v[108:109], v[108:109], v[204:205], v[204:205]
  v_pk_fma_f32 v[110:111], v[110:111], v[204:205], v[204:205]
  v_pk_fma_f32 v[112:113], v[112:113], v[204:205], v[204:205]
  v_pk_fma_f32 v[114:115], v[114:115], v[204:205], v[204:205]
  v_pk_fma_f32 v[116:117], v[116:117], v[204:205], v[204:205]
  v_pk_fma_f32 v[118:119], v[118:119], v[204:205], v[204:205]
  v_rcp_f32 v100, v100
  v_rcp_f32 v101, v101
  v_rcp_f32 v102, v102
  v_rcp_f32 v103, v103
  v_rcp_f32 v104, v104
  v_rcp_f32 v105, v105
  v_rcp_f32 v106, v106
  v_rcp_f32 v107, v107
  v_rcp_f32 v108, v108
  v_rcp_f32 v109, v109
  v_rcp_f32 v110, v110
  v_rcp_f32 v111, v111
  v_rcp_f32 v112, v112
  v_rcp_f32 v113, v113
  v_rcp_f32 v114, v114
  v_rcp_f32 v115, v115
  v_rcp_f32 v116, v116
  v_rcp_f32 v117, v117
  v_rcp_f32 v118, v118
  v_rcp_f32 v119, v119
  v_pk_mul_f32 v[100:101], v[100:101], v[64:65]
  v_pk_mul_f32 v[102:103], v[102:103], v[66:67]
  v_pk_mul_f32 v[104:105], v[104:105], v[68:69]
  v_pk_mul_f32 v[106:107], v[106:107], v[70:71]
  v_pk_mul_f32 v[108:109], v[108:109], v[72:73]
  v_pk_mul_f32 v[110:111], v[110:111], v[74:75]
  v_pk_mul_f32 v[112:113], v[112:113], v[76:77]
  v_pk_mul_f32 v[114:115], v[114:115], v[78:79]
  v_pk_mul_f32 v[116:117], v[116:117], v[80:81]
  v_pk_mul_f32 v[118:119], v[118:119], v[82:83]
  v_cvt_pk_bf16_f32 v84, v100, v101
  v_cvt_pk_bf16_f32 v85, v102, v103
  v_cvt_pk_bf16_f32 v86, v104, v105
  v_cvt_pk_bf16_f32 v87, v106, v107
  v_cvt_pk_bf16_f32 v88, v108, v109
  v_cvt_pk_bf16_f32 v89, v110, v111
  v_cvt_pk_bf16_f32 v90, v112, v113
  v_cvt_pk_bf16_f32 v91, v114, v115
  v_cvt_pk_bf16_f32 v92, v116, v117
  v_cvt_pk_bf16_f32 v93, v118, v119
  s_add_u32 s63, s44, 655296
  s_add_u32 s62, s63, s64
  s_add_u32 s63, s63, s65
  s_add_u32 s61, s62, 16384
  s_cmp_eq_u32 s55, 0
  s_cbranch_scc1 Lsafe_31
  buffer_store_dwordx4 v[84:87], v206, s[40:43], s62 offen
  buffer_store_dwordx4 v[88:91], v206, s[40:43], s61 offen
  buffer_store_dwordx2 v[92:93], v206, s[40:43], s63 offen
  s_branch Ljoin_32
Lsafe_31:
  buffer_store_dwordx4 v[84:87], v206, s[40:43], s62 offen sc1
  buffer_store_dwordx4 v[88:91], v206, s[40:43], s61 offen sc1
  buffer_store_dwordx2 v[92:93], v206, s[40:43], s63 offen sc1
Ljoin_32:
  s_add_u32 s58, s56, 1
  s_and_b32 s58, s58, 15
  s_cmp_gt_u32 s58, 1
  s_cselect_b32 s70, 0, 1
  s_cbranch_scc1 Lnohalo_33
  s_mul_i32 s59, s53, 327680
  s_mul_i32 s58, s58, 651008
  s_sub_u32 s59, s59, s58
  s_add_u32 s63, s59, 10813120
  s_add_u32 s62, s63, s64
  s_add_u32 s63, s63, s65
  s_add_u32 s61, s62, 16384
  buffer_store_dwordx4 v[84:87], v207, s[40:43], s62 offen sc1
  buffer_store_dwordx4 v[88:91], v207, s[40:43], s61 offen sc1
  buffer_store_dwordx2 v[92:93], v207, s[40:43], s63 offen sc1
  s_waitcnt vmcnt(3)
  s_add_u32 s58, s67, 28356608
  v_mov_b32 v6, s3
  s_mov_b64 exec, 1
  s_cmp_eq_u32 s55, 0
  s_cbranch_scc1 Lsafe_34
  buffer_store_dword v6, v251, s[40:43], s58 offen
  s_branch Ljoin_35
Lsafe_34:
  buffer_store_dword v6, v251, s[40:43], s58 offen sc1
Ljoin_35:
  s_mov_b64 exec, -1
Lnohalo_33:
  s_and_b32 s59, s56, 0x7c
  v_lshrrev_b32 v5, 3, v1
  v_and_b32 v6, 3, v5
  v_cmp_eq_u32 vcc, 4, v5
  s_nop 1
  v_cndmask_b32 v6, v6, -1, vcc
  v_cmp_eq_u32 vcc, 5, v5
  s_nop 1
  v_cndmask_b32 v6, v6, 4, vcc
  v_add_u32 v6, s59, v6
  v_mov_b32 v7, s56
  v_xor_b32 v5, s56, v6
  v_cmp_lt_u32 vcc, 15, v5
  s_nop 1
  v_cndmask_b32 v6, v6, v7, vcc
  v_lshlrev_b32 v6, 5, v6
  v_and_b32 v5, 7, v1
  v_lshl_add_u32 v60, v5, 2, v6
  v_add_u32 v60, 28356608, v60
  s_and_b32 s59, s56, 0x7c
  v_lshrrev_b32 v5, 3, v1
  v_and_b32 v6, 3, v5
  v_cmp_eq_u32 vcc, 4, v5
  s_nop 1
  v_cndmask_b32 v6, v6, -1, vcc
  v_cmp_eq_u32 vcc, 5, v5
  s_nop 1
  v_cndmask_b32 v6, v6, 4, vcc
  v_add_u32 v6, s59, v6
  v_mov_b32 v7, s56
  v_cmp_lt_u32 vcc, 127, v6
  s_nop 1
  v_cndmask_b32 v6, v6, v7, vcc
  v_xor_b32 v7, s56, v6
  v_lshlrev_b32 v6, 5, v6
  v_and_b32 v5, 7, v1
  v_lshl_add_u32 v59, v5, 2, v6
  v_lshlrev_b32 v5, 5, v59
  v_add_u32 v5, 21069824, v5
  v_add_u32 v59, 28356608, v59
  v_cmp_lt_u32 vcc, 15, v7
  s_nop 1
  v_cndmask_b32 v59, v59, v5, vcc
  s_waitcnt vmcnt(0)
  s_cmp_eq_u32 s70, 1
  s_cbranch_scc1 Lhf_36
  s_add_u32 s58, s67, 28356608
  v_mov_b32 v6, s3
  s_mov_b64 exec, 1
  s_cmp_eq_u32 s55, 0
  s_cbranch_scc1 Lsafe_38
  buffer_store_dword v6, v251, s[40:43], s58 offen
  s_branch Ljoin_39
Lsafe_38:
  buffer_store_dword v6, v251, s[40:43], s58 offen sc1
Ljoin_39:
  s_mov_b64 exec, -1
  s_branch Lhf_37
Lhf_36:
  s_lshl_b32 s58, s67, 5
  s_add_u32 s58, s58, 21069824
  v_mov_b32 v240, s3
  v_mov_b32 v241, s51
  v_mov_b32 v242, s3
  v_mov_b32 v243, s51
  s_mov_b64 exec, 0xff
  buffer_store_dwordx4 v[240:243], v4, s[40:43], s58 offen sc1
  s_mov_b64 exec, -1
  s_nop 0
Lhf_37:
  buffer_load_dwordx4 a[68:71], v4, s[40:43], s47 offen offset:2048 sc1
  buffer_load_dwordx4 a[72:75], v4, s[40:43], s47 offen offset:3072 sc1
  s_add_u32 s47, s46, 495616
  buffer_load_dwordx4 a[76:79], v4, s[40:43], s47 offen offset:0 sc1
  s_add_u32 s47, s46, 655360
  buffer_load_dwordx4 a[80:83], v4, s[40:43], s47 offen offset:0 sc1
  buffer_load_dwordx4 a[84:87], v4, s[40:43], s47 offen offset:1024 sc1
  buffer_load_dwordx4 a[88:91], v4, s[40:43], s47 offen offset:2048 sc1
  buffer_load_dwordx4 a[92:95], v4, s[40:43], s47 offen offset:3072 sc1
  s_add_u32 s47, s46, 659456
  buffer_load_dwordx4 a[96:99], v4, s[40:43], s47 offen offset:0 sc1
  v_sub_f32 v8, 0, v246
  v_sub_f32 v9, 0, v246
  v_mov_b32 v10, v247
  v_mov_b32 v11, v247
  v_pk_add_f32 v[64:65], v[220:221], v[8:9]
  v_pk_add_f32 v[66:67], v[222:223], v[8:9]
  v_pk_add_f32 v[68:69], v[224:225], v[8:9]
  v_pk_add_f32 v[70:71], v[226:227], v[8:9]
  v_pk_add_f32 v[72:73], v[228:229], v[8:9]
  v_pk_add_f32 v[74:75], v[230:231], v[8:9]
  v_pk_add_f32 v[76:77], v[232:233], v[8:9]
  v_pk_add_f32 v[78:79], v[234:235], v[8:9]
  v_pk_add_f32 v[80:81], v[236:237], v[8:9]
  v_pk_add_f32 v[82:83], v[238:239], v[8:9]
  v_pk_mul_f32 v[64:65], v[64:65], v[10:11]
  v_pk_mul_f32 v[66:67], v[66:67], v[10:11]
  v_pk_mul_f32 v[68:69], v[68:69], v[10:11]
  v_pk_mul_f32 v[70:71], v[70:71], v[10:11]
  v_pk_mul_f32 v[72:73], v[72:73], v[10:11]
  v_pk_mul_f32 v[74:75], v[74:75], v[10:11]
  v_pk_mul_f32 v[76:77], v[76:77], v[10:11]
  v_pk_mul_f32 v[78:79], v[78:79], v[10:11]
  v_pk_mul_f32 v[80:81], v[80:81], v[10:11]
  v_pk_mul_f32 v[82:83], v[82:83], v[10:11]
  s_mov_b32 s48, 0
  s_nop 0
Lpoll_40:
  buffer_load_dword v240, v60, s[40:43], 0 offen sc1
  s_add_u32 s48, s48, 1
  s_cmp_gt_u32 s48, 0x40000
  s_cbranch_scc1 Lend
  s_waitcnt vmcnt(0)
  v_cmp_ne_u32 vcc, s3, v240
  s_nop 4
  s_cbranch_vccnz Lpoll_40
  s_mul_i32 s78, s82, 256
  s_add_u32 s78, s78, s80
  s_add_u32 s78, s78, 655360
  buffer_load_dwordx4 v[100:103], v180, s[40:43], s78 offen sc1
  s_add_u32 s78, s78, 65536
  buffer_load_dwordx4 v[104:107], v181, s[40:43], s78 offen sc1
  s_add_u32 s78, s78, 65536
  buffer_load_dwordx4 v[108:111], v182, s[40:43], s78 offen sc1
  s_add_u32 s78, s78, 65536
  buffer_load_dwordx4 v[112:115], v183, s[40:43], s78 offen sc1
  s_add_u32 s78, s78, 65536
  buffer_load_dwordx4 v[116:119], v184, s[40:43], s78 offen sc1
  s_mul_i32 s78, s83, 256
  s_add_u32 s78, s78, s80
  s_add_u32 s78, s78, 655360
  buffer_load_dwordx4 v[120:123], v185, s[40:43], s78 offen sc1
  buffer_load_dword v58, v59, s[40:43], 0 offen sc1
  s_waitcnt vmcnt(6)
  v_mfma_f32_16x16x32_bf16 v[8:11], a[0:3], v[100:103], 0
  s_add_u32 s78, s78, 65536
  v_mfma_f32_16x16x32_bf16 v[12:15], a[4:7], v[100:103], 0
  buffer_load_dwordx4 v[124:127], v186, s[40:43], s78 offen sc1
  v_mfma_f32_16x16x32_bf16 v[16:19], a[8:11], v[100:103], 0
  v_mfma_f32_16x16x32_bf16 v[20:23], a[12:15], v[100:103], 0
  s_add_u32 s78, s78, 65536
  v_mfma_f32_16x16x32_bf16 v[24:27], a[16:19], v[100:103], 0
  buffer_load_dwordx4 v[128:131], v187, s[40:43], s78 offen sc1
  s_waitcnt vmcnt(7)
  v_mfma_f32_16x16x32_bf16 v[8:11], a[20:23], v[104:107], v[8:11]
  v_mfma_f32_16x16x32_bf16 v[12:15], a[24:27], v[104:107], v[12:15]
  s_add_u32 s78, s78, 65536
  v_mfma_f32_16x16x32_bf16 v[16:19], a[28:31], v[104:107], v[16:19]
  buffer_load_dwordx4 v[132:135], v188, s[40:43], s78 offen sc1
  v_mfma_f32_16x16x32_bf16 v[20:23], a[32:35], v[104:107], v[20:23]
  v_mfma_f32_16x16x32_bf16 v[24:27], a[36:39], v[104:107], v[24:27]
  s_add_u32 s78, s78, 65536
  s_waitcnt vmcnt(7)
  v_mfma_f32_16x16x32_bf16 v[8:11], a[40:43], v[108:111], v[8:11]
  buffer_load_dwordx4 v[136:139], v189, s[40:43], s78 offen sc1
  v_mfma_f32_16x16x32_bf16 v[12:15], a[44:47], v[108:111], v[12:15]
  v_mfma_f32_16x16x32_bf16 v[16:19], a[48:51], v[108:111], v[16:19]
  v_mfma_f32_16x16x32_bf16 v[20:23], a[52:55], v[108:111], v[20:23]
  v_mfma_f32_16x16x32_bf16 v[24:27], a[56:59], v[108:111], v[24:27]
  s_waitcnt vmcnt(7)
  v_mfma_f32_16x16x32_bf16 v[8:11], a[60:63], v[112:115], v[8:11]
  v_mfma_f32_16x16x32_bf16 v[12:15], a[64:67], v[112:115], v[12:15]
  v_mfma_f32_16x16x32_bf16 v[16:19], a[68:71], v[112:115], v[16:19]
  v_mfma_f32_16x16x32_bf16 v[20:23], a[72:75], v[112:115], v[20:23]
  v_mfma_f32_16x16x32_bf16 v[24:27], a[76:79], v[112:115], v[24:27]
  s_waitcnt vmcnt(6)
  v_mfma_f32_16x16x32_bf16 v[8:11], a[80:83], v[116:119], v[8:11]
  v_mfma_f32_16x16x32_bf16 v[12:15], a[84:87], v[116:119], v[12:15]
  v_mfma_f32_16x16x32_bf16 v[16:19], a[88:91], v[116:119], v[16:19]
  v_mfma_f32_16x16x32_bf16 v[20:23], a[92:95], v[116:119], v[20:23]
  v_mfma_f32_16x16x32_bf16 v[24:27], a[96:99], v[116:119], v[24:27]
  s_waitcnt vmcnt(4)
  v_cmp_ne_u32 vcc, s3, v58
  s_nop 4
  s_cbranch_vccz Lrm_ok
  s_mov_b32 s48, 0
Lpoll_41:
  buffer_load_dword v240, v59, s[40:43], 0 offen sc1
  s_add_u32 s48, s48, 1
  s_cmp_gt_u32 s48, 0x40000
  s_cbranch_scc1 Lend
  s_waitcnt vmcnt(0)
  v_cmp_ne_u32 vcc, s3, v240
  s_nop 4
  s_cbranch_vccnz Lpoll_41
Lrm_ok:
  v_mfma_f32_16x16x32_bf16 v[28:31], a[0:3], v[120:123], 0
  s_mul_i32 s78, s84, 256
  v_mfma_f32_16x16x32_bf16 v[32:35], a[4:7], v[120:123], 0
  s_add_u32 s78, s78, s80
  s_add_u32 s78, s78, 655360
  v_mfma_f32_16x16x32_bf16 v[36:39], a[8:11], v[120:123], 0
  ds_write_b128 v253, v[8:11] offset:0
  v_mfma_f32_16x16x32_bf16 v[40:43], a[12:15], v[120:123], 0
  buffer_load_dwordx4 v[140:143], v190, s[40:43], s78 offen sc1
  v_mfma_f32_16x16x32_bf16 v[44:47], a[16:19], v[120:123], 0
  s_add_u32 s78, s78, 65536
  s_waitcnt vmcnt(4)
  v_mfma_f32_16x16x32_bf16 v[28:31], a[20:23], v[124:127], v[28:31]
  ds_write_b128 v253, v[12:15] offset:1024
  v_mfma_f32_16x16x32_bf16 v[32:35], a[24:27], v[124:127], v[32:35]
  buffer_load_dwordx4 v[144:147], v191, s[40:43], s78 offen sc1
  v_mfma_f32_16x16x32_bf16 v[36:39], a[28:31], v[124:127], v[36:39]
  s_add_u32 s78, s78, 65536
  v_mfma_f32_16x16x32_bf16 v[40:43], a[32:35], v[124:127], v[40:43]
  ds_write_b128 v253, v[16:19] offset:2048
  v_mfma_f32_16x16x32_bf16 v[44:47], a[36:39], v[124:127], v[44:47]
  buffer_load_dwordx4 v[148:151], v192, s[40:43], s78 offen sc1
  s_waitcnt vmcnt(5)
  v_mfma_f32_16x16x32_bf16 v[28:31], a[40:43], v[128:131], v[28:31]
  s_add_u32 s78, s78, 65536
  v_mfma_f32_16x16x32_bf16 v[32:35], a[44:47], v[128:131], v[32:35]
  ds_write_b128 v253, v[20:23] offset:3072
  v_mfma_f32_16x16x32_bf16 v[36:39], a[48:51], v[128:131], v[36:39]
  buffer_load_dwordx4 v[152:155], v193, s[40:43], s78 offen sc1
  v_mfma_f32_16x16x32_bf16 v[40:43], a[52:55], v[128:131], v[40:43]
  s_add_u32 s78, s78, 65536
  v_mfma_f32_16x16x32_bf16 v[44:47], a[56:59], v[128:131], v[44:47]
  ds_write_b128 v253, v[24:27] offset:4096
  s_waitcnt vmcnt(5)
  v_mfma_f32_16x16x32_bf16 v[28:31], a[60:63], v[132:135], v[28:31]
  buffer_load_dwordx4 v[156:159], v194, s[40:43], s78 offen sc1
  v_mfma_f32_16x16x32_bf16 v[32:35], a[64:67], v[132:135], v[32:35]
  s_mul_i32 s78, s85, 256
  v_mfma_f32_16x16x32_bf16 v[36:39], a[68:71], v[132:135], v[36:39]
  s_add_u32 s78, s78, s80
  s_add_u32 s78, s78, 655360
  v_mfma_f32_16x16x32_bf16 v[40:43], a[72:75], v[132:135], v[40:43]
  buffer_load_dwordx4 v[160:163], v195, s[40:43], s78 offen sc1
  v_mfma_f32_16x16x32_bf16 v[44:47], a[76:79], v[132:135], v[44:47]
  s_add_u32 s78, s78, 65536
  s_waitcnt vmcnt(6)
  v_mfma_f32_16x16x32_bf16 v[28:31], a[80:83], v[136:139], v[28:31]
  buffer_load_dwordx4 v[164:167], v196, s[40:43], s78 offen sc1
  v_mfma_f32_16x16x32_bf16 v[32:35], a[84:87], v[136:139], v[32:35]
  s_add_u32 s78, s78, 65536
  v_mfma_f32_16x16x32_bf16 v[36:39], a[88:91], v[136:139], v[36:39]
  buffer_load_dwordx4 v[168:171], v197, s[40:43], s78 offen sc1
  v_mfma_f32_16x16x32_bf16 v[40:43], a[92:95], v[136:139], v[40:43]
  s_add_u32 s78, s78, 65536
  v_mfma_f32_16x16x32_bf16 v[44:47], a[96:99], v[136:139], v[44:47]
  buffer_load_dwordx4 v[172:175], v198, s[40:43], s78 offen sc1
  s_waitcnt vmcnt(8)
  v_mfma_f32_16x16x32_bf16 v[8:11], a[0:3], v[140:143], 0
  s_add_u32 s78, s78, 65536
  v_mfma_f32_16x16x32_bf16 v[12:15], a[4:7], v[140:143], 0
  buffer_load_dwordx4 v[176:179], v199, s[40:43], s78 offen sc1
  v_mfma_f32_16x16x32_bf16 v[16:19], a[8:11], v[140:143], 0
  ds_write_b128 v254, v[28:31] offset:0
  v_mfma_f32_16x16x32_bf16 v[20:23], a[12:15], v[140:143], 0
  s_lshr_b32 s50, s54, 3
  s_and_b32 s50, s50, 1
  v_mfma_f32_16x16x32_bf16 v[24:27], a[16:19], v[140:143], 0
  s_mul_i32 s50, s50, 1105920
  s_mul_i32 s63, s57, 5120
  s_waitcnt vmcnt(8)
  v_mfma_f32_16x16x32_bf16 v[8:11], a[20:23], v[144:147], v[8:11]
  ds_write_b128 v254, v[32:35] offset:1024
  v_mfma_f32_16x16x32_bf16 v[12:15], a[24:27], v[144:147], v[12:15]
  s_add_u32 s63, s63, s50
  s_mul_i32 s46, s52, 40960
  v_mfma_f32_16x16x32_bf16 v[16:19], a[28:31], v[144:147], v[16:19]
  s_add_u32 s46, s46, s63
  s_add_u32 s46, s46, 15564800
  v_mfma_f32_16x16x32_bf16 v[20:23], a[32:35], v[144:147], v[20:23]
  ds_write_b128 v254, v[36:39] offset:2048
  v_mfma_f32_16x16x32_bf16 v[24:27], a[36:39], v[144:147], v[24:27]
  s_add_u32 s47, s46, 0
  buffer_load_dwordx4 a[160:163], v4, s[40:43], s47 offen offset:0 sc1
  s_waitcnt vmcnt(8)
  v_mfma_f32_16x16x32_bf16 v[8:11], a[40:43], v[148:151], v[8:11]
  buffer_load_dwordx4 a[164:167], v4, s[40:43], s47 offen offset:1024 sc1
  buffer_load_dwordx4 a[168:171], v4, s[40:43], s47 offen offset:2048 sc1
  v_mfma_f32_16x16x32_bf16 v[12:15], a[44:47], v[148:151], v[12:15]
  ds_write_b128 v254, v[40:43] offset:3072
  v_mfma_f32_16x16x32_bf16 v[16:19], a[48:51], v[148:151], v[16:19]
  buffer_load_dwordx4 a[172:175], v4, s[40:43], s47 offen offset:3072 sc1
  s_add_u32 s47, s46, 4096
  v_mfma_f32_16x16x32_bf16 v[20:23], a[52:55], v[148:151], v[20:23]
  buffer_load_dwordx4 a[176:179], v4, s[40:43], s47 offen offset:0 sc1
  s_add_u32 s47, s46, 163840
  v_mfma_f32_16x16x32_bf16 v[24:27], a[56:59], v[148:151], v[24:27]
  ds_write_b128 v254, v[44:47] offset:4096
  s_waitcnt vmcnt(11)
  v_mfma_f32_16x16x32_bf16 v[8:11], a[60:63], v[152:155], v[8:11]
  buffer_load_dwordx4 a[180:183], v4, s[40:43], s47 offen offset:0 sc1
  buffer_load_dwordx4 a[184:187], v4, s[40:43], s47 offen offset:1024 sc1
  v_mfma_f32_16x16x32_bf16 v[12:15], a[64:67], v[152:155], v[12:15]
  buffer_load_dwordx4 a[188:191], v4, s[40:43], s47 offen offset:2048 sc1
  s_lshr_b32 s58, s54, 4
  v_mfma_f32_16x16x32_bf16 v[16:19], a[68:71], v[152:155], v[16:19]
  s_lshl_b32 s58, s58, 2
  s_add_u32 s95, s58, s52
  v_mfma_f32_16x16x32_bf16 v[20:23], a[72:75], v[152:155], v[20:23]
  s_lshl_b32 s59, s53, 3
  s_add_u32 s94, s95, s59
  v_mfma_f32_16x16x32_bf16 v[24:27], a[76:79], v[152:155], v[24:27]
  s_mul_i32 s76, s53, 1310720
  s_lshr_b32 s58, s92, 1
  s_waitcnt vmcnt(13)
  v_mfma_f32_16x16x32_bf16 v[8:11], a[80:83], v[156:159], v[8:11]
  s_mul_i32 s58, s58, 7
  s_and_b32 s59, s92, 1
  v_mfma_f32_16x16x32_bf16 v[12:15], a[84:87], v[156:159], v[12:15]
  s_mul_i32 s60, s59, 3
  s_add_u32 s60, s60, s58
  v_mfma_f32_16x16x32_bf16 v[16:19], a[88:91], v[156:159], v[16:19]
  s_min_u32 s60, s60, 50
  s_add_u32 s58, s58, 6
  v_mfma_f32_16x16x32_bf16 v[20:23], a[92:95], v[156:159], v[20:23]
  s_min_u32 s58, s58, 53
  s_mul_i32 s61, s95, 110592
  v_mfma_f32_16x16x32_bf16 v[24:27], a[96:99], v[156:159], v[24:27]
  s_add_u32 s61, s61, s76
  s_add_u32 s61, s61, 327680
  s_waitcnt vmcnt(12)
  v_mfma_f32_16x16x32_bf16 v[64:67], a[0:3], v[160:163], v[64:67]
  s_lshl_b32 s60, s60, 10
  s_add_u32 s72, s60, s61
  v_mfma_f32_16x16x32_bf16 v[68:71], a[4:7], v[160:163], v[68:71]
  s_lshl_b32 s58, s58, 10
  s_add_u32 s73, s58, s61
  v_mfma_f32_16x16x32_bf16 v[72:75], a[8:11], v[160:163], v[72:75]
  ds_write_b128 v255, v[8:11] offset:0
  v_mfma_f32_16x16x32_bf16 v[76:79], a[12:15], v[160:163], v[76:79]
  s_add_u32 s74, s72, 55296
  s_lshl_b32 s59, s59, 3
  v_mfma_f32_16x16x32_bf16 v[80:83], a[16:19], v[160:163], v[80:83]
  s_add_u32 s73, s73, s59
  s_add_u32 s75, s73, 55296
  s_waitcnt vmcnt(11)
  v_mfma_f32_16x16x32_bf16 v[64:67], a[20:23], v[164:167], v[64:67]
  ds_write_b128 v255, v[12:15] offset:1024
  v_mfma_f32_16x16x32_bf16 v[68:71], a[24:27], v[164:167], v[68:71]
  s_lshl_b32 s58, s53, 9
  s_add_u32 s59, s58, 28360704
  v_mfma_f32_16x16x32_bf16 v[72:75], a[28:31], v[164:167], v[72:75]
  v_lshl_add_u32 v61, v1, 3, s59
  v_lshlrev_b32 v62, 2, v2
  v_mfma_f32_16x16x32_bf16 v[76:79], a[32:35], v[164:167], v[76:79]
  ds_write_b128 v255, v[16:19] offset:2048
  v_mfma_f32_16x16x32_bf16 v[80:83], a[36:39], v[164:167], v[80:83]
  s_lshl_b32 s86, s94, 6
  s_add_u32 s86, s86, 28360704
  s_waitcnt vmcnt(10)
  v_mfma_f32_16x16x32_bf16 v[64:67], a[40:43], v[168:171], v[64:67]
  s_lshl_b32 s87, s94, 11
  s_add_u32 s87, s87, 28196864
  v_mfma_f32_16x16x32_bf16 v[68:71], a[44:47], v[168:171], v[68:71]
  ds_write_b128 v255, v[20:23] offset:3072
  v_mfma_f32_16x16x32_bf16 v[72:75], a[48:51], v[168:171], v[72:75]
  s_lshl_b32 s79, s95, 9
  s_add_u32 s79, s79, s76
  v_mfma_f32_16x16x32_bf16 v[76:79], a[52:55], v[168:171], v[76:79]
  s_lshl_b32 s4, s93, 5
  s_mul_i32 s5, s52, 13824
  v_mfma_f32_16x16x32_bf16 v[80:83], a[56:59], v[168:171], v[80:83]
  ds_write_b128 v255, v[24:27] offset:4096
  s_waitcnt vmcnt(9)
  v_mfma_f32_16x16x32_bf16 v[64:67], a[60:63], v[172:175], v[64:67]
  s_add_u32 s4, s4, s5
  s_mul_i32 s5, s52, 896
  v_mfma_f32_16x16x32_bf16 v[68:71], a[64:67], v[172:175], v[68:71]
  v_mul_u32_u24 v5, 147, v1
  v_lshrrev_b32 v5, 11, v5
  v_mfma_f32_16x16x32_bf16 v[72:75], a[68:71], v[172:175], v[72:75]
  s_waitcnt lgkmcnt(0)
  s_barrier
  ds_read_b128 v[100:103], v219 offset:0
  v_mfma_f32_16x16x32_bf16 v[76:79], a[72:75], v[172:175], v[76:79]
  ds_read_b128 v[104:107], v219 offset:1024
  v_mfma_f32_16x16x32_bf16 v[80:83], a[76:79], v[172:175], v[80:83]
  ds_read_b128 v[108:111], v219 offset:2048
  s_waitcnt vmcnt(8)
  v_mfma_f32_16x16x32_bf16 v[64:67], a[80:83], v[176:179], v[64:67]
  ds_read_b128 v[112:115], v219 offset:3072
  v_mfma_f32_16x16x32_bf16 v[68:71], a[84:87], v[176:179], v[68:71]
  ds_read_b128 v[116:119], v219 offset:4096
  v_mfma_f32_16x16x32_bf16 v[72:75], a[88:91], v[176:179], v[72:75]
  ds_read_b128 v[120:123], v219 offset:5120
  v_mfma_f32_16x16x32_bf16 v[76:79], a[92:95], v[176:179], v[76:79]
  ds_read_b128 v[124:127], v219 offset:6144
  v_mfma_f32_16x16x32_bf16 v[80:83], a[96:99], v[176:179], v[80:83]
  ds_read_b128 v[128:131], v219 offset:7168
  ds_read_b128 v[132:135], v219 offset:8192
  ds_read_b128 v[136:139], v219 offset:9216
  ds_read_b128 v[140:143], v219 offset:10240
  ds_read_b128 v[144:147], v219 offset:11264
  ds_read_b128 v[148:151], v219 offset:12288
  ds_read_b128 v[152:155], v219 offset:13312
  ds_read_b128 v[156:159], v219 offset:14336
  v_mul_u32_u24 v5, 3232, v5
  v_add_u32 v56, v5, v4
  s_waitcnt lgkmcnt(10)
  v_pk_add_f32 v[64:65], v[64:65], v[100:101]
  v_pk_add_f32 v[66:67], v[66:67], v[102:103]
  v_pk_add_f32 v[68:69], v[68:69], v[104:105]
  v_pk_add_f32 v[70:71], v[70:71], v[106:107]
  v_pk_add_f32 v[72:73], v[72:73], v[108:109]
  v_pk_add_f32 v[74:75], v[74:75], v[110:111]
  v_pk_add_f32 v[76:77], v[76:77], v[112:113]
  v_pk_add_f32 v[78:79], v[78:79], v[114:115]
  v_pk_add_f32 v[80:81], v[80:81], v[116:117]
  v_pk_add_f32 v[82:83], v[82:83], v[118:119]
  s_waitcnt lgkmcnt(5)
  v_pk_add_f32 v[64:65], v[64:65], v[120:121]
  v_pk_add_f32 v[66:67], v[66:67], v[122:123]
  v_pk_add_f32 v[68:69], v[68:69], v[124:125]
  v_pk_add_f32 v[70:71], v[70:71], v[126:127]
  v_pk_add_f32 v[72:73], v[72:73], v[128:129]
  v_pk_add_f32 v[74:75], v[74:75], v[130:131]
  v_pk_add_f32 v[76:77], v[76:77], v[132:133]
  v_pk_add_f32 v[78:79], v[78:79], v[134:135]
  v_pk_add_f32 v[80:81], v[80:81], v[136:137]
  v_pk_add_f32 v[82:83], v[82:83], v[138:139]
  s_waitcnt lgkmcnt(0)
  v_pk_add_f32 v[64:65], v[64:65], v[140:141]
  v_pk_add_f32 v[66:67], v[66:67], v[142:143]
  v_pk_add_f32 v[68:69], v[68:69], v[144:145]
  v_pk_add_f32 v[70:71], v[70:71], v[146:147]
  v_pk_add_f32 v[72:73], v[72:73], v[148:149]
  v_pk_add_f32 v[74:75], v[74:75], v[150:151]
  v_pk_add_f32 v[76:77], v[76:77], v[152:153]
  v_pk_add_f32 v[78:79], v[78:79], v[154:155]
  v_pk_add_f32 v[80:81], v[80:81], v[156:157]
  v_pk_add_f32 v[82:83], v[82:83], v[158:159]
  v_cvt_pk_bf16_f32 v84, v64, v65
  v_cvt_pk_bf16_f32 v85, v66, v67
  v_cvt_pk_bf16_f32 v86, v68, v69
  v_cvt_pk_bf16_f32 v87, v70, v71
  v_cvt_pk_bf16_f32 v88, v72, v73
  v_cvt_pk_bf16_f32 v89, v74, v75
  v_cvt_pk_bf16_f32 v90, v76, v77
  v_cvt_pk_bf16_f32 v91, v78, v79
  v_cvt_pk_bf16_f32 v92, v80, v81
  v_cvt_pk_bf16_f32 v93, v82, v83
  s_add_u32 s63, s44, 0
  s_add_u32 s62, s63, s64
  s_add_u32 s63, s63, s65
  s_add_u32 s61, s62, 16384
  s_cmp_eq_u32 s55, 0
  s_cbranch_scc1 Lsafe_42
  buffer_store_dwordx4 v[84:87], v248, s[40:43], s62 offen
  buffer_store_dwordx4 v[88:91], v248, s[40:43], s61 offen
  buffer_store_dwordx2 v[92:93], v248, s[40:43], s63 offen
  s_branch Ljoin_43
Lsafe_42:
  buffer_store_dwordx4 v[84:87], v248, s[40:43], s62 offen sc1
  buffer_store_dwordx4 v[88:91], v248, s[40:43], s61 offen sc1
  buffer_store_dwordx2 v[92:93], v248, s[40:43], s63 offen sc1
Ljoin_43:
  v_lshlrev_b32 v100, 16, v84
  v_and_b32 v101, 0xffff0000, v84
  v_lshlrev_b32 v102, 16, v85
  v_and_b32 v103, 0xffff0000, v85
  v_lshlrev_b32 v104, 16, v86
  v_and_b32 v105, 0xffff0000, v86
  v_lshlrev_b32 v106, 16, v87
  v_and_b32 v107, 0xffff0000, v87
  v_lshlrev_b32 v108, 16, v88
  v_and_b32 v109, 0xffff0000, v88
  v_lshlrev_b32 v110, 16, v89
  v_and_b32 v111, 0xffff0000, v89
  v_lshlrev_b32 v112, 16, v90
  v_and_b32 v113, 0xffff0000, v90
  v_lshlrev_b32 v114, 16, v91
  v_and_b32 v115, 0xffff0000, v91
  v_lshlrev_b32 v116, 16, v92
  v_and_b32 v117, 0xffff0000, v92
  v_lshlrev_b32 v118, 16, v93
  v_and_b32 v119, 0xffff0000, v93
  v_pk_add_f32 v[48:49], v[100:101], v[102:103]
  v_pk_mul_f32 v[50:51], v[100:101], v[100:101]
  v_pk_fma_f32 v[50:51], v[102:103], v[102:103], v[50:51]
  v_pk_add_f32 v[48:49], v[48:49], v[104:105]
  v_pk_fma_f32 v[50:51], v[104:105], v[104:105], v[50:51]
  v_pk_add_f32 v[48:49], v[48:49], v[106:107]
  v_pk_fma_f32 v[50:51], v[106:107], v[106:107], v[50:51]
  v_pk_add_f32 v[48:49], v[48:49], v[108:109]
  v_pk_fma_f32 v[50:51], v[108:109], v[108:109], v[50:51]
  v_pk_add_f32 v[48:49], v[48:49], v[110:111]
  v_pk_fma_f32 v[50:51], v[110:111], v[110:111], v[50:51]
  v_pk_add_f32 v[48:49], v[48:49], v[112:113]
  v_pk_fma_f32 v[50:51], v[112:113], v[112:113], v[50:51]
  v_pk_add_f32 v[48:49], v[48:49], v[114:115]
  v_pk_fma_f32 v[50:51], v[114:115], v[114:115], v[50:51]
  v_pk_add_f32 v[48:49], v[48:49], v[116:117]
  v_pk_fma_f32 v[50:51], v[116:117], v[116:117], v[50:51]
  v_pk_add_f32 v[48:49], v[48:49], v[118:119]
  v_pk_fma_f32 v[50:51], v[118:119], v[118:119], v[50:51]
  v_add_f32 v48, v48, v49
  v_add_f32 v49, v50, v51
  s_nop 1
  v_permlane32_swap_b32 v48, v49
  v_add_f32 v48, v48, v49
  v_mov_b32 v49, v48
  s_nop 1
  v_permlane16_swap_b32 v48, v49
  v_add_f32 v48, v48, v49
  s_add_u32 s61, s66, 28196864
  s_mov_b64 exec, s[68:69]
  s_cmp_eq_u32 s55, 0
  s_cbranch_scc1 Lsafe_44
  buffer_store_dword v48, v252, s[40:43], s61 offen
  s_branch Ljoin_45
Lsafe_44:
  buffer_store_dword v48, v252, s[40:43], s61 offen sc1
Ljoin_45:
  s_mov_b64 exec, -1
  v_pk_add_f32 v[220:221], v[220:221], v[100:101]
  v_pk_add_f32 v[222:223], v[222:223], v[102:103]
  v_pk_add_f32 v[224:225], v[224:225], v[104:105]
  v_pk_add_f32 v[226:227], v[226:227], v[106:107]
  v_pk_add_f32 v[228:229], v[228:229], v[108:109]
  v_pk_add_f32 v[230:231], v[230:231], v[110:111]
  v_pk_add_f32 v[232:233], v[232:233], v[112:113]
  v_pk_add_f32 v[234:235], v[234:235], v[114:115]
  v_pk_add_f32 v[236:237], v[236:237], v[116:117]
  v_pk_add_f32 v[238:239], v[238:239], v[118:119]
  s_waitcnt vmcnt(0)
  s_add_u32 s58, s67, 28360704
  v_mov_b32 v6, s3
  s_mov_b64 exec, 1
  s_cmp_eq_u32 s55, 0
  s_cbranch_scc1 Lsafe_46
  buffer_store_dword v6, v251, s[40:43], s58 offen
  s_branch Ljoin_47
Lsafe_46:
  buffer_store_dword v6, v251, s[40:43], s58 offen sc1
Ljoin_47:
  s_mov_b64 exec, -1
  s_barrier
  s_add_u32 m0, s5, 0
  s_add_u32 s6, s4, 1327104
  buffer_load_dwordx4 v56, s[28:31], s6 offen lds
  s_add_u32 m0, s5, 3584
  s_add_u32 s6, s4, 1382400
  buffer_load_dwordx4 v56, s[28:31], s6 offen lds
  s_add_u32 m0, s5, 7168
  s_add_u32 s6, s4, 1437696
  buffer_load_dwordx4 v56, s[28:31], s6 offen lds
  s_add_u32 m0, s5, 10752
  s_add_u32 s6, s4, 1492992
  buffer_load_dwordx4 v56, s[28:31], s6 offen lds
  s_add_u32 m0, s5, 14336
  s_add_u32 s6, s4, 1548288
  buffer_load_dwordx4 v56, s[28:31], s6 offen lds
  s_add_u32 m0, s5, 17920
  s_add_u32 s6, s4, 1603584
  buffer_load_dwordx4 v56, s[28:31], s6 offen lds
  v_lshrrev_b32 v5, 2, v2
  v_lshl_add_u32 v5, v3, 2, v5
  v_mul_u32_u24 v5, 224, v5
  v_and_b32 v6, 3, v1
  v_lshl_add_u32 v36, v6, 3, v5
  v_add_u32 v37, 0x10000, v36
  v_add_u32 v38, 0x20000, v36
  s_mov_b32 s48, 0
  s_nop 0
Lpoll_48:
  buffer_load_dword v240, v62, s[40:43], s86 offen sc1
  s_add_u32 s48, s48, 1
  s_cmp_gt_u32 s48, 0x40000
  s_cbranch_scc1 Lend
  s_waitcnt vmcnt(0)
  v_cmp_ne_u32 vcc, s3, v240
  s_nop 4
  s_cbranch_vccnz Lpoll_48
  s_add_u32 s58, s79, 0
  buffer_load_dwordx4 a[0:3], v248, s[40:43], s58 offen sc1
  buffer_load_dwordx4 a[4:7], v248, s[40:43], s58 offen offset:256 sc1
  s_add_u32 s58, s79, 16384
  buffer_load_dwordx4 a[8:11], v248, s[40:43], s58 offen sc1
  buffer_load_dwordx4 a[12:15], v248, s[40:43], s58 offen offset:256 sc1
  s_add_u32 s58, s79, 32768
  buffer_load_dwordx4 a[16:19], v248, s[40:43], s58 offen sc1
  buffer_load_dwordx4 a[20:23], v248, s[40:43], s58 offen offset:256 sc1
  buffer_load_dwordx4 v[40:43], v4, s[40:43], s87 offen offset:0 sc1
  buffer_load_dwordx4 v[44:47], v4, s[40:43], s87 offen offset:1024 sc1
  ds_read_b64_tr_b16 v[128:129], v36 offset:61440
  ds_read_b64_tr_b16 v[130:131], v36 offset:65024
  ds_read_b64_tr_b16 v[132:133], v36 offset:61472
  ds_read_b64_tr_b16 v[134:135], v36 offset:65056
  ds_read_b64_tr_b16 v[136:137], v36 offset:61504
  ds_read_b64_tr_b16 v[138:139], v36 offset:65088
  ds_read_b64_tr_b16 v[140:141], v36 offset:61536
  ds_read_b64_tr_b16 v[142:143], v36 offset:65120
  ds_read_b64_tr_b16 v[144:145], v36 offset:61568
  ds_read_b64_tr_b16 v[146:147], v36 offset:65152
  s_waitcnt vmcnt(6)
  s_waitcnt lgkmcnt(6)
  v_mfma_f32_16x16x32_bf16 v[64:67], v[128:131], a[0:3], 0
  ds_read_b64_tr_b16 v[148:149], v36 offset:61600
  s_add_u32 s58, s79, 49152
  v_mfma_f32_16x16x32_bf16 v[92:95], v[128:131], a[4:7], 0
  ds_read_b64_tr_b16 v[150:151], v36 offset:65184
  v_mfma_f32_16x16x32_bf16 v[68:71], v[132:135], a[0:3], 0
  ds_read_b64_tr_b16 v[128:129], v36 offset:61632
  v_mfma_f32_16x16x32_bf16 v[96:99], v[132:135], a[4:7], 0
  ds_read_b64_tr_b16 v[130:131], v36 offset:65216
  s_waitcnt lgkmcnt(6)
  v_mfma_f32_16x16x32_bf16 v[72:75], v[136:139], a[0:3], 0
  ds_read_b64_tr_b16 v[132:133], v37 offset:3072
  buffer_load_dwordx4 a[24:27], v248, s[40:43], s58 offen sc1
  v_mfma_f32_16x16x32_bf16 v[100:103], v[136:139], a[4:7], 0
  ds_read_b64_tr_b16 v[134:135], v37 offset:6656
  v_mfma_f32_16x16x32_bf16 v[76:79], v[140:143], a[0:3], 0
  ds_read_b64_tr_b16 v[136:137], v37 offset:3104
  buffer_load_dwordx4 a[28:31], v248, s[40:43], s58 offen offset:256 sc1
  v_mfma_f32_16x16x32_bf16 v[104:107], v[140:143], a[4:7], 0
  ds_read_b64_tr_b16 v[138:139], v37 offset:6688
  s_waitcnt lgkmcnt(6)
  v_mfma_f32_16x16x32_bf16 v[80:83], v[144:147], a[0:3], 0
  ds_read_b64_tr_b16 v[140:141], v37 offset:3136
  s_add_u32 s58, s79, 65536
  v_mfma_f32_16x16x32_bf16 v[108:111], v[144:147], a[4:7], 0
  ds_read_b64_tr_b16 v[142:143], v37 offset:6720
  v_mfma_f32_16x16x32_bf16 v[84:87], v[148:151], a[0:3], 0
  ds_read_b64_tr_b16 v[144:145], v37 offset:3168
  buffer_load_dwordx4 a[32:35], v248, s[40:43], s58 offen sc1
  v_mfma_f32_16x16x32_bf16 v[112:115], v[148:151], a[4:7], 0
  ds_read_b64_tr_b16 v[146:147], v37 offset:6752
  s_waitcnt lgkmcnt(6)
  v_mfma_f32_16x16x32_bf16 v[88:91], v[128:131], a[0:3], 0
  ds_read_b64_tr_b16 v[148:149], v37 offset:3200
  buffer_load_dwordx4 a[36:39], v248, s[40:43], s58 offen offset:256 sc1
  v_mfma_f32_16x16x32_bf16 v[116:119], v[128:131], a[4:7], 0
  ds_read_b64_tr_b16 v[150:151], v37 offset:6784
  s_waitcnt vmcnt(8)
  v_mfma_f32_16x16x32_bf16 v[64:67], v[132:135], a[8:11], v[64:67]
  ds_read_b64_tr_b16 v[128:129], v37 offset:3232
  s_add_u32 s58, s79, 81920
  v_mfma_f32_16x16x32_bf16 v[92:95], v[132:135], a[12:15], v[92:95]
  ds_read_b64_tr_b16 v[130:131], v37 offset:6816
  s_waitcnt lgkmcnt(6)
  v_mfma_f32_16x16x32_bf16 v[68:71], v[136:139], a[8:11], v[68:71]
  ds_read_b64_tr_b16 v[132:133], v37 offset:3264
  buffer_load_dwordx4 a[40:43], v248, s[40:43], s58 offen sc1
  v_mfma_f32_16x16x32_bf16 v[96:99], v[136:139], a[12:15], v[96:99]
  ds_read_b64_tr_b16 v[134:135], v37 offset:6848
  v_mfma_f32_16x16x32_bf16 v[72:75], v[140:143], a[8:11], v[72:75]
  ds_read_b64_tr_b16 v[136:137], v37 offset:13824
  v_mfma_f32_16x16x32_bf16 v[100:103], v[140:143], a[12:15], v[100:103]
  ds_read_b64_tr_b16 v[138:139], v37 offset:17408
  s_waitcnt lgkmcnt(6)
  v_mfma_f32_16x16x32_bf16 v[76:79], v[144:147], a[8:11], v[76:79]
  ds_read_b64_tr_b16 v[140:141], v37 offset:13856
  buffer_load_dwordx4 a[44:47], v248, s[40:43], s58 offen offset:256 sc1
  v_mfma_f32_16x16x32_bf16 v[104:107], v[144:147], a[12:15], v[104:107]
  ds_read_b64_tr_b16 v[142:143], v37 offset:17440
  v_mfma_f32_16x16x32_bf16 v[80:83], v[148:151], a[8:11], v[80:83]
  ds_read_b64_tr_b16 v[144:145], v37 offset:13888
  s_add_u32 s58, s79, 98304
  v_mfma_f32_16x16x32_bf16 v[108:111], v[148:151], a[12:15], v[108:111]
  ds_read_b64_tr_b16 v[146:147], v37 offset:17472
  s_waitcnt lgkmcnt(6)
  v_mfma_f32_16x16x32_bf16 v[84:87], v[128:131], a[8:11], v[84:87]
  ds_read_b64_tr_b16 v[148:149], v37 offset:13920
  buffer_load_dwordx4 a[48:51], v248, s[40:43], s58 offen sc1
  v_mfma_f32_16x16x32_bf16 v[112:115], v[128:131], a[12:15], v[112:115]
  ds_read_b64_tr_b16 v[150:151], v37 offset:17504
  v_mfma_f32_16x16x32_bf16 v[88:91], v[132:135], a[8:11], v[88:91]
  ds_read_b64_tr_b16 v[128:129], v37 offset:13952
  buffer_load_dwordx4 a[52:55], v248, s[40:43], s58 offen offset:256 sc1
  v_mfma_f32_16x16x32_bf16 v[116:119], v[132:135], a[12:15], v[116:119]
  ds_read_b64_tr_b16 v[130:131], v37 offset:17536
  s_waitcnt vmcnt(10)
  s_waitcnt lgkmcnt(6)
  v_mfma_f32_16x16x32_bf16 v[64:67], v[136:139], a[16:19], v[64:67]
  ds_read_b64_tr_b16 v[132:133], v37 offset:13984
  s_add_u32 s58, s79, 114688
  v_mfma_f32_16x16x32_bf16 v[92:95], v[136:139], a[20:23], v[92:95]
  ds_read_b64_tr_b16 v[134:135], v37 offset:17568
  s_waitcnt vmcnt(8)
  v_mfma_f32_16x16x32_bf16 v[68:71], v[140:143], a[16:19], v[68:71]
  ds_read_b64_tr_b16 v[136:137], v37 offset:14016
  buffer_load_dwordx4 a[56:59], v248, s[40:43], s58 offen sc1
  v_mfma_f32_16x16x32_bf16 v[96:99], v[140:143], a[20:23], v[96:99]
  ds_read_b64_tr_b16 v[138:139], v37 offset:17600
  s_waitcnt lgkmcnt(6)
  v_mfma_f32_16x16x32_bf16 v[72:75], v[144:147], a[16:19], v[72:75]
  ds_read_b64_tr_b16 v[140:141], v37 offset:20992
  buffer_load_dwordx4 a[60:63], v248, s[40:43], s58 offen offset:256 sc1
  v_mfma_f32_16x16x32_bf16 v[100:103], v[144:147], a[20:23], v[100:103]
  ds_read_b64_tr_b16 v[142:143], v37 offset:24576
  v_add_f32 v40, v40, v42
  v_mfma_f32_16x16x32_bf16 v[76:79], v[148:151], a[16:19], v[76:79]
  ds_read_b64_tr_b16 v[144:145], v37 offset:21024
  s_add_u32 m0, s5, 21504
  s_add_u32 s6, s4, 1658880
  buffer_load_dwordx4 v56, s[28:31], s6 offen lds
  v_mfma_f32_16x16x32_bf16 v[104:107], v[148:151], a[20:23], v[104:107]
  ds_read_b64_tr_b16 v[146:147], v37 offset:24608
  s_waitcnt lgkmcnt(6)
  v_mfma_f32_16x16x32_bf16 v[80:83], v[128:131], a[16:19], v[80:83]
  ds_read_b64_tr_b16 v[148:149], v37 offset:21056
  v_mfma_f32_16x16x32_bf16 v[108:111], v[128:131], a[20:23], v[108:111]
  ds_read_b64_tr_b16 v[150:151], v37 offset:24640
  v_add_f32 v41, v41, v43
  v_mfma_f32_16x16x32_bf16 v[84:87], v[132:135], a[16:19], v[84:87]
  ds_read_b64_tr_b16 v[128:129], v37 offset:21088
  s_add_u32 m0, s5, 25088
  s_add_u32 s6, s4, 1714176
  buffer_load_dwordx4 v56, s[28:31], s6 offen lds
  v_mfma_f32_16x16x32_bf16 v[112:115], v[132:135], a[20:23], v[112:115]
  ds_read_b64_tr_b16 v[130:131], v37 offset:24672
  s_waitcnt lgkmcnt(6)
  v_mfma_f32_16x16x32_bf16 v[88:91], v[136:139], a[16:19], v[88:91]
  ds_read_b64_tr_b16 v[132:133], v37 offset:21120
  s_add_u32 m0, s5, 28672
  s_add_u32 s6, s4, 1769472
  buffer_load_dwordx4 v56, s[28:31], s6 offen lds
  v_mfma_f32_16x16x32_bf16 v[116:119], v[136:139], a[20:23], v[116:119]
  ds_read_b64_tr_b16 v[134:135], v37 offset:24704
  v_permlane32_swap_b32 v40, v41
  s_waitcnt vmcnt(11)
  v_mfma_f32_16x16x32_bf16 v[64:67], v[140:143], a[24:27], v[64:67]
  ds_read_b64_tr_b16 v[136:137], v37 offset:21152
  s_add_u32 m0, s5, 32256
  s_add_u32 s6, s4, 1824768
  buffer_load_dwordx4 v56, s[28:31], s6 offen lds
  v_mfma_f32_16x16x32_bf16 v[92:95], v[140:143], a[28:31], v[92:95]
  ds_read_b64_tr_b16 v[138:139], v37 offset:24736
  s_waitcnt lgkmcnt(6)
  v_mfma_f32_16x16x32_bf16 v[68:71], v[144:147], a[24:27], v[68:71]
  ds_read_b64_tr_b16 v[140:141], v37 offset:21184
  s_add_u32 m0, s5, 35840
  s_add_u32 s6, s4, 1880064
  buffer_load_dwordx4 v56, s[28:31], s6 offen lds
  v_mfma_f32_16x16x32_bf16 v[96:99], v[144:147], a[28:31], v[96:99]
  ds_read_b64_tr_b16 v[142:143], v37 offset:24768
  v_add_f32 v40, v40, v41
  v_mfma_f32_16x16x32_bf16 v[72:75], v[148:151], a[24:27], v[72:75]
  ds_read_b64_tr_b16 v[144:145], v37 offset:10240
  s_add_u32 m0, s5, 39424
  s_add_u32 s6, s4, 1935360
  buffer_load_dwordx4 v56, s[28:31], s6 offen lds
  v_mfma_f32_16x16x32_bf16 v[100:103], v[148:151], a[28:31], v[100:103]
  ds_read_b64_tr_b16 v[146:147], v37 offset:28160
  s_waitcnt lgkmcnt(6)
  v_mfma_f32_16x16x32_bf16 v[76:79], v[128:131], a[24:27], v[76:79]
  ds_read_b64_tr_b16 v[148:149], v37 offset:10272
  s_add_u32 m0, s5, 43008
  s_add_u32 s6, s4, 1990656
  buffer_load_dwordx4 v56, s[28:31], s6 offen lds
  v_mfma_f32_16x16x32_bf16 v[104:107], v[128:131], a[28:31], v[104:107]
  ds_read_b64_tr_b16 v[150:151], v37 offset:28192
  v_mov_b32 v41, v40
  v_mfma_f32_16x16x32_bf16 v[80:83], v[132:135], a[24:27], v[80:83]
  ds_read_b64_tr_b16 v[128:129], v37 offset:10304
  s_add_u32 m0, s5, 46592
  s_add_u32 s6, s4, 2045952
  buffer_load_dwordx4 v56, s[28:31], s6 offen lds
  v_mfma_f32_16x16x32_bf16 v[108:111], v[132:135], a[28:31], v[108:111]
  ds_read_b64_tr_b16 v[130:131], v37 offset:28224
  s_waitcnt lgkmcnt(6)
  v_mfma_f32_16x16x32_bf16 v[84:87], v[136:139], a[24:27], v[84:87]
  ds_read_b64_tr_b16 v[132:133], v37 offset:10336
  v_mfma_f32_16x16x32_bf16 v[112:115], v[136:139], a[28:31], v[112:115]
  ds_read_b64_tr_b16 v[134:135], v37 offset:28256
  v_permlane16_swap_b32 v40, v41
  v_mfma_f32_16x16x32_bf16 v[88:91], v[140:143], a[24:27], v[88:91]
  ds_read_b64_tr_b16 v[136:137], v37 offset:10368
  s_add_u32 m0, s5, 50176
  s_add_u32 s6, s4, 2101248
  buffer_load_dwordx4 v56, s[28:31], s6 offen lds
  v_mfma_f32_16x16x32_bf16 v[116:119], v[140:143], a[28:31], v[116:119]
  ds_read_b64_tr_b16 v[138:139], v37 offset:28288
  s_waitcnt vmcnt(15)
  s_waitcnt lgkmcnt(6)
  v_mfma_f32_16x16x32_bf16 v[64:67], v[144:147], a[32:35], v[64:67]
  ds_read_b64_tr_b16 v[140:141], v37 offset:10400
  s_add_u32 m0, s5, 53760
  s_add_u32 s6, s4, 2156544
  buffer_load_dwordx4 v56, s[28:31], s6 offen lds
  v_mfma_f32_16x16x32_bf16 v[92:95], v[144:147], a[36:39], v[92:95]
  ds_read_b64_tr_b16 v[142:143], v37 offset:28320
  v_add_f32 v40, v40, v41
  v_mfma_f32_16x16x32_bf16 v[68:71], v[148:151], a[32:35], v[68:71]
  ds_read_b64_tr_b16 v[144:145], v37 offset:10432
  s_add_u32 s58, s79, 131072
  v_mfma_f32_16x16x32_bf16 v[96:99], v[148:151], a[36:39], v[96:99]
  ds_read_b64_tr_b16 v[146:147], v37 offset:28352
  s_waitcnt lgkmcnt(6)
  v_mfma_f32_16x16x32_bf16 v[72:75], v[128:131], a[32:35], v[72:75]
  ds_read_b64_tr_b16 v[148:149], v37 offset:31744
  buffer_load_dwordx4 a[64:67], v248, s[40:43], s58 offen sc1
  v_mfma_f32_16x16x32_bf16 v[100:103], v[128:131], a[36:39], v[100:103]
  ds_read_b64_tr_b16 v[150:151], v37 offset:35328
  v_mov_b32 v41, v40
  v_mfma_f32_16x16x32_bf16 v[76:79], v[132:135], a[32:35], v[76:79]
  ds_read_b64_tr_b16 v[128:129], v37 offset:31776
  buffer_load_dwordx4 a[68:71], v248, s[40:43], s58 offen offset:256 sc1
  v_mfma_f32_16x16x32_bf16 v[104:107], v[132:135], a[36:39], v[104:107]
  ds_read_b64_tr_b16 v[130:131], v37 offset:35360
  s_waitcnt lgkmcnt(6)
  v_mfma_f32_16x16x32_bf16 v[80:83], v[136:139], a[32:35], v[80:83]
  ds_read_b64_tr_b16 v[132:133], v37 offset:31808
  s_add_u32 s58, s79, 147456
  v_mfma_f32_16x16x32_bf16 v[108:111], v[136:139], a[36:39], v[108:111]
  ds_read_b64_tr_b16 v[134:135], v37 offset:35392
  v_permlane32_swap_b32 v40, v41
  v_mfma_f32_16x16x32_bf16 v[84:87], v[140:143], a[32:35], v[84:87]
  ds_read_b64_tr_b16 v[136:137], v37 offset:31840
  buffer_load_dwordx4 a[72:75], v248, s[40:43], s58 offen sc1
  v_mfma_f32_16x16x32_bf16 v[112:115], v[140:143], a[36:39], v[112:115]
  ds_read_b64_tr_b16 v[138:139], v37 offset:35424
  s_waitcnt lgkmcnt(6)
  v_mfma_f32_16x16x32_bf16 v[88:91], v[144:147], a[32:35], v[88:91]
  ds_read_b64_tr_b16 v[140:141], v37 offset:31872
  buffer_load_dwordx4 a[76:79], v248, s[40:43], s58 offen offset:256 sc1
  v_mfma_f32_16x16x32_bf16 v[116:119], v[144:147], a[36:39], v[116:119]
  ds_read_b64_tr_b16 v[142:143], v37 offset:35456
  v_mul_f32 v48, 0x3acccccd, v40
  s_waitcnt vmcnt(18)
  v_mfma_f32_16x16x32_bf16 v[64:67], v[148:151], a[40:43], v[64:67]
  ds_read_b64_tr_b16 v[144:145], v37 offset:31904
  v_mfma_f32_16x16x32_bf16 v[92:95], v[148:151], a[44:47], v[92:95]
  ds_read_b64_tr_b16 v[146:147], v37 offset:35488
  s_waitcnt lgkmcnt(6)
  v_mfma_f32_16x16x32_bf16 v[68:71], v[128:131], a[40:43], v[68:71]
  ds_read_b64_tr_b16 v[148:149], v37 offset:31936
  s_add_u32 s58, s79, 163840
  v_mfma_f32_16x16x32_bf16 v[96:99], v[128:131], a[44:47], v[96:99]
  ds_read_b64_tr_b16 v[150:151], v37 offset:35520
  v_mul_f32 v50, 0x3acccccd, v41
  v_mfma_f32_16x16x32_bf16 v[72:75], v[132:135], a[40:43], v[72:75]
  ds_read_b64_tr_b16 v[128:129], v37 offset:38912
  buffer_load_dwordx4 a[80:83], v248, s[40:43], s58 offen sc1
  v_mfma_f32_16x16x32_bf16 v[100:103], v[132:135], a[44:47], v[100:103]
  ds_read_b64_tr_b16 v[130:131], v37 offset:42496
  s_waitcnt lgkmcnt(6)
  v_mfma_f32_16x16x32_bf16 v[76:79], v[136:139], a[40:43], v[76:79]
  ds_read_b64_tr_b16 v[132:133], v37 offset:38944
  buffer_load_dwordx4 a[84:87], v248, s[40:43], s58 offen offset:256 sc1
  v_mfma_f32_16x16x32_bf16 v[104:107], v[136:139], a[44:47], v[104:107]
  ds_read_b64_tr_b16 v[134:135], v37 offset:42528
  v_fma_f32 v50, -v48, v48, v50
  v_mfma_f32_16x16x32_bf16 v[80:83], v[140:143], a[40:43], v[80:83]
  ds_read_b64_tr_b16 v[136:137], v37 offset:38976
  s_add_u32 s58, s79, 180224
  v_mfma_f32_16x16x32_bf16 v[108:111], v[140:143], a[44:47], v[108:111]
  ds_read_b64_tr_b16 v[138:139], v37 offset:42560
  s_waitcnt lgkmcnt(6)
  v_mfma_f32_16x16x32_bf16 v[84:87], v[144:147], a[40:43], v[84:87]
  ds_read_b64_tr_b16 v[140:141], v37 offset:39008
  buffer_load_dwordx4 a[88:91], v248, s[40:43], s58 offen sc1
  v_mfma_f32_16x16x32_bf16 v[112:115], v[144:147], a[44:47], v[112:115]
  ds_read_b64_tr_b16 v[142:143], v37 offset:42592
  v_max_f32 v50, 0, v50
  v_mfma_f32_16x16x32_bf16 v[88:91], v[148:151], a[40:43], v[88:91]
  ds_read_b64_tr_b16 v[144:145], v37 offset:39040
  buffer_load_dwordx4 a[92:95], v248, s[40:43], s58 offen offset:256 sc1
  v_mfma_f32_16x16x32_bf16 v[116:119], v[148:151], a[44:47], v[116:119]
  ds_read_b64_tr_b16 v[146:147], v37 offset:42624
  s_waitcnt vmcnt(20)
  s_waitcnt lgkmcnt(6)
  v_mfma_f32_16x16x32_bf16 v[64:67], v[128:131], a[48:51], v[64:67]
  ds_read_b64_tr_b16 v[148:149], v37 offset:39072
  s_add_u32 s58, s79, 196608
  v_mfma_f32_16x16x32_bf16 v[92:95], v[128:131], a[52:55], v[92:95]
  ds_read_b64_tr_b16 v[150:151], v37 offset:42656
  v_add_f32 v50, 0x3727c5ac, v50
  v_mfma_f32_16x16x32_bf16 v[68:71], v[132:135], a[48:51], v[68:71]
  ds_read_b64_tr_b16 v[128:129], v37 offset:39104
  buffer_load_dwordx4 a[96:99], v248, s[40:43], s58 offen sc1
  v_mfma_f32_16x16x32_bf16 v[96:99], v[132:135], a[52:55], v[96:99]
  ds_read_b64_tr_b16 v[130:131], v37 offset:42688
  s_waitcnt lgkmcnt(6)
  v_mfma_f32_16x16x32_bf16 v[72:75], v[136:139], a[48:51], v[72:75]
  ds_read_b64_tr_b16 v[132:133], v37 offset:49664
  v_mfma_f32_16x16x32_bf16 v[100:103], v[136:139], a[52:55], v[100:103]
  ds_read_b64_tr_b16 v[134:135], v37 offset:53248
  v_rsq_f32 v50, v50
  v_mfma_f32_16x16x32_bf16 v[76:79], v[140:143], a[48:51], v[76:79]
  ds_read_b64_tr_b16 v[136:137], v37 offset:49696
  buffer_load_dwordx4 a[100:103], v248, s[40:43], s58 offen offset:256 sc1
  v_mfma_f32_16x16x32_bf16 v[104:107], v[140:143], a[52:55], v[104:107]
  ds_read_b64_tr_b16 v[138:139], v37 offset:53280
  s_waitcnt lgkmcnt(6)
  v_mfma_f32_16x16x32_bf16 v[80:83], v[144:147], a[48:51], v[80:83]
  ds_read_b64_tr_b16 v[140:141], v37 offset:49728
  s_add_u32 s58, s79, 212992
  v_mfma_f32_16x16x32_bf16 v[108:111], v[144:147], a[52:55], v[108:111]
  ds_read_b64_tr_b16 v[142:143], v37 offset:53312
  v_sub_f32 v48, 0, v48
  v_mfma_f32_16x16x32_bf16 v[84:87], v[148:151], a[48:51], v[84:87]
  ds_read_b64_tr_b16 v[144:145], v37 offset:49760
  buffer_load_dwordx4 a[104:107], v248, s[40:43], s58 offen sc1
  v_mfma_f32_16x16x32_bf16 v[112:115], v[148:151], a[52:55], v[112:115]
  ds_read_b64_tr_b16 v[146:147], v37 offset:53344
  s_waitcnt lgkmcnt(6)
  v_mfma_f32_16x16x32_bf16 v[88:91], v[128:131], a[48:51], v[88:91]
  ds_read_b64_tr_b16 v[148:149], v37 offset:49792
  buffer_load_dwordx4 a[108:111], v248, s[40:43], s58 offen offset:256 sc1
  v_mfma_f32_16x16x32_bf16 v[116:119], v[128:131], a[52:55], v[116:119]
  ds_read_b64_tr_b16 v[150:151], v37 offset:53376
  v_mov_b32 v49, v48
  s_waitcnt vmcnt(22)
  v_mfma_f32_16x16x32_bf16 v[64:67], v[132:135], a[56:59], v[64:67]
  ds_read_b64_tr_b16 v[128:129], v37 offset:49824
  s_add_u32 s58, s79, 229376
  v_mfma_f32_16x16x32_bf16 v[92:95], v[132:135], a[60:63], v[92:95]
  ds_read_b64_tr_b16 v[130:131], v37 offset:53408
  s_waitcnt lgkmcnt(6)
  v_mfma_f32_16x16x32_bf16 v[68:71], v[136:139], a[56:59], v[68:71]
  ds_read_b64_tr_b16 v[132:133], v37 offset:49856
  buffer_load_dwordx4 a[112:115], v248, s[40:43], s58 offen sc1
  v_mfma_f32_16x16x32_bf16 v[96:99], v[136:139], a[60:63], v[96:99]
  ds_read_b64_tr_b16 v[134:135], v37 offset:53440
  v_mul_f32 v152, 0xc0135761, v50
  v_mfma_f32_16x16x32_bf16 v[72:75], v[140:143], a[56:59], v[72:75]
  ds_read_b64_tr_b16 v[136:137], v37 offset:56832
  buffer_load_dwordx4 a[116:119], v248, s[40:43], s58 offen offset:256 sc1
  v_mfma_f32_16x16x32_bf16 v[100:103], v[140:143], a[60:63], v[100:103]
  ds_read_b64_tr_b16 v[138:139], v37 offset:60416
  s_waitcnt lgkmcnt(6)
  v_mfma_f32_16x16x32_bf16 v[76:79], v[144:147], a[56:59], v[76:79]
  ds_read_b64_tr_b16 v[140:141], v37 offset:56864
  v_mfma_f32_16x16x32_bf16 v[104:107], v[144:147], a[60:63], v[104:107]
  ds_read_b64_tr_b16 v[142:143], v37 offset:60448
  v_mul_f32 v154, v50, v50
  v_mfma_f32_16x16x32_bf16 v[80:83], v[148:151], a[56:59], v[80:83]
  ds_read_b64_tr_b16 v[144:145], v37 offset:56896
  s_add_u32 s58, s79, 245760
  v_mfma_f32_16x16x32_bf16 v[108:111], v[148:151], a[60:63], v[108:111]
  ds_read_b64_tr_b16 v[146:147], v37 offset:60480
  s_waitcnt lgkmcnt(6)
  v_mfma_f32_16x16x32_bf16 v[84:87], v[128:131], a[56:59], v[84:87]
  ds_read_b64_tr_b16 v[148:149], v37 offset:56928
  buffer_load_dwordx4 a[120:123], v248, s[40:43], s58 offen sc1
  v_mfma_f32_16x16x32_bf16 v[112:115], v[128:131], a[60:63], v[112:115]
  ds_read_b64_tr_b16 v[150:151], v37 offset:60512
  v_rcp_f32 v156, v50
  v_mfma_f32_16x16x32_bf16 v[88:91], v[132:135], a[56:59], v[88:91]
  ds_read_b64_tr_b16 v[128:129], v37 offset:56960
  buffer_load_dwordx4 a[124:127], v248, s[40:43], s58 offen offset:256 sc1
  v_mfma_f32_16x16x32_bf16 v[116:119], v[132:135], a[60:63], v[116:119]
  ds_read_b64_tr_b16 v[130:131], v37 offset:60544
  s_waitcnt vmcnt(14)
  s_waitcnt lgkmcnt(6)
  v_mfma_f32_16x16x32_bf16 v[64:67], v[136:139], a[64:67], v[64:67]
  ds_read_b64_tr_b16 v[132:133], v37 offset:56992
  s_add_u32 s58, s79, 262144
  v_mfma_f32_16x16x32_bf16 v[92:95], v[136:139], a[68:71], v[92:95]
  ds_read_b64_tr_b16 v[134:135], v37 offset:60576
  v_mul_f32 v154, v154, v50
  v_mfma_f32_16x16x32_bf16 v[68:71], v[140:143], a[64:67], v[68:71]
  ds_read_b64_tr_b16 v[136:137], v37 offset:57024
  buffer_load_dwordx4 a[128:131], v248, s[40:43], s58 offen sc1
  v_mfma_f32_16x16x32_bf16 v[96:99], v[140:143], a[68:71], v[96:99]
  ds_read_b64_tr_b16 v[138:139], v37 offset:60608
  s_waitcnt lgkmcnt(6)
  v_mfma_f32_16x16x32_bf16 v[72:75], v[144:147], a[64:67], v[72:75]
  ds_read_b64_tr_b16 v[140:141], v37 offset:46080
  buffer_load_dwordx4 a[132:135], v248, s[40:43], s58 offen offset:256 sc1
  v_mfma_f32_16x16x32_bf16 v[100:103], v[144:147], a[68:71], v[100:103]
  ds_read_b64_tr_b16 v[142:143], v37 offset:64000
  v_mul_f32 v154, 0xbdd2d3e8, v154
  v_mfma_f32_16x16x32_bf16 v[76:79], v[148:151], a[64:67], v[76:79]
  ds_read_b64_tr_b16 v[144:145], v37 offset:46112
  s_add_u32 s58, s79, 278528
  v_mfma_f32_16x16x32_bf16 v[104:107], v[148:151], a[68:71], v[104:107]
  ds_read_b64_tr_b16 v[146:147], v37 offset:64032
  s_waitcnt lgkmcnt(6)
  v_mfma_f32_16x16x32_bf16 v[80:83], v[128:131], a[64:67], v[80:83]
  ds_read_b64_tr_b16 v[148:149], v37 offset:46144
  buffer_load_dwordx4 a[136:139], v248, s[40:43], s58 offen sc1
  v_mfma_f32_16x16x32_bf16 v[108:111], v[128:131], a[68:71], v[108:111]
  ds_read_b64_tr_b16 v[150:151], v37 offset:64064
  v_mov_b32 v153, v152
  v_mfma_f32_16x16x32_bf16 v[84:87], v[132:135], a[64:67], v[84:87]
  ds_read_b64_tr_b16 v[128:129], v37 offset:46176
  v_mfma_f32_16x16x32_bf16 v[112:115], v[132:135], a[68:71], v[112:115]
  ds_read_b64_tr_b16 v[130:131], v37 offset:64096
  v_mov_b32 v155, v154
  s_waitcnt lgkmcnt(6)
  v_mfma_f32_16x16x32_bf16 v[88:91], v[136:139], a[64:67], v[88:91]
  ds_read_b64_tr_b16 v[132:133], v37 offset:46208
  buffer_load_dwordx4 a[140:143], v248, s[40:43], s58 offen offset:256 sc1
  v_mfma_f32_16x16x32_bf16 v[116:119], v[136:139], a[68:71], v[116:119]
  ds_read_b64_tr_b16 v[134:135], v37 offset:64128
  v_mov_b32 v157, v156
  s_waitcnt vmcnt(16)
  v_mfma_f32_16x16x32_bf16 v[64:67], v[140:143], a[72:75], v[64:67]
  ds_read_b64_tr_b16 v[136:137], v37 offset:46240
  s_add_u32 s58, s79, 294912
  v_mfma_f32_16x16x32_bf16 v[92:95], v[140:143], a[76:79], v[92:95]
  ds_read_b64_tr_b16 v[138:139], v37 offset:64160
  v_add_f32 v44, v44, v46
  s_waitcnt lgkmcnt(6)
  v_mfma_f32_16x16x32_bf16 v[68:71], v[144:147], a[72:75], v[68:71]
  ds_read_b64_tr_b16 v[140:141], v37 offset:46272
  buffer_load_dwordx4 a[144:147], v248, s[40:43], s58 offen sc1
  v_mfma_f32_16x16x32_bf16 v[96:99], v[144:147], a[76:79], v[96:99]
  ds_read_b64_tr_b16 v[142:143], v37 offset:64192
  v_add_f32 v45, v45, v47
  v_mfma_f32_16x16x32_bf16 v[72:75], v[148:151], a[72:75], v[72:75]
  ds_read_b64_tr_b16 v[144:145], v38 offset:2048
  buffer_load_dwordx4 a[148:151], v248, s[40:43], s58 offen offset:256 sc1
  v_mfma_f32_16x16x32_bf16 v[100:103], v[148:151], a[76:79], v[100:103]
  ds_read_b64_tr_b16 v[146:147], v38 offset:5632
  v_permlane32_swap_b32 v44, v45
  s_waitcnt lgkmcnt(6)
  v_mfma_f32_16x16x32_bf16 v[76:79], v[128:131], a[72:75], v[76:79]
  ds_read_b64_tr_b16 v[148:149], v38 offset:2080
  s_add_u32 s58, s79, 311296
  v_mfma_f32_16x16x32_bf16 v[104:107], v[128:131], a[76:79], v[104:107]
  ds_read_b64_tr_b16 v[150:151], v38 offset:5664
  v_add_f32 v44, v44, v45
  v_mfma_f32_16x16x32_bf16 v[80:83], v[132:135], a[72:75], v[80:83]
  ds_read_b64_tr_b16 v[128:129], v38 offset:2112
  buffer_load_dwordx4 a[152:155], v248, s[40:43], s58 offen sc1
  v_mfma_f32_16x16x32_bf16 v[108:111], v[132:135], a[76:79], v[108:111]
  ds_read_b64_tr_b16 v[130:131], v38 offset:5696
  v_mov_b32 v45, v44
  s_waitcnt lgkmcnt(6)
  v_mfma_f32_16x16x32_bf16 v[84:87], v[136:139], a[72:75], v[84:87]
  ds_read_b64_tr_b16 v[132:133], v38 offset:2144
  buffer_load_dwordx4 a[156:159], v248, s[40:43], s58 offen offset:256 sc1
  v_mfma_f32_16x16x32_bf16 v[112:115], v[136:139], a[76:79], v[112:115]
  ds_read_b64_tr_b16 v[134:135], v38 offset:5728
  v_permlane16_swap_b32 v44, v45
  v_mfma_f32_16x16x32_bf16 v[88:91], v[140:143], a[72:75], v[88:91]
  ds_read_b64_tr_b16 v[136:137], v38 offset:2176
  s_lshl_b32 s62, s93, 6
  v_mfma_f32_16x16x32_bf16 v[116:119], v[140:143], a[76:79], v[116:119]
  ds_read_b64_tr_b16 v[138:139], v38 offset:5760
  v_add_f32 v44, v44, v45
  s_waitcnt vmcnt(18)
  s_waitcnt lgkmcnt(6)
  v_mfma_f32_16x16x32_bf16 v[64:67], v[144:147], a[80:83], v[64:67]
  ds_read_b64_tr_b16 v[140:141], v38 offset:2208
  s_add_u32 s62, s62, 28332032
  v_mfma_f32_16x16x32_bf16 v[92:95], v[144:147], a[84:87], v[92:95]
  ds_read_b64_tr_b16 v[142:143], v38 offset:5792
  v_mov_b32 v45, v44
  v_mfma_f32_16x16x32_bf16 v[68:71], v[148:151], a[80:83], v[68:71]
  ds_read_b64_tr_b16 v[144:145], v38 offset:2240
  v_lshlrev_b32 v6, 4, v3
  v_mfma_f32_16x16x32_bf16 v[96:99], v[148:151], a[84:87], v[96:99]
  ds_read_b64_tr_b16 v[146:147], v38 offset:5824
  v_permlane32_swap_b32 v44, v45
  s_waitcnt lgkmcnt(6)
  v_mfma_f32_16x16x32_bf16 v[72:75], v[128:131], a[80:83], v[72:75]
  ds_read_b64_tr_b16 v[148:149], v38 offset:9216
  buffer_load_dwordx4 v[8:11], v6, s[40:43], s62 offen offset:0 sc1
  v_mfma_f32_16x16x32_bf16 v[100:103], v[128:131], a[84:87], v[100:103]
  ds_read_b64_tr_b16 v[150:151], v38 offset:12800
  v_mul_f32 v52, 0x3acccccd, v44
  v_mfma_f32_16x16x32_bf16 v[76:79], v[132:135], a[80:83], v[76:79]
  ds_read_b64_tr_b16 v[128:129], v38 offset:9248
  buffer_load_dwordx4 v[12:15], v6, s[40:43], s62 offen offset:64 sc1
  v_mfma_f32_16x16x32_bf16 v[104:107], v[132:135], a[84:87], v[104:107]
  ds_read_b64_tr_b16 v[130:131], v38 offset:12832
  v_mul_f32 v54, 0x3acccccd, v45
  s_waitcnt lgkmcnt(6)
  v_mfma_f32_16x16x32_bf16 v[80:83], v[136:139], a[80:83], v[80:83]
  ds_read_b64_tr_b16 v[132:133], v38 offset:9280
  buffer_load_dwordx4 v[16:19], v6, s[40:43], s62 offen offset:128 sc1
  v_mfma_f32_16x16x32_bf16 v[108:111], v[136:139], a[84:87], v[108:111]
  ds_read_b64_tr_b16 v[134:135], v38 offset:12864
  v_fma_f32 v54, -v52, v52, v54
  v_mfma_f32_16x16x32_bf16 v[84:87], v[140:143], a[80:83], v[84:87]
  ds_read_b64_tr_b16 v[136:137], v38 offset:9312
  buffer_load_dwordx4 v[20:23], v6, s[40:43], s62 offen offset:192 sc1
  v_mfma_f32_16x16x32_bf16 v[112:115], v[140:143], a[84:87], v[112:115]
  ds_read_b64_tr_b16 v[138:139], v38 offset:12896
  v_max_f32 v54, 0, v54
  s_waitcnt lgkmcnt(6)
  v_mfma_f32_16x16x32_bf16 v[88:91], v[144:147], a[80:83], v[88:91]
  ds_read_b64_tr_b16 v[140:141], v38 offset:9344
  buffer_load_dwordx4 v[24:27], v6, s[40:43], s62 offen offset:256 sc1
  v_mfma_f32_16x16x32_bf16 v[116:119], v[144:147], a[84:87], v[116:119]
  ds_read_b64_tr_b16 v[142:143], v38 offset:12928
  v_add_f32 v54, 0x3727c5ac, v54
  s_waitcnt vmcnt(21)
  v_mfma_f32_16x16x32_bf16 v[64:67], v[148:151], a[88:91], v[64:67]
  ds_read_b64_tr_b16 v[144:145], v38 offset:9376
  buffer_load_dwordx4 v[28:31], v6, s[40:43], s62 offen offset:320 sc1
  v_mfma_f32_16x16x32_bf16 v[92:95], v[148:151], a[92:95], v[92:95]
  ds_read_b64_tr_b16 v[146:147], v38 offset:12960
  v_rsq_f32 v54, v54
  s_waitcnt lgkmcnt(6)
  v_mfma_f32_16x16x32_bf16 v[68:71], v[128:131], a[88:91], v[68:71]
  ds_read_b64_tr_b16 v[148:149], v38 offset:9408
  buffer_load_dwordx4 v[32:35], v6, s[40:43], s62 offen offset:384 sc1
  v_mfma_f32_16x16x32_bf16 v[96:99], v[128:131], a[92:95], v[96:99]
  ds_read_b64_tr_b16 v[150:151], v38 offset:12992
  v_sub_f32 v52, 0, v52
  v_mfma_f32_16x16x32_bf16 v[72:75], v[132:135], a[88:91], v[72:75]
  s_barrier
  ds_read_b64_tr_b16 v[128:129], v36 offset:3584
  buffer_load_dwordx2 v[240:241], v61, s[40:43], 0 offen sc1
  v_mfma_f32_16x16x32_bf16 v[100:103], v[132:135], a[92:95], v[100:103]
  ds_read_b64_tr_b16 v[130:131], v36 offset:7168
  v_mov_b32 v53, v52
  s_waitcnt lgkmcnt(6)
  v_mfma_f32_16x16x32_bf16 v[76:79], v[136:139], a[88:91], v[76:79]
  ds_read_b64_tr_b16 v[132:133], v36 offset:3616
  buffer_load_dwordx4 a[192:195], v4, s[40:43], s47 offen offset:3072 sc1
  v_mfma_f32_16x16x32_bf16 v[104:107], v[136:139], a[92:95], v[104:107]
  ds_read_b64_tr_b16 v[134:135], v36 offset:7200
  v_mul_f32 v158, 0xc0135761, v54
  v_mfma_f32_16x16x32_bf16 v[80:83], v[140:143], a[88:91], v[80:83]
  ds_read_b64_tr_b16 v[136:137], v36 offset:3648
  v_mfma_f32_16x16x32_bf16 v[108:111], v[140:143], a[92:95], v[108:111]
  ds_read_b64_tr_b16 v[138:139], v36 offset:7232
  v_mul_f32 v160, v54, v54
  s_waitcnt lgkmcnt(6)
  v_mfma_f32_16x16x32_bf16 v[84:87], v[144:147], a[88:91], v[84:87]
  ds_read_b64_tr_b16 v[140:141], v36 offset:3680
  v_mfma_f32_16x16x32_bf16 v[112:115], v[144:147], a[92:95], v[112:115]
  ds_read_b64_tr_b16 v[142:143], v36 offset:7264
  v_rcp_f32 v162, v54
  v_mfma_f32_16x16x32_bf16 v[88:91], v[148:151], a[88:91], v[88:91]
  ds_read_b64_tr_b16 v[144:145], v36 offset:3712
  s_add_u32 s47, s46, 167936
  v_mfma_f32_16x16x32_bf16 v[116:119], v[148:151], a[92:95], v[116:119]
  ds_read_b64_tr_b16 v[146:147], v36 offset:7296
  v_mul_f32 v160, v160, v54
  s_waitcnt vmcnt(23)
  s_waitcnt lgkmcnt(6)
  v_mfma_f32_16x16x32_bf16 v[64:67], v[128:131], a[96:99], v[64:67]
  ds_read_b64_tr_b16 v[148:149], v36 offset:3744
  v_mfma_f32_16x16x32_bf16 v[92:95], v[128:131], a[100:103], v[92:95]
  ds_read_b64_tr_b16 v[150:151], v36 offset:7328
  v_mul_f32 v160, 0xbdd2d3e8, v160
  v_mfma_f32_16x16x32_bf16 v[68:71], v[132:135], a[96:99], v[68:71]
  ds_read_b64_tr_b16 v[128:129], v36 offset:3776
  buffer_load_dwordx4 a[196:199], v4, s[40:43], s47 offen offset:0 sc1
  v_mfma_f32_16x16x32_bf16 v[96:99], v[132:135], a[100:103], v[96:99]
  ds_read_b64_tr_b16 v[130:131], v36 offset:7360
  v_mov_b32 v159, v158
  s_waitcnt lgkmcnt(6)
  v_mfma_f32_16x16x32_bf16 v[72:75], v[136:139], a[96:99], v[72:75]
  ds_read_b64_tr_b16 v[132:133], v36 offset:10752
  v_mfma_f32_16x16x32_bf16 v[100:103], v[136:139], a[100:103], v[100:103]
  ds_read_b64_tr_b16 v[134:135], v36 offset:14336
  v_mov_b32 v161, v160
  v_mfma_f32_16x16x32_bf16 v[76:79], v[140:143], a[96:99], v[76:79]
  ds_read_b64_tr_b16 v[136:137], v36 offset:10784
  s_add_u32 s47, s46, 327680
  v_mfma_f32_16x16x32_bf16 v[104:107], v[140:143], a[100:103], v[104:107]
  ds_read_b64_tr_b16 v[138:139], v36 offset:14368
  v_mov_b32 v163, v162
  s_waitcnt lgkmcnt(6)
  v_mfma_f32_16x16x32_bf16 v[80:83], v[144:147], a[96:99], v[80:83]
  ds_read_b64_tr_b16 v[140:141], v36 offset:10816
  v_mfma_f32_16x16x32_bf16 v[108:111], v[144:147], a[100:103], v[108:111]
  ds_read_b64_tr_b16 v[142:143], v36 offset:14400
  v_lshlrev_b32 v63, 2, v1
  v_mfma_f32_16x16x32_bf16 v[84:87], v[148:151], a[96:99], v[84:87]
  ds_read_b64_tr_b16 v[144:145], v36 offset:10848
  buffer_load_dwordx4 a[200:203], v4, s[40:43], s47 offen offset:0 sc1
  v_mfma_f32_16x16x32_bf16 v[112:115], v[148:151], a[100:103], v[112:115]
  ds_read_b64_tr_b16 v[146:147], v36 offset:14432
  s_lshr_b32 s86, s56, 3
  s_waitcnt lgkmcnt(6)
  v_mfma_f32_16x16x32_bf16 v[88:91], v[128:131], a[96:99], v[88:91]
  ds_read_b64_tr_b16 v[148:149], v36 offset:10880
  v_mfma_f32_16x16x32_bf16 v[116:119], v[128:131], a[100:103], v[116:119]
  ds_read_b64_tr_b16 v[150:151], v36 offset:14464
  s_lshl_b32 s86, s86, 8
  s_waitcnt vmcnt(23)
  v_mfma_f32_16x16x32_bf16 v[64:67], v[132:135], a[104:107], v[64:67]
  ds_read_b64_tr_b16 v[128:129], v36 offset:10912
  v_mfma_f32_16x16x32_bf16 v[92:95], v[132:135], a[108:111], v[92:95]
  ds_read_b64_tr_b16 v[130:131], v36 offset:14496
  s_add_u32 s86, s86, 28364800
  s_waitcnt lgkmcnt(6)
  v_mfma_f32_16x16x32_bf16 v[68:71], v[136:139], a[104:107], v[68:71]
  ds_read_b64_tr_b16 v[132:133], v36 offset:10944
  buffer_load_dwordx4 a[204:207], v4, s[40:43], s47 offen offset:1024 sc1
  v_mfma_f32_16x16x32_bf16 v[96:99], v[136:139], a[108:111], v[96:99]
  ds_read_b64_tr_b16 v[134:135], v36 offset:14528
  s_lshr_b32 s60, s54, 3
  v_mfma_f32_16x16x32_bf16 v[72:75], v[140:143], a[104:107], v[72:75]
  ds_read_b64_tr_b16 v[136:137], v36 offset:0
  v_mfma_f32_16x16x32_bf16 v[100:103], v[140:143], a[108:111], v[100:103]
  ds_read_b64_tr_b16 v[138:139], v36 offset:17920
  s_and_b32 s61, s60, 1
  s_waitcnt lgkmcnt(6)
  v_mfma_f32_16x16x32_bf16 v[76:79], v[144:147], a[104:107], v[76:79]
  ds_read_b64_tr_b16 v[140:141], v36 offset:32
  buffer_load_dwordx4 a[208:211], v4, s[40:43], s47 offen offset:2048 sc1
  v_mfma_f32_16x16x32_bf16 v[104:107], v[144:147], a[108:111], v[104:107]
  ds_read_b64_tr_b16 v[142:143], v36 offset:17952
  s_mul_i32 s61, s61, 27
  v_mfma_f32_16x16x32_bf16 v[80:83], v[148:151], a[104:107], v[80:83]
  ds_read_b64_tr_b16 v[144:145], v36 offset:64
  v_mfma_f32_16x16x32_bf16 v[108:111], v[148:151], a[108:111], v[108:111]
  ds_read_b64_tr_b16 v[146:147], v36 offset:17984
  s_add_u32 s61, s61, s52
  s_waitcnt lgkmcnt(6)
  v_mfma_f32_16x16x32_bf16 v[84:87], v[128:131], a[104:107], v[84:87]
  ds_read_b64_tr_b16 v[148:149], v36 offset:96
  buffer_load_dwordx4 a[212:215], v4, s[40:43], s47 offen offset:3072 sc1
  v_mfma_f32_16x16x32_bf16 v[112:115], v[128:131], a[108:111], v[112:115]
  ds_read_b64_tr_b16 v[150:151], v36 offset:18016
  s_lshl_b32 s61, s61, 10
  v_mfma_f32_16x16x32_bf16 v[88:91], v[132:135], a[104:107], v[88:91]
  ds_read_b64_tr_b16 v[128:129], v36 offset:128
  v_mfma_f32_16x16x32_bf16 v[116:119], v[132:135], a[108:111], v[116:119]
  ds_read_b64_tr_b16 v[130:131], v36 offset:18048
  s_add_u32 s61, s61, s76
  s_waitcnt vmcnt(24)
  s_waitcnt lgkmcnt(6)
  v_mfma_f32_16x16x32_bf16 v[64:67], v[136:139], a[112:115], v[64:67]
  ds_read_b64_tr_b16 v[132:133], v36 offset:160
  s_add_u32 s47, s46, 331776
  v_mfma_f32_16x16x32_bf16 v[92:95], v[136:139], a[116:119], v[92:95]
  ds_read_b64_tr_b16 v[134:135], v36 offset:18080
  s_add_u32 s61, s61, 327680
  v_mfma_f32_16x16x32_bf16 v[68:71], v[140:143], a[112:115], v[68:71]
  ds_read_b64_tr_b16 v[136:137], v36 offset:192
  v_mfma_f32_16x16x32_bf16 v[96:99], v[140:143], a[116:119], v[96:99]
  ds_read_b64_tr_b16 v[138:139], v36 offset:18112
  s_mul_i32 s88, s60, 221184
  s_waitcnt lgkmcnt(6)
  v_mfma_f32_16x16x32_bf16 v[72:75], v[144:147], a[112:115], v[72:75]
  ds_read_b64_tr_b16 v[140:141], v36 offset:21504
  v_mfma_f32_16x16x32_bf16 v[100:103], v[144:147], a[116:119], v[100:103]
  ds_read_b64_tr_b16 v[142:143], v36 offset:25088
  s_add_u32 s88, s88, s61
  v_mfma_f32_16x16x32_bf16 v[76:79], v[148:151], a[112:115], v[76:79]
  ds_read_b64_tr_b16 v[144:145], v36 offset:21536
  buffer_load_dwordx4 a[216:219], v4, s[40:43], s47 offen offset:0 sc1
  v_mfma_f32_16x16x32_bf16 v[104:107], v[148:151], a[116:119], v[104:107]
  ds_read_b64_tr_b16 v[146:147], v36 offset:25120
  s_xor_b32 s60, s60, 1
  s_waitcnt lgkmcnt(6)
  v_mfma_f32_16x16x32_bf16 v[80:83], v[128:131], a[112:115], v[80:83]
  ds_read_b64_tr_b16 v[148:149], v36 offset:21568
  v_mfma_f32_16x16x32_bf16 v[108:111], v[128:131], a[116:119], v[108:111]
  ds_read_b64_tr_b16 v[150:151], v36 offset:25152
  s_mul_i32 s89, s60, 221184
  v_mfma_f32_16x16x32_bf16 v[84:87], v[132:135], a[112:115], v[84:87]
  ds_read_b64_tr_b16 v[128:129], v36 offset:21600
  s_add_u32 s47, s46, 491520
  v_mfma_f32_16x16x32_bf16 v[112:115], v[132:135], a[116:119], v[112:115]
  ds_read_b64_tr_b16 v[130:131], v36 offset:25184
  s_add_u32 s89, s89, s61
  s_waitcnt lgkmcnt(6)
  v_mfma_f32_16x16x32_bf16 v[88:91], v[136:139], a[112:115], v[88:91]
  ds_read_b64_tr_b16 v[132:133], v36 offset:21632
  v_mfma_f32_16x16x32_bf16 v[116:119], v[136:139], a[116:119], v[116:119]
  ds_read_b64_tr_b16 v[134:135], v36 offset:25216
  s_and_b32 s90, s56, 15
  s_waitcnt vmcnt(23)
  v_mfma_f32_16x16x32_bf16 v[64:67], v[140:143], a[120:123], v[64:67]
  ds_read_b64_tr_b16 v[136:137], v36 offset:21664
  buffer_load_dwordx4 a[220:223], v4, s[40:43], s47 offen offset:0 sc1
  v_mfma_f32_16x16x32_bf16 v[92:95], v[140:143], a[124:127], v[92:95]
  ds_read_b64_tr_b16 v[138:139], v36 offset:25248
  s_xor_b32 s90, s90, 4
  s_waitcnt lgkmcnt(6)
  v_mfma_f32_16x16x32_bf16 v[68:71], v[144:147], a[120:123], v[68:71]
  ds_read_b64_tr_b16 v[140:141], v36 offset:21696
  v_mfma_f32_16x16x32_bf16 v[96:99], v[144:147], a[124:127], v[96:99]
  ds_read_b64_tr_b16 v[142:143], v36 offset:25280
  s_lshl_b32 s90, s90, 8
  v_mfma_f32_16x16x32_bf16 v[72:75], v[148:151], a[120:123], v[72:75]
  ds_read_b64_tr_b16 v[144:145], v36 offset:28672
  buffer_load_dwordx4 a[224:227], v4, s[40:43], s47 offen offset:1024 sc1
  v_mfma_f32_16x16x32_bf16 v[100:103], v[148:151], a[124:127], v[100:103]
  ds_read_b64_tr_b16 v[146:147], v36 offset:32256
  s_add_u32 s90, s90, s76
  s_waitcnt lgkmcnt(6)
  v_mfma_f32_16x16x32_bf16 v[76:79], v[128:131], a[120:123], v[76:79]
  ds_read_b64_tr_b16 v[148:149], v36 offset:28704
  v_mfma_f32_16x16x32_bf16 v[104:107], v[128:131], a[124:127], v[104:107]
  ds_read_b64_tr_b16 v[150:151], v36 offset:32288
  s_add_u32 s60, s52, 1
  v_mfma_f32_16x16x32_bf16 v[80:83], v[132:135], a[120:123], v[80:83]
  ds_read_b64_tr_b16 v[128:129], v36 offset:28736
  v_mfma_f32_16x16x32_bf16 v[108:111], v[132:135], a[124:127], v[108:111]
  ds_read_b64_tr_b16 v[130:131], v36 offset:32320
  s_lshr_b32 s60, s60, 2
  s_waitcnt lgkmcnt(6)
  v_mfma_f32_16x16x32_bf16 v[84:87], v[136:139], a[120:123], v[84:87]
  ds_read_b64_tr_b16 v[132:133], v36 offset:28768
  buffer_load_dwordx4 a[228:231], v4, s[40:43], s47 offen offset:2048 sc1
  v_mfma_f32_16x16x32_bf16 v[112:115], v[136:139], a[124:127], v[112:115]
  ds_read_b64_tr_b16 v[134:135], v36 offset:32352
  s_lshl_b32 s60, s60, 31
  v_mfma_f32_16x16x32_bf16 v[88:91], v[140:143], a[120:123], v[88:91]
  ds_read_b64_tr_b16 v[136:137], v36 offset:28800
  v_mfma_f32_16x16x32_bf16 v[116:119], v[140:143], a[124:127], v[116:119]
  ds_read_b64_tr_b16 v[138:139], v36 offset:32384
  v_or_b32 v59, s60, v4
  s_waitcnt vmcnt(24)
  s_waitcnt lgkmcnt(6)
  v_mfma_f32_16x16x32_bf16 v[64:67], v[144:147], a[128:131], v[64:67]
  ds_read_b64_tr_b16 v[140:141], v36 offset:28832
  buffer_load_dwordx4 a[232:235], v4, s[40:43], s47 offen offset:3072 sc1
  v_mfma_f32_16x16x32_bf16 v[92:95], v[144:147], a[132:135], v[92:95]
  ds_read_b64_tr_b16 v[142:143], v36 offset:32416
  v_mfma_f32_16x16x32_bf16 v[68:71], v[148:151], a[128:131], v[68:71]
  ds_read_b64_tr_b16 v[144:145], v36 offset:28864
  v_mfma_f32_16x16x32_bf16 v[96:99], v[148:151], a[132:135], v[96:99]
  ds_read_b64_tr_b16 v[146:147], v36 offset:32448
  s_waitcnt lgkmcnt(6)
  v_mfma_f32_16x16x32_bf16 v[72:75], v[128:131], a[128:131], v[72:75]
  ds_read_b64_tr_b16 v[148:149], v36 offset:39424
  s_add_u32 s47, s46, 495616
  v_mfma_f32_16x16x32_bf16 v[100:103], v[128:131], a[132:135], v[100:103]
  ds_read_b64_tr_b16 v[150:151], v36 offset:43008
  v_mfma_f32_16x16x32_bf16 v[76:79], v[132:135], a[128:131], v[76:79]
  ds_read_b64_tr_b16 v[128:129], v36 offset:39456
  v_mfma_f32_16x16x32_bf16 v[104:107], v[132:135], a[132:135], v[104:107]
  ds_read_b64_tr_b16 v[130:131], v36 offset:43040
  s_waitcnt lgkmcnt(6)
  v_mfma_f32_16x16x32_bf16 v[80:83], v[136:139], a[128:131], v[80:83]
  ds_read_b64_tr_b16 v[132:133], v36 offset:39488
  buffer_load_dwordx4 a[236:239], v4, s[40:43], s47 offen offset:0 sc1
  v_mfma_f32_16x16x32_bf16 v[108:111], v[136:139], a[132:135], v[108:111]
  ds_read_b64_tr_b16 v[134:135], v36 offset:43072
  v_mfma_f32_16x16x32_bf16 v[84:87], v[140:143], a[128:131], v[84:87]
  ds_read_b64_tr_b16 v[136:137], v36 offset:39520
  v_mfma_f32_16x16x32_bf16 v[112:115], v[140:143], a[132:135], v[112:115]
  ds_read_b64_tr_b16 v[138:139], v36 offset:43104
  s_waitcnt lgkmcnt(6)
  v_mfma_f32_16x16x32_bf16 v[88:91], v[144:147], a[128:131], v[88:91]
  ds_read_b64_tr_b16 v[140:141], v36 offset:39552
  v_mfma_f32_16x16x32_bf16 v[116:119], v[144:147], a[132:135], v[116:119]
  ds_read_b64_tr_b16 v[142:143], v36 offset:43136
  s_waitcnt vmcnt(24)
  v_mfma_f32_16x16x32_bf16 v[64:67], v[148:151], a[136:139], v[64:67]
  ds_read_b64_tr_b16 v[144:145], v36 offset:39584
  s_add_u32 s47, s46, 655360
  v_mfma_f32_16x16x32_bf16 v[92:95], v[148:151], a[140:143], v[92:95]
  ds_read_b64_tr_b16 v[146:147], v36 offset:43168
  s_waitcnt lgkmcnt(6)
  v_mfma_f32_16x16x32_bf16 v[68:71], v[128:131], a[136:139], v[68:71]
  ds_read_b64_tr_b16 v[148:149], v36 offset:39616
  v_mfma_f32_16x16x32_bf16 v[96:99], v[128:131], a[140:143], v[96:99]
  ds_read_b64_tr_b16 v[150:151], v36 offset:43200
  v_mfma_f32_16x16x32_bf16 v[72:75], v[132:135], a[136:139], v[72:75]
  ds_read_b64_tr_b16 v[128:129], v36 offset:46592
  buffer_load_dwordx4 a[240:243], v4, s[40:43], s47 offen offset:0 sc1
  v_mfma_f32_16x16x32_bf16 v[100:103], v[132:135], a[140:143], v[100:103]
  ds_read_b64_tr_b16 v[130:131], v36 offset:50176
  s_waitcnt lgkmcnt(6)
  v_mfma_f32_16x16x32_bf16 v[76:79], v[136:139], a[136:139], v[76:79]
  ds_read_b64_tr_b16 v[132:133], v36 offset:46624
  v_mfma_f32_16x16x32_bf16 v[104:107], v[136:139], a[140:143], v[104:107]
  ds_read_b64_tr_b16 v[134:135], v36 offset:50208
  v_mfma_f32_16x16x32_bf16 v[80:83], v[140:143], a[136:139], v[80:83]
  ds_read_b64_tr_b16 v[136:137], v36 offset:46656
  buffer_load_dwordx4 a[244:247], v4, s[40:43], s47 offen offset:1024 sc1
  v_mfma_f32_16x16x32_bf16 v[108:111], v[140:143], a[140:143], v[108:111]
  ds_read_b64_tr_b16 v[138:139], v36 offset:50240
  s_waitcnt lgkmcnt(6)
  v_mfma_f32_16x16x32_bf16 v[84:87], v[144:147], a[136:139], v[84:87]
  ds_read_b64_tr_b16 v[140:141], v36 offset:46688
  v_mfma_f32_16x16x32_bf16 v[112:115], v[144:147], a[140:143], v[112:115]
  ds_read_b64_tr_b16 v[142:143], v36 offset:50272
  v_mfma_f32_16x16x32_bf16 v[88:91], v[148:151], a[136:139], v[88:91]
  ds_read_b64_tr_b16 v[144:145], v36 offset:46720
  buffer_load_dwordx4 a[248:251], v4, s[40:43], s47 offen offset:2048 sc1
  v_mfma_f32_16x16x32_bf16 v[116:119], v[148:151], a[140:143], v[116:119]
  ds_read_b64_tr_b16 v[146:147], v36 offset:50304
  s_waitcnt vmcnt(25)
  s_waitcnt lgkmcnt(6)
  v_mfma_f32_16x16x32_bf16 v[64:67], v[128:131], a[144:147], v[64:67]
  ds_read_b64_tr_b16 v[148:149], v36 offset:46752
  v_mfma_f32_16x16x32_bf16 v[92:95], v[128:131], a[148:151], v[92:95]
  ds_read_b64_tr_b16 v[150:151], v36 offset:50336
  v_mfma_f32_16x16x32_bf16 v[68:71], v[132:135], a[144:147], v[68:71]
  ds_read_b64_tr_b16 v[128:129], v36 offset:46784
  v_mfma_f32_16x16x32_bf16 v[96:99], v[132:135], a[148:151], v[96:99]
  ds_read_b64_tr_b16 v[130:131], v36 offset:50368
  s_waitcnt lgkmcnt(6)
  v_mfma_f32_16x16x32_bf16 v[72:75], v[136:139], a[144:147], v[72:75]
  ds_read_b64_tr_b16 v[132:133], v36 offset:35840
  buffer_load_dwordx4 a[252:255], v4, s[40:43], s47 offen offset:3072 sc1
  v_mfma_f32_16x16x32_bf16 v[100:103], v[136:139], a[148:151], v[100:103]
  ds_read_b64_tr_b16 v[134:135], v36 offset:53760
  v_mfma_f32_16x16x32_bf16 v[76:79], v[140:143], a[144:147], v[76:79]
  ds_read_b64_tr_b16 v[136:137], v36 offset:35872
  v_mfma_f32_16x16x32_bf16 v[104:107], v[140:143], a[148:151], v[104:107]
  ds_read_b64_tr_b16 v[138:139], v36 offset:53792
  s_waitcnt lgkmcnt(6)
  v_mfma_f32_16x16x32_bf16 v[80:83], v[144:147], a[144:147], v[80:83]
  ds_read_b64_tr_b16 v[140:141], v36 offset:35904
  s_add_u32 s47, s46, 659456
  v_mfma_f32_16x16x32_bf16 v[108:111], v[144:147], a[148:151], v[108:111]
  ds_read_b64_tr_b16 v[142:143], v36 offset:53824
  v_mfma_f32_16x16x32_bf16 v[84:87], v[148:151], a[144:147], v[84:87]
  ds_read_b64_tr_b16 v[144:145], v36 offset:35936
  v_mfma_f32_16x16x32_bf16 v[112:115], v[148:151], a[148:151], v[112:115]
  ds_read_b64_tr_b16 v[146:147], v36 offset:53856
  s_waitcnt lgkmcnt(6)
  v_mfma_f32_16x16x32_bf16 v[88:91], v[128:131], a[144:147], v[88:91]
  ds_read_b64_tr_b16 v[148:149], v36 offset:35968
  buffer_load_dwordx4 v[164:167], v4, s[40:43], s47 offen offset:0 sc1
  v_mfma_f32_16x16x32_bf16 v[116:119], v[128:131], a[148:151], v[116:119]
  ds_read_b64_tr_b16 v[150:151], v36 offset:53888
  s_waitcnt vmcnt(25)
  v_mfma_f32_16x16x32_bf16 v[64:67], v[132:135], a[152:155], v[64:67]
  ds_read_b64_tr_b16 v[128:129], v36 offset:36000
  v_mfma_f32_16x16x32_bf16 v[92:95], v[132:135], a[156:159], v[92:95]
  ds_read_b64_tr_b16 v[130:131], v36 offset:53920
  s_waitcnt lgkmcnt(6)
  v_mfma_f32_16x16x32_bf16 v[68:71], v[136:139], a[152:155], v[68:71]
  ds_read_b64_tr_b16 v[132:133], v36 offset:36032
  v_mfma_f32_16x16x32_bf16 v[96:99], v[136:139], a[156:159], v[96:99]
  ds_read_b64_tr_b16 v[134:135], v36 offset:53952
  v_mfma_f32_16x16x32_bf16 v[72:75], v[140:143], a[152:155], v[72:75]
  v_mfma_f32_16x16x32_bf16 v[100:103], v[140:143], a[156:159], v[100:103]
  s_waitcnt lgkmcnt(4)
  v_mfma_f32_16x16x32_bf16 v[76:79], v[144:147], a[152:155], v[76:79]
  v_mfma_f32_16x16x32_bf16 v[104:107], v[144:147], a[156:159], v[104:107]
  v_mfma_f32_16x16x32_bf16 v[80:83], v[148:151], a[152:155], v[80:83]
  v_mfma_f32_16x16x32_bf16 v[108:111], v[148:151], a[156:159], v[108:111]
  s_waitcnt lgkmcnt(0)
  v_mfma_f32_16x16x32_bf16 v[84:87], v[128:131], a[152:155], v[84:87]
  v_mfma_f32_16x16x32_bf16 v[112:115], v[128:131], a[156:159], v[112:115]
  v_mfma_f32_16x16x32_bf16 v[88:91], v[132:135], a[152:155], v[88:91]
  v_mfma_f32_16x16x32_bf16 v[116:119], v[132:135], a[156:159], v[116:119]
  s_waitcnt vmcnt(17)
  v_xor_b32 v240, s3, v240
  v_xor_b32 v241, s3, v241
  v_or_b32 v240, v240, v241
  v_cmp_ne_u32 vcc, 0, v240
  s_nop 4
  s_cbranch_vccz Lg5_ok
  s_mov_b32 s48, 0
Lpoll_49:
  buffer_load_dwordx2 v[240:241], v61, s[40:43], 0 offen sc1
  s_add_u32 s48, s48, 1
  s_cmp_gt_u32 s48, 0x40000
  s_cbranch_scc1 Lend
  s_waitcnt vmcnt(0)
  v_xor_b32 v240, s3, v240
  v_xor_b32 v241, s3, v241
  v_or_b32 v240, v240, v241
  v_cmp_ne_u32 vcc, 0, v240
  s_nop 4
  s_cbranch_vccnz Lpoll_49
Lg5_ok:
  v_pk_fma_f32 v[64:65], v[48:49], v[8:9], v[64:65]
  v_pk_fma_f32 v[66:67], v[48:49], v[10:11], v[66:67]
  v_pk_fma_f32 v[68:69], v[48:49], v[12:13], v[68:69]
  v_pk_fma_f32 v[70:71], v[48:49], v[14:15], v[70:71]
  v_pk_fma_f32 v[72:73], v[48:49], v[16:17], v[72:73]
  v_pk_fma_f32 v[74:75], v[48:49], v[18:19], v[74:75]
  v_pk_fma_f32 v[76:77], v[48:49], v[20:21], v[76:77]
  v_pk_fma_f32 v[78:79], v[48:49], v[22:23], v[78:79]
  v_pk_fma_f32 v[80:81], v[48:49], v[24:25], v[80:81]
  v_pk_fma_f32 v[82:83], v[48:49], v[26:27], v[82:83]
  v_pk_fma_f32 v[84:85], v[48:49], v[28:29], v[84:85]
  v_pk_fma_f32 v[86:87], v[48:49], v[30:31], v[86:87]
  v_pk_fma_f32 v[88:89], v[48:49], v[32:33], v[88:89]
  v_pk_fma_f32 v[90:91], v[48:49], v[34:35], v[90:91]
  v_pk_fma_f32 v[92:93], v[52:53], v[8:9], v[92:93]
  v_pk_fma_f32 v[94:95], v[52:53], v[10:11], v[94:95]
  v_pk_fma_f32 v[96:97], v[52:53], v[12:13], v[96:97]
  v_pk_fma_f32 v[98:99], v[52:53], v[14:15], v[98:99]
  v_pk_fma_f32 v[100:101], v[52:53], v[16:17], v[100:101]
  v_pk_fma_f32 v[102:103], v[52:53], v[18:19], v[102:103]
  v_pk_fma_f32 v[104:105], v[52:53], v[20:21], v[104:105]
  v_pk_fma_f32 v[106:107], v[52:53], v[22:23], v[106:107]
  v_pk_fma_f32 v[108:109], v[52:53], v[24:25], v[108:109]
  v_pk_fma_f32 v[110:111], v[52:53], v[26:27], v[110:111]
  v_pk_fma_f32 v[112:113], v[52:53], v[28:29], v[112:113]
  v_pk_fma_f32 v[114:115], v[52:53], v[30:31], v[114:115]
  v_pk_fma_f32 v[116:117], v[52:53], v[32:33], v[116:117]
  v_pk_fma_f32 v[118:119], v[52:53], v[34:35], v[118:119]
  v_pk_mul_f32 v[120:121], v[64:65], v[64:65]
  v_pk_mul_f32 v[122:123], v[66:67], v[66:67]
  v_pk_mul_f32 v[124:125], v[68:69], v[68:69]
  v_pk_mul_f32 v[126:127], v[70:71], v[70:71]
  v_pk_mul_f32 v[128:129], v[72:73], v[72:73]
  v_pk_mul_f32 v[130:131], v[74:75], v[74:75]
  v_pk_mul_f32 v[132:133], v[76:77], v[76:77]
  v_pk_mul_f32 v[134:135], v[78:79], v[78:79]
  v_pk_mul_f32 v[136:137], v[80:81], v[80:81]
  v_pk_mul_f32 v[138:139], v[82:83], v[82:83]
  s_add_u32 s47, s46, 819200
  v_pk_mul_f32 v[140:141], v[84:85], v[84:85]
  v_pk_mul_f32 v[142:143], v[86:87], v[86:87]
  v_pk_mul_f32 v[144:145], v[88:89], v[88:89]
  v_pk_mul_f32 v[146:147], v[90:91], v[90:91]
  v_pk_fma_f32 v[120:121], v[120:121], v[154:155], v[152:153]
  v_pk_fma_f32 v[122:123], v[122:123], v[154:155], v[152:153]
  v_pk_fma_f32 v[124:125], v[124:125], v[154:155], v[152:153]
  v_pk_fma_f32 v[126:127], v[126:127], v[154:155], v[152:153]
  v_pk_fma_f32 v[128:129], v[128:129], v[154:155], v[152:153]
  v_pk_fma_f32 v[130:131], v[130:131], v[154:155], v[152:153]
  buffer_load_dwordx4 v[168:171], v4, s[40:43], s47 offen offset:0 sc1
  v_pk_fma_f32 v[132:133], v[132:133], v[154:155], v[152:153]
  v_pk_fma_f32 v[134:135], v[134:135], v[154:155], v[152:153]
  v_pk_fma_f32 v[136:137], v[136:137], v[154:155], v[152:153]
  v_pk_fma_f32 v[138:139], v[138:139], v[154:155], v[152:153]
  v_pk_fma_f32 v[140:141], v[140:141], v[154:155], v[152:153]
  v_pk_fma_f32 v[142:143], v[142:143], v[154:155], v[152:153]
  v_pk_fma_f32 v[144:145], v[144:145], v[154:155], v[152:153]
  v_pk_fma_f32 v[146:147], v[146:147], v[154:155], v[152:153]
  v_pk_mul_f32 v[120:121], v[120:121], v[64:65]
  v_pk_mul_f32 v[122:123], v[122:123], v[66:67]
  buffer_load_dwordx4 v[172:175], v4, s[40:43], s47 offen offset:1024 sc1
  v_pk_mul_f32 v[124:125], v[124:125], v[68:69]
  v_pk_mul_f32 v[126:127], v[126:127], v[70:71]
  v_pk_mul_f32 v[128:129], v[128:129], v[72:73]
  v_pk_mul_f32 v[130:131], v[130:131], v[74:75]
  v_pk_mul_f32 v[132:133], v[132:133], v[76:77]
  v_pk_mul_f32 v[134:135], v[134:135], v[78:79]
  v_pk_mul_f32 v[136:137], v[136:137], v[80:81]
  v_pk_mul_f32 v[138:139], v[138:139], v[82:83]
  v_pk_mul_f32 v[140:141], v[140:141], v[84:85]
  v_pk_mul_f32 v[142:143], v[142:143], v[86:87]
  buffer_load_dwordx4 v[176:179], v4, s[40:43], s47 offen offset:2048 sc1
  v_pk_mul_f32 v[144:145], v[144:145], v[88:89]
  v_pk_mul_f32 v[146:147], v[146:147], v[90:91]
  v_exp_f32 v120, v120
  v_exp_f32 v121, v121
  v_exp_f32 v122, v122
  v_exp_f32 v123, v123
  v_exp_f32 v124, v124
  v_exp_f32 v125, v125
  v_exp_f32 v126, v126
  v_exp_f32 v127, v127
  buffer_load_dwordx4 v[180:183], v4, s[40:43], s47 offen offset:3072 sc1
  v_exp_f32 v128, v128
  v_exp_f32 v129, v129
  v_exp_f32 v130, v130
  v_exp_f32 v131, v131
  v_exp_f32 v132, v132
  v_exp_f32 v133, v133
  v_exp_f32 v134, v134
  v_exp_f32 v135, v135
  v_exp_f32 v136, v136
  v_exp_f32 v137, v137
  s_add_u32 s47, s46, 823296
  v_exp_f32 v138, v138
  v_exp_f32 v139, v139
  v_exp_f32 v140, v140
  v_exp_f32 v141, v141
  v_exp_f32 v142, v142
  v_exp_f32 v143, v143
  v_exp_f32 v144, v144
  v_exp_f32 v145, v145
  v_exp_f32 v146, v146
  v_exp_f32 v147, v147
  buffer_load_dwordx4 v[184:187], v4, s[40:43], s47 offen offset:0 sc1
  v_pk_fma_f32 v[120:121], v[120:121], v[156:157], v[156:157]
  v_pk_fma_f32 v[122:123], v[122:123], v[156:157], v[156:157]
  v_pk_fma_f32 v[124:125], v[124:125], v[156:157], v[156:157]
  v_pk_fma_f32 v[126:127], v[126:127], v[156:157], v[156:157]
  v_pk_fma_f32 v[128:129], v[128:129], v[156:157], v[156:157]
  v_pk_fma_f32 v[130:131], v[130:131], v[156:157], v[156:157]
  v_pk_fma_f32 v[132:133], v[132:133], v[156:157], v[156:157]
  v_pk_fma_f32 v[134:135], v[134:135], v[156:157], v[156:157]
  v_pk_fma_f32 v[136:137], v[136:137], v[156:157], v[156:157]
  v_pk_fma_f32 v[138:139], v[138:139], v[156:157], v[156:157]
  v_pk_fma_f32 v[140:141], v[140:141], v[156:157], v[156:157]
  v_pk_fma_f32 v[142:143], v[142:143], v[156:157], v[156:157]
  v_pk_fma_f32 v[144:145], v[144:145], v[156:157], v[156:157]
  v_pk_fma_f32 v[146:147], v[146:147], v[156:157], v[156:157]
  v_rcp_f32 v120, v120
  v_rcp_f32 v121, v121
  v_rcp_f32 v122, v122
  v_rcp_f32 v123, v123
  v_rcp_f32 v124, v124
  v_rcp_f32 v125, v125
  v_rcp_f32 v126, v126
  v_rcp_f32 v127, v127
  v_rcp_f32 v128, v128
  v_rcp_f32 v129, v129
  v_rcp_f32 v130, v130
  v_rcp_f32 v131, v131
  v_rcp_f32 v132, v132
  v_rcp_f32 v133, v133
  v_rcp_f32 v134, v134
  v_rcp_f32 v135, v135
  v_rcp_f32 v136, v136
  v_rcp_f32 v137, v137
  v_rcp_f32 v138, v138
  v_rcp_f32 v139, v139
  v_rcp_f32 v140, v140
  v_rcp_f32 v141, v141
  v_rcp_f32 v142, v142
  v_rcp_f32 v143, v143
  v_rcp_f32 v144, v144
  v_rcp_f32 v145, v145
  v_rcp_f32 v146, v146
  v_rcp_f32 v147, v147
  v_pk_mul_f32 v[120:121], v[120:121], v[64:65]
  v_pk_mul_f32 v[122:123], v[122:123], v[66:67]
  v_pk_mul_f32 v[124:125], v[124:125], v[68:69]
  v_pk_mul_f32 v[126:127], v[126:127], v[70:71]
  v_pk_mul_f32 v[128:129], v[128:129], v[72:73]
  v_pk_mul_f32 v[130:131], v[130:131], v[74:75]
  v_pk_mul_f32 v[132:133], v[132:133], v[76:77]
  v_pk_mul_f32 v[134:135], v[134:135], v[78:79]
  v_pk_mul_f32 v[136:137], v[136:137], v[80:81]
  v_pk_mul_f32 v[138:139], v[138:139], v[82:83]
  v_pk_mul_f32 v[140:141], v[140:141], v[84:85]
  v_pk_mul_f32 v[142:143], v[142:143], v[86:87]
  v_pk_mul_f32 v[144:145], v[144:145], v[88:89]
  v_pk_mul_f32 v[146:147], v[146:147], v[90:91]
  v_cvt_pk_bf16_f32 v8, v120, v121
  v_cvt_pk_bf16_f32 v9, v122, v123
  v_cvt_pk_bf16_f32 v10, v124, v125
  v_cvt_pk_bf16_f32 v11, v126, v127
  v_cvt_pk_bf16_f32 v12, v128, v129
  v_cvt_pk_bf16_f32 v13, v130, v131
  v_cvt_pk_bf16_f32 v14, v132, v133
  v_cvt_pk_bf16_f32 v15, v134, v135
  v_cvt_pk_bf16_f32 v16, v136, v137
  v_cvt_pk_bf16_f32 v17, v138, v139
  v_cvt_pk_bf16_f32 v18, v140, v141
  v_cvt_pk_bf16_f32 v19, v142, v143
  v_cvt_pk_bf16_f32 v20, v144, v145
  v_cvt_pk_bf16_f32 v21, v146, v147
  s_cmp_eq_u32 s55, 0
  s_cbranch_scc1 Lsafe_50
  s_cmp_eq_u32 s92, 15
  s_cbranch_scc1 Lskip15_52
  buffer_store_dwordx4 v[8:11], v4, s[40:43], s72 offen offset:0
  buffer_store_dwordx4 v[12:15], v4, s[40:43], s72 offen offset:1024
  s_nop 1
Lskip15_52:
  buffer_store_dwordx4 v[16:19], v4, s[40:43], s72 offen offset:2048
  buffer_store_dwordx2 v[20:21], v4, s[40:43], s73 offen
  s_branch Ljoin_51
Lsafe_50:
  s_cmp_eq_u32 s92, 15
  s_cbranch_scc1 Lskip15_53
  buffer_store_dwordx4 v[8:11], v4, s[40:43], s72 offen offset:0 sc1
  buffer_store_dwordx4 v[12:15], v4, s[40:43], s72 offen offset:1024 sc1
  s_nop 1
Lskip15_53:
  buffer_store_dwordx4 v[16:19], v4, s[40:43], s72 offen offset:2048 sc1
  buffer_store_dwordx2 v[20:21], v4, s[40:43], s73 offen sc1
Ljoin_51:
  v_pk_mul_f32 v[120:121], v[92:93], v[92:93]
  v_pk_mul_f32 v[122:123], v[94:95], v[94:95]
  v_pk_mul_f32 v[124:125], v[96:97], v[96:97]
  v_pk_mul_f32 v[126:127], v[98:99], v[98:99]
  v_pk_mul_f32 v[128:129], v[100:101], v[100:101]
  v_pk_mul_f32 v[130:131], v[102:103], v[102:103]
  v_pk_mul_f32 v[132:133], v[104:105], v[104:105]
  v_pk_mul_f32 v[134:135], v[106:107], v[106:107]
  v_pk_mul_f32 v[136:137], v[108:109], v[108:109]
  v_pk_mul_f32 v[138:139], v[110:111], v[110:111]
  v_pk_mul_f32 v[140:141], v[112:113], v[112:113]
  v_pk_mul_f32 v[142:143], v[114:115], v[114:115]
  v_pk_mul_f32 v[144:145], v[116:117], v[116:117]
  v_pk_mul_f32 v[146:147], v[118:119], v[118:119]
  v_pk_fma_f32 v[120:121], v[120:121], v[160:161], v[158:159]
  v_pk_fma_f32 v[122:123], v[122:123], v[160:161], v[158:159]
  v_pk_fma_f32 v[124:125], v[124:125], v[160:161], v[158:159]
  v_pk_fma_f32 v[126:127], v[126:127], v[160:161], v[158:159]
  v_pk_fma_f32 v[128:129], v[128:129], v[160:161], v[158:159]
  v_pk_fma_f32 v[130:131], v[130:131], v[160:161], v[158:159]
  v_pk_fma_f32 v[132:133], v[132:133], v[160:161], v[158:159]
  v_pk_fma_f32 v[134:135], v[134:135], v[160:161], v[158:159]
  v_pk_fma_f32 v[136:137], v[136:137], v[160:161], v[158:159]
  v_pk_fma_f32 v[138:139], v[138:139], v[160:161], v[158:159]
  v_pk_fma_f32 v[140:141], v[140:141], v[160:161], v[158:159]
  v_pk_fma_f32 v[142:143], v[142:143], v[160:161], v[158:159]
  v_pk_fma_f32 v[144:145], v[144:145], v[160:161], v[158:159]
  v_pk_fma_f32 v[146:147], v[146:147], v[160:161], v[158:159]
  v_pk_mul_f32 v[120:121], v[120:121], v[92:93]
  v_pk_mul_f32 v[122:123], v[122:123], v[94:95]
  v_pk_mul_f32 v[124:125], v[124:125], v[96:97]
  v_pk_mul_f32 v[126:127], v[126:127], v[98:99]
  v_pk_mul_f32 v[128:129], v[128:129], v[100:101]
  v_pk_mul_f32 v[130:131], v[130:131], v[102:103]
  v_pk_mul_f32 v[132:133], v[132:133], v[104:105]
  v_pk_mul_f32 v[134:135], v[134:135], v[106:107]
  v_pk_mul_f32 v[136:137], v[136:137], v[108:109]
  v_pk_mul_f32 v[138:139], v[138:139], v[110:111]
  v_pk_mul_f32 v[140:141], v[140:141], v[112:113]
  v_pk_mul_f32 v[142:143], v[142:143], v[114:115]
  v_pk_mul_f32 v[144:145], v[144:145], v[116:117]
  v_pk_mul_f32 v[146:147], v[146:147], v[118:119]
  v_exp_f32 v120, v120
  v_exp_f32 v121, v121
  v_exp_f32 v122, v122
  v_exp_f32 v123, v123
  v_exp_f32 v124, v124
  v_exp_f32 v125, v125
  v_exp_f32 v126, v126
  v_exp_f32 v127, v127
  v_exp_f32 v128, v128
  v_exp_f32 v129, v129
  v_exp_f32 v130, v130
  v_exp_f32 v131, v131
  v_exp_f32 v132, v132
  v_exp_f32 v133, v133
  v_exp_f32 v134, v134
  v_exp_f32 v135, v135
  v_exp_f32 v136, v136
  v_exp_f32 v137, v137
  v_exp_f32 v138, v138
  v_exp_f32 v139, v139
  v_exp_f32 v140, v140
  v_exp_f32 v141, v141
  v_exp_f32 v142, v142
  v_exp_f32 v143, v143
  v_exp_f32 v144, v144
  v_exp_f32 v145, v145
  v_exp_f32 v146, v146
  v_exp_f32 v147, v147
  v_pk_fma_f32 v[120:121], v[120:121], v[162:163], v[162:163]
  v_pk_fma_f32 v[122:123], v[122:123], v[162:163], v[162:163]
  v_pk_fma_f32 v[124:125], v[124:125], v[162:163], v[162:163]
  v_pk_fma_f32 v[126:127], v[126:127], v[162:163], v[162:163]
  v_pk_fma_f32 v[128:129], v[128:129], v[162:163], v[162:163]
  v_pk_fma_f32 v[130:131], v[130:131], v[162:163], v[162:163]
  v_pk_fma_f32 v[132:133], v[132:133], v[162:163], v[162:163]
  v_pk_fma_f32 v[134:135], v[134:135], v[162:163], v[162:163]
  v_pk_fma_f32 v[136:137], v[136:137], v[162:163], v[162:163]
  v_pk_fma_f32 v[138:139], v[138:139], v[162:163], v[162:163]
  v_pk_fma_f32 v[140:141], v[140:141], v[162:163], v[162:163]
  v_pk_fma_f32 v[142:143], v[142:143], v[162:163], v[162:163]
  v_pk_fma_f32 v[144:145], v[144:145], v[162:163], v[162:163]
  v_pk_fma_f32 v[146:147], v[146:147], v[162:163], v[162:163]
  v_rcp_f32 v120, v120
  v_rcp_f32 v121, v121
  v_rcp_f32 v122, v122
  v_rcp_f32 v123, v123
  v_rcp_f32 v124, v124
  v_rcp_f32 v125, v125
  v_rcp_f32 v126, v126
  v_rcp_f32 v127, v127
  v_rcp_f32 v128, v128
  v_rcp_f32 v129, v129
  v_rcp_f32 v130, v130
  v_rcp_f32 v131, v131
  v_rcp_f32 v132, v132
  v_rcp_f32 v133, v133
  v_rcp_f32 v134, v134
  v_rcp_f32 v135, v135
  v_rcp_f32 v136, v136
  v_rcp_f32 v137, v137
  v_rcp_f32 v138, v138
  v_rcp_f32 v139, v139
  v_rcp_f32 v140, v140
  v_rcp_f32 v141, v141
  v_rcp_f32 v142, v142
  v_rcp_f32 v143, v143
  v_rcp_f32 v144, v144
  v_rcp_f32 v145, v145
  v_rcp_f32 v146, v146
  v_rcp_f32 v147, v147
  v_pk_mul_f32 v[120:121], v[120:121], v[92:93]
  v_pk_mul_f32 v[122:123], v[122:123], v[94:95]
  v_pk_mul_f32 v[124:125], v[124:125], v[96:97]
  v_pk_mul_f32 v[126:127], v[126:127], v[98:99]
  v_pk_mul_f32 v[128:129], v[128:129], v[100:101]
  v_pk_mul_f32 v[130:131], v[130:131], v[102:103]
  v_pk_mul_f32 v[132:133], v[132:133], v[104:105]
  v_pk_mul_f32 v[134:135], v[134:135], v[106:107]
  v_pk_mul_f32 v[136:137], v[136:137], v[108:109]
  v_pk_mul_f32 v[138:139], v[138:139], v[110:111]
  v_pk_mul_f32 v[140:141], v[140:141], v[112:113]
  v_pk_mul_f32 v[142:143], v[142:143], v[114:115]
  v_pk_mul_f32 v[144:145], v[144:145], v[116:117]
  v_pk_mul_f32 v[146:147], v[146:147], v[118:119]
  v_cvt_pk_bf16_f32 v24, v120, v121
  v_cvt_pk_bf16_f32 v25, v122, v123
  v_cvt_pk_bf16_f32 v26, v124, v125
  v_cvt_pk_bf16_f32 v27, v126, v127
  v_cvt_pk_bf16_f32 v28, v128, v129
  v_cvt_pk_bf16_f32 v29, v130, v131
  v_cvt_pk_bf16_f32 v30, v132, v133
  v_cvt_pk_bf16_f32 v31, v134, v135
  v_cvt_pk_bf16_f32 v32, v136, v137
  v_cvt_pk_bf16_f32 v33, v138, v139
  v_cvt_pk_bf16_f32 v34, v140, v141
  v_cvt_pk_bf16_f32 v35, v142, v143
  v_cvt_pk_bf16_f32 v36, v144, v145
  v_cvt_pk_bf16_f32 v37, v146, v147
  s_cmp_eq_u32 s55, 0
  s_cbranch_scc1 Lsafe_54
  s_cmp_eq_u32 s92, 15
  s_cbranch_scc1 Lskip15_56
  buffer_store_dwordx4 v[24:27], v4, s[40:43], s74 offen offset:0
  buffer_store_dwordx4 v[28:31], v4, s[40:43], s74 offen offset:1024
  s_nop 1
Lskip15_56:
  buffer_store_dwordx4 v[32:35], v4, s[40:43], s74 offen offset:2048
  buffer_store_dwordx2 v[36:37], v4, s[40:43], s75 offen
  s_branch Ljoin_55
Lsafe_54:
  s_cmp_eq_u32 s92, 15
  s_cbranch_scc1 Lskip15_57
  buffer_store_dwordx4 v[24:27], v4, s[40:43], s74 offen offset:0 sc1
  buffer_store_dwordx4 v[28:31], v4, s[40:43], s74 offen offset:1024 sc1
  s_nop 1
Lskip15_57:
  buffer_store_dwordx4 v[32:35], v4, s[40:43], s74 offen offset:2048 sc1
  buffer_store_dwordx2 v[36:37], v4, s[40:43], s75 offen sc1
Ljoin_55:
  s_lshl_b32 s58, s94, 4
  s_add_u32 s58, s58, s92
  s_lshl_b32 s58, s58, 2
  s_add_u32 s58, s58, 28364800
  s_waitcnt vmcnt(0)
  v_mov_b32 v6, s3
  s_mov_b64 exec, 1
  s_cmp_eq_u32 s55, 0
  s_cbranch_scc1 Lsafe_58
  buffer_store_dword v6, v251, s[40:43], s58 offen
  s_branch Ljoin_59
Lsafe_58:
  buffer_store_dword v6, v251, s[40:43], s58 offen sc1
Ljoin_59:
  s_mov_b64 exec, -1
  s_add_u32 s47, s46, 983040
  buffer_load_dwordx4 v[188:191], v59, s[40:43], s47 offen offset:0 sc1
  buffer_load_dwordx4 v[192:195], v59, s[40:43], s47 offen offset:1024 sc1
  buffer_load_dwordx4 v[196:199], v59, s[40:43], s47 offen offset:2048 sc1
  buffer_load_dwordx4 v[200:203], v59, s[40:43], s47 offen offset:3072 sc1
  s_add_u32 s47, s46, 987136
  buffer_load_dwordx4 v[204:207], v59, s[40:43], s47 offen offset:0 sc1
  s_barrier
  s_mov_b32 s48, 0
Lpoll_60:
  buffer_load_dword v240, v63, s[40:43], s86 offen sc1
  s_add_u32 s48, s48, 1
  s_cmp_gt_u32 s48, 0x40000
  s_cbranch_scc1 Lend
  s_waitcnt vmcnt(0)
  v_cmp_ne_u32 vcc, s3, v240
  s_nop 4
  s_cbranch_vccnz Lpoll_60
  s_mul_i32 s78, s82, 55296
  s_add_u32 s78, s78, s89
  buffer_load_dwordx4 a[0:3], v4, s[40:43], s78 offen sc1
  s_add_u32 s78, s78, 4096
  buffer_load_dwordx4 a[4:7], v4, s[40:43], s78 offen sc1
  s_add_u32 s78, s78, 4096
  buffer_load_dwordx4 a[8:11], v4, s[40:43], s78 offen sc1
  s_add_u32 s78, s78, 4096
  buffer_load_dwordx4 a[12:15], v4, s[40:43], s78 offen sc1
  s_add_u32 s78, s78, 4096
  buffer_load_dwordx4 a[16:19], v4, s[40:43], s78 offen sc1
  s_add_u32 s78, s78, 4096
  buffer_load_dwordx4 a[20:23], v4, s[40:43], s78 offen sc1
  s_add_u32 s78, s78, 4096
  s_waitcnt vmcnt(5)
  v_mfma_f32_16x16x32_bf16 v[8:11], a[160:163], a[0:3], 0
  buffer_load_dwordx4 a[24:27], v59, s[40:43], s78 offen sc1
  v_mfma_f32_16x16x32_bf16 v[12:15], a[164:167], a[0:3], 0
  s_mul_i32 s78, s83, 55296
  v_mfma_f32_16x16x32_bf16 v[16:19], a[168:171], a[0:3], 0
  v_mfma_f32_16x16x32_bf16 v[20:23], a[172:175], a[0:3], 0
  s_add_u32 s78, s78, s89
  v_mfma_f32_16x16x32_bf16 v[24:27], a[176:179], a[0:3], 0
  buffer_load_dwordx4 a[28:31], v4, s[40:43], s78 offen sc1
  s_waitcnt vmcnt(6)
  v_mfma_f32_16x16x32_bf16 v[8:11], a[180:183], a[4:7], v[8:11]
  v_mfma_f32_16x16x32_bf16 v[12:15], a[184:187], a[4:7], v[12:15]
  s_add_u32 s78, s78, 4096
  v_mfma_f32_16x16x32_bf16 v[16:19], a[188:191], a[4:7], v[16:19]
  buffer_load_dwordx4 a[32:35], v4, s[40:43], s78 offen sc1
  v_mfma_f32_16x16x32_bf16 v[20:23], a[192:195], a[4:7], v[20:23]
  v_mfma_f32_16x16x32_bf16 v[24:27], a[196:199], a[4:7], v[24:27]
  s_add_u32 s78, s78, 4096
  s_waitcnt vmcnt(6)
  v_mfma_f32_16x16x32_bf16 v[8:11], a[200:203], a[8:11], v[8:11]
  buffer_load_dwordx4 a[36:39], v4, s[40:43], s78 offen sc1
  v_mfma_f32_16x16x32_bf16 v[12:15], a[204:207], a[8:11], v[12:15]
  v_mfma_f32_16x16x32_bf16 v[16:19], a[208:211], a[8:11], v[16:19]
  s_add_u32 s78, s78, 4096
  v_mfma_f32_16x16x32_bf16 v[20:23], a[212:215], a[8:11], v[20:23]
  buffer_load_dwordx4 a[40:43], v4, s[40:43], s78 offen sc1
  v_mfma_f32_16x16x32_bf16 v[24:27], a[216:219], a[8:11], v[24:27]
  s_waitcnt vmcnt(7)
  v_mfma_f32_16x16x32_bf16 v[8:11], a[220:223], a[12:15], v[8:11]
  s_add_u32 s78, s78, 4096
  v_mfma_f32_16x16x32_bf16 v[12:15], a[224:227], a[12:15], v[12:15]
  buffer_load_dwordx4 a[44:47], v4, s[40:43], s78 offen sc1
  v_mfma_f32_16x16x32_bf16 v[16:19], a[228:231], a[12:15], v[16:19]
  v_mfma_f32_16x16x32_bf16 v[20:23], a[232:235], a[12:15], v[20:23]
  s_add_u32 s78, s78, 4096
  v_mfma_f32_16x16x32_bf16 v[24:27], a[236:239], a[12:15], v[24:27]
  buffer_load_dwordx4 a[48:51], v4, s[40:43], s78 offen sc1
  s_waitcnt vmcnt(8)
  v_mfma_f32_16x16x32_bf16 v[8:11], a[240:243], a[16:19], v[8:11]
  v_mfma_f32_16x16x32_bf16 v[12:15], a[244:247], a[16:19], v[12:15]
  s_add_u32 s78, s78, 4096
  v_mfma_f32_16x16x32_bf16 v[16:19], a[248:251], a[16:19], v[16:19]
  buffer_load_dwordx4 a[52:55], v59, s[40:43], s78 offen sc1
  v_mfma_f32_16x16x32_bf16 v[20:23], a[252:255], a[16:19], v[20:23]
  v_mfma_f32_16x16x32_bf16 v[24:27], v[164:167], a[16:19], v[24:27]
  s_mul_i32 s78, s84, 55296
  s_waitcnt vmcnt(8)
  v_mfma_f32_16x16x32_bf16 v[8:11], v[168:171], a[20:23], v[8:11]
  s_add_u32 s78, s78, s89
  v_mfma_f32_16x16x32_bf16 v[12:15], v[172:175], a[20:23], v[12:15]
  v_mfma_f32_16x16x32_bf16 v[16:19], v[176:179], a[20:23], v[16:19]
  buffer_load_dwordx4 a[56:59], v4, s[40:43], s78 offen sc1
  v_mfma_f32_16x16x32_bf16 v[20:23], v[180:183], a[20:23], v[20:23]
  s_add_u32 s78, s78, 4096
  v_mfma_f32_16x16x32_bf16 v[24:27], v[184:187], a[20:23], v[24:27]
  s_waitcnt vmcnt(8)
  v_mfma_f32_16x16x32_bf16 v[8:11], v[188:191], a[24:27], v[8:11]
  buffer_load_dwordx4 a[60:63], v4, s[40:43], s78 offen sc1
  v_mfma_f32_16x16x32_bf16 v[12:15], v[192:195], a[24:27], v[12:15]
  s_add_u32 s78, s78, 4096
  v_mfma_f32_16x16x32_bf16 v[16:19], v[196:199], a[24:27], v[16:19]
  v_mfma_f32_16x16x32_bf16 v[20:23], v[200:203], a[24:27], v[20:23]
  buffer_load_dwordx4 a[64:67], v4, s[40:43], s78 offen sc1
  v_mfma_f32_16x16x32_bf16 v[24:27], v[204:207], a[24:27], v[24:27]
  s_add_u32 s78, s78, 4096
  s_waitcnt vmcnt(9)
  v_mfma_f32_16x16x32_bf16 v[28:31], a[160:163], a[28:31], 0
  v_mfma_f32_16x16x32_bf16 v[32:35], a[164:167], a[28:31], 0
  buffer_load_dwordx4 a[68:71], v4, s[40:43], s78 offen sc1
  v_mfma_f32_16x16x32_bf16 v[36:39], a[168:171], a[28:31], 0
  ds_write_b128 v253, v[8:11] offset:0
  v_mfma_f32_16x16x32_bf16 v[40:43], a[172:175], a[28:31], 0
  s_add_u32 s78, s78, 4096
  v_mfma_f32_16x16x32_bf16 v[44:47], a[176:179], a[28:31], 0
  s_waitcnt vmcnt(9)
  v_mfma_f32_16x16x32_bf16 v[28:31], a[180:183], a[32:35], v[28:31]
  ds_write_b128 v253, v[12:15] offset:1024
  v_mfma_f32_16x16x32_bf16 v[32:35], a[184:187], a[32:35], v[32:35]
  buffer_load_dwordx4 a[72:75], v4, s[40:43], s78 offen sc1
  v_mfma_f32_16x16x32_bf16 v[36:39], a[188:191], a[32:35], v[36:39]
  s_add_u32 s78, s78, 4096
  v_mfma_f32_16x16x32_bf16 v[40:43], a[192:195], a[32:35], v[40:43]
  ds_write_b128 v253, v[16:19] offset:2048
  v_mfma_f32_16x16x32_bf16 v[44:47], a[196:199], a[32:35], v[44:47]
  s_waitcnt vmcnt(9)
  v_mfma_f32_16x16x32_bf16 v[28:31], a[200:203], a[36:39], v[28:31]
  buffer_load_dwordx4 a[76:79], v4, s[40:43], s78 offen sc1
  v_mfma_f32_16x16x32_bf16 v[32:35], a[204:207], a[36:39], v[32:35]
  ds_write_b128 v253, v[20:23] offset:3072
  v_mfma_f32_16x16x32_bf16 v[36:39], a[208:211], a[36:39], v[36:39]
  s_add_u32 s78, s78, 4096
  v_mfma_f32_16x16x32_bf16 v[40:43], a[212:215], a[36:39], v[40:43]
  v_mfma_f32_16x16x32_bf16 v[44:47], a[216:219], a[36:39], v[44:47]
  ds_write_b128 v253, v[24:27] offset:4096
  s_waitcnt vmcnt(9)
  v_mfma_f32_16x16x32_bf16 v[28:31], a[220:223], a[40:43], v[28:31]
  buffer_load_dwordx4 a[80:83], v59, s[40:43], s78 offen sc1
  v_mfma_f32_16x16x32_bf16 v[32:35], a[224:227], a[40:43], v[32:35]
  s_mul_i32 s78, s85, 55296
  v_mfma_f32_16x16x32_bf16 v[36:39], a[228:231], a[40:43], v[36:39]
  v_mfma_f32_16x16x32_bf16 v[40:43], a[232:235], a[40:43], v[40:43]
  s_add_u32 s78, s78, s89
  v_mfma_f32_16x16x32_bf16 v[44:47], a[236:239], a[40:43], v[44:47]
  buffer_load_dwordx4 a[84:87], v4, s[40:43], s78 offen sc1
  s_waitcnt vmcnt(10)
  v_mfma_f32_16x16x32_bf16 v[28:31], a[240:243], a[44:47], v[28:31]
  v_mfma_f32_16x16x32_bf16 v[32:35], a[244:247], a[44:47], v[32:35]
  s_add_u32 s78, s78, 4096
  v_mfma_f32_16x16x32_bf16 v[36:39], a[248:251], a[44:47], v[36:39]
  buffer_load_dwordx4 a[88:91], v4, s[40:43], s78 offen sc1
  v_mfma_f32_16x16x32_bf16 v[40:43], a[252:255], a[44:47], v[40:43]
  v_mfma_f32_16x16x32_bf16 v[44:47], v[164:167], a[44:47], v[44:47]
  s_add_u32 s78, s78, 4096
  s_waitcnt vmcnt(10)
  v_mfma_f32_16x16x32_bf16 v[28:31], v[168:171], a[48:51], v[28:31]
  buffer_load_dwordx4 a[92:95], v4, s[40:43], s78 offen sc1
  v_mfma_f32_16x16x32_bf16 v[32:35], v[172:175], a[48:51], v[32:35]
  v_mfma_f32_16x16x32_bf16 v[36:39], v[176:179], a[48:51], v[36:39]
  s_add_u32 s78, s78, 4096
  v_mfma_f32_16x16x32_bf16 v[40:43], v[180:183], a[48:51], v[40:43]
  buffer_load_dwordx4 a[96:99], v4, s[40:43], s78 offen sc1
  v_mfma_f32_16x16x32_bf16 v[44:47], v[184:187], a[48:51], v[44:47]
  s_waitcnt vmcnt(11)
  v_mfma_f32_16x16x32_bf16 v[28:31], v[188:191], a[52:55], v[28:31]
  s_add_u32 s78, s78, 4096
  v_mfma_f32_16x16x32_bf16 v[32:35], v[192:195], a[52:55], v[32:35]
  buffer_load_dwordx4 a[100:103], v4, s[40:43], s78 offen sc1
  v_mfma_f32_16x16x32_bf16 v[36:39], v[196:199], a[52:55], v[36:39]
  v_mfma_f32_16x16x32_bf16 v[40:43], v[200:203], a[52:55], v[40:43]
  s_add_u32 s78, s78, 4096
  v_mfma_f32_16x16x32_bf16 v[44:47], v[204:207], a[52:55], v[44:47]
  buffer_load_dwordx4 a[104:107], v4, s[40:43], s78 offen sc1
  s_waitcnt vmcnt(12)
  v_mfma_f32_16x16x32_bf16 v[8:11], a[160:163], a[56:59], 0
  v_mfma_f32_16x16x32_bf16 v[12:15], a[164:167], a[56:59], 0
  s_add_u32 s78, s78, 4096
  v_mfma_f32_16x16x32_bf16 v[16:19], a[168:171], a[56:59], 0
  ds_write_b128 v254, v[28:31] offset:0
  v_mfma_f32_16x16x32_bf16 v[20:23], a[172:175], a[56:59], 0
  buffer_load_dwordx4 a[108:111], v59, s[40:43], s78 offen sc1
  v_mfma_f32_16x16x32_bf16 v[24:27], a[176:179], a[56:59], 0
  s_waitcnt vmcnt(12)
  v_mfma_f32_16x16x32_bf16 v[8:11], a[180:183], a[60:63], v[8:11]
  ds_write_b128 v254, v[32:35] offset:1024
  v_mfma_f32_16x16x32_bf16 v[12:15], a[184:187], a[60:63], v[12:15]
  s_mul_i32 s78, s82, 55296
  v_mfma_f32_16x16x32_bf16 v[16:19], a[188:191], a[60:63], v[16:19]
  s_add_u32 s78, s78, s88
  v_mfma_f32_16x16x32_bf16 v[20:23], a[192:195], a[60:63], v[20:23]
  ds_write_b128 v254, v[36:39] offset:2048
  v_mfma_f32_16x16x32_bf16 v[24:27], a[196:199], a[60:63], v[24:27]
  s_waitcnt vmcnt(11)
  v_mfma_f32_16x16x32_bf16 v[8:11], a[200:203], a[64:67], v[8:11]
  buffer_load_dwordx4 a[112:115], v4, s[40:43], s78 offen sc1
  v_mfma_f32_16x16x32_bf16 v[12:15], a[204:207], a[64:67], v[12:15]
  ds_write_b128 v254, v[40:43] offset:3072
  v_mfma_f32_16x16x32_bf16 v[16:19], a[208:211], a[64:67], v[16:19]
  s_add_u32 s78, s78, 4096
  v_mfma_f32_16x16x32_bf16 v[20:23], a[212:215], a[64:67], v[20:23]
  v_mfma_f32_16x16x32_bf16 v[24:27], a[216:219], a[64:67], v[24:27]
  ds_write_b128 v254, v[44:47] offset:4096
  s_waitcnt vmcnt(11)
  v_mfma_f32_16x16x32_bf16 v[8:11], a[220:223], a[68:71], v[8:11]
  buffer_load_dwordx4 a[116:119], v4, s[40:43], s78 offen sc1
  v_mfma_f32_16x16x32_bf16 v[12:15], a[224:227], a[68:71], v[12:15]
  s_add_u32 s78, s78, 4096
  v_mfma_f32_16x16x32_bf16 v[16:19], a[228:231], a[68:71], v[16:19]
  v_mfma_f32_16x16x32_bf16 v[20:23], a[232:235], a[68:71], v[20:23]
  buffer_load_dwordx4 a[120:123], v4, s[40:43], s78 offen sc1
  v_mfma_f32_16x16x32_bf16 v[24:27], a[236:239], a[68:71], v[24:27]
  s_add_u32 s78, s78, 4096
  s_waitcnt vmcnt(12)
  v_mfma_f32_16x16x32_bf16 v[8:11], a[240:243], a[72:75], v[8:11]
  v_mfma_f32_16x16x32_bf16 v[12:15], a[244:247], a[72:75], v[12:15]
  buffer_load_dwordx4 a[124:127], v4, s[40:43], s78 offen sc1
  v_mfma_f32_16x16x32_bf16 v[16:19], a[248:251], a[72:75], v[16:19]
  s_add_u32 s78, s78, 4096
  v_mfma_f32_16x16x32_bf16 v[20:23], a[252:255], a[72:75], v[20:23]
  v_mfma_f32_16x16x32_bf16 v[24:27], v[164:167], a[72:75], v[24:27]
  buffer_load_dwordx4 a[128:131], v4, s[40:43], s78 offen sc1
  s_waitcnt vmcnt(13)
  v_mfma_f32_16x16x32_bf16 v[8:11], v[168:171], a[76:79], v[8:11]
  s_add_u32 s78, s78, 4096
  v_mfma_f32_16x16x32_bf16 v[12:15], v[172:175], a[76:79], v[12:15]
  v_mfma_f32_16x16x32_bf16 v[16:19], v[176:179], a[76:79], v[16:19]
  buffer_load_dwordx4 a[132:135], v4, s[40:43], s78 offen sc1
  v_mfma_f32_16x16x32_bf16 v[20:23], v[180:183], a[76:79], v[20:23]
  s_add_u32 s78, s78, 4096
  v_mfma_f32_16x16x32_bf16 v[24:27], v[184:187], a[76:79], v[24:27]
  s_waitcnt vmcnt(13)
  v_mfma_f32_16x16x32_bf16 v[8:11], v[188:191], a[80:83], v[8:11]
  buffer_load_dwordx4 a[136:139], v59, s[40:43], s78 offen sc1
  v_mfma_f32_16x16x32_bf16 v[12:15], v[192:195], a[80:83], v[12:15]
  v_mfma_f32_16x16x32_bf16 v[16:19], v[196:199], a[80:83], v[16:19]
  v_mfma_f32_16x16x32_bf16 v[20:23], v[200:203], a[80:83], v[20:23]
  v_mfma_f32_16x16x32_bf16 v[24:27], v[204:207], a[80:83], v[24:27]
  s_waitcnt vmcnt(13)
  v_mfma_f32_16x16x32_bf16 v[84:87], a[160:163], a[84:87], 0
  s_mul_i32 s78, s83, 55296
  v_mfma_f32_16x16x32_bf16 v[88:91], a[164:167], a[84:87], 0
  s_add_u32 s78, s78, s88
  v_mfma_f32_16x16x32_bf16 v[92:95], a[168:171], a[84:87], 0
  ds_write_b128 v255, v[8:11] offset:0
  v_mfma_f32_16x16x32_bf16 v[96:99], a[172:175], a[84:87], 0
  buffer_load_dwordx4 a[0:3], v4, s[40:43], s78 offen sc1
  v_mfma_f32_16x16x32_bf16 v[100:103], a[176:179], a[84:87], 0
  s_add_u32 s78, s78, 4096
  s_waitcnt vmcnt(13)
  v_mfma_f32_16x16x32_bf16 v[84:87], a[180:183], a[88:91], v[84:87]
  ds_write_b128 v255, v[12:15] offset:1024
  v_mfma_f32_16x16x32_bf16 v[88:91], a[184:187], a[88:91], v[88:91]
  buffer_load_dwordx4 a[4:7], v4, s[40:43], s78 offen sc1
  v_mfma_f32_16x16x32_bf16 v[92:95], a[188:191], a[88:91], v[92:95]
  s_add_u32 s78, s78, 4096
  v_mfma_f32_16x16x32_bf16 v[96:99], a[192:195], a[88:91], v[96:99]
  ds_write_b128 v255, v[16:19] offset:2048
  v_mfma_f32_16x16x32_bf16 v[100:103], a[196:199], a[88:91], v[100:103]
  buffer_load_dwordx4 a[8:11], v4, s[40:43], s78 offen sc1
  s_waitcnt vmcnt(14)
  v_mfma_f32_16x16x32_bf16 v[84:87], a[200:203], a[92:95], v[84:87]
  s_add_u32 s78, s78, 4096
  v_mfma_f32_16x16x32_bf16 v[88:91], a[204:207], a[92:95], v[88:91]
  ds_write_b128 v255, v[20:23] offset:3072
  v_mfma_f32_16x16x32_bf16 v[92:95], a[208:211], a[92:95], v[92:95]
  buffer_load_dwordx4 a[12:15], v4, s[40:43], s78 offen sc1
  v_mfma_f32_16x16x32_bf16 v[96:99], a[212:215], a[92:95], v[96:99]
  s_add_u32 s78, s78, 4096
  v_mfma_f32_16x16x32_bf16 v[100:103], a[216:219], a[92:95], v[100:103]
  ds_write_b128 v255, v[24:27] offset:4096
  s_waitcnt vmcnt(14)
  v_mfma_f32_16x16x32_bf16 v[84:87], a[220:223], a[96:99], v[84:87]
  buffer_load_dwordx4 a[16:19], v4, s[40:43], s78 offen sc1
  v_mfma_f32_16x16x32_bf16 v[88:91], a[224:227], a[96:99], v[88:91]
  s_add_u32 s78, s78, 4096
  v_mfma_f32_16x16x32_bf16 v[92:95], a[228:231], a[96:99], v[92:95]
  buffer_load_dwordx4 a[20:23], v4, s[40:43], s78 offen sc1
  v_mfma_f32_16x16x32_bf16 v[96:99], a[232:235], a[96:99], v[96:99]
  s_add_u32 s78, s78, 4096
  v_mfma_f32_16x16x32_bf16 v[100:103], a[236:239], a[96:99], v[100:103]
  buffer_load_dwordx4 a[24:27], v59, s[40:43], s78 offen sc1
  s_waitcnt vmcnt(16)
  v_mfma_f32_16x16x32_bf16 v[84:87], a[240:243], a[100:103], v[84:87]
  s_waitcnt lgkmcnt(0)
  s_barrier
  ds_read_b128 v[104:107], v219 offset:0
  v_mfma_f32_16x16x32_bf16 v[88:91], a[244:247], a[100:103], v[88:91]
  ds_read_b128 v[108:111], v219 offset:1024
  v_mfma_f32_16x16x32_bf16 v[92:95], a[248:251], a[100:103], v[92:95]
  ds_read_b128 v[112:115], v219 offset:2048
  v_mfma_f32_16x16x32_bf16 v[96:99], a[252:255], a[100:103], v[96:99]
  ds_read_b128 v[116:119], v219 offset:3072
  v_mfma_f32_16x16x32_bf16 v[100:103], v[164:167], a[100:103], v[100:103]
  ds_read_b128 v[120:123], v219 offset:4096
  s_waitcnt vmcnt(15)
  v_mfma_f32_16x16x32_bf16 v[84:87], v[168:171], a[104:107], v[84:87]
  ds_read_b128 v[124:127], v219 offset:5120
  v_mfma_f32_16x16x32_bf16 v[88:91], v[172:175], a[104:107], v[88:91]
  ds_read_b128 v[128:131], v219 offset:6144
  v_mfma_f32_16x16x32_bf16 v[92:95], v[176:179], a[104:107], v[92:95]
  ds_read_b128 v[132:135], v219 offset:7168
  v_mfma_f32_16x16x32_bf16 v[96:99], v[180:183], a[104:107], v[96:99]
  ds_read_b128 v[136:139], v219 offset:8192
  v_mfma_f32_16x16x32_bf16 v[100:103], v[184:187], a[104:107], v[100:103]
  ds_read_b128 v[140:143], v219 offset:9216
  s_waitcnt vmcnt(14)
  v_mfma_f32_16x16x32_bf16 v[84:87], v[188:191], a[108:111], v[84:87]
  ds_read_b128 v[144:147], v219 offset:10240
  v_mfma_f32_16x16x32_bf16 v[88:91], v[192:195], a[108:111], v[88:91]
  ds_read_b128 v[148:151], v219 offset:11264
  v_mfma_f32_16x16x32_bf16 v[92:95], v[196:199], a[108:111], v[92:95]
  ds_read_b128 v[152:155], v219 offset:12288
  v_mfma_f32_16x16x32_bf16 v[96:99], v[200:203], a[108:111], v[96:99]
  ds_read_b128 v[156:159], v219 offset:13312
  v_mfma_f32_16x16x32_bf16 v[100:103], v[204:207], a[108:111], v[100:103]
  ds_read_b128 v[160:163], v219 offset:14336
  s_waitcnt vmcnt(13)
  v_mfma_f32_16x16x32_bf16 v[8:11], a[160:163], a[112:115], 0
  v_add_u32 v253, 61440, v253
  v_add_u32 v254, 61440, v254
  v_mfma_f32_16x16x32_bf16 v[12:15], a[164:167], a[112:115], 0
  v_add_u32 v255, 61440, v255
  v_add_u32 v219, 61440, v219
  v_mfma_f32_16x16x32_bf16 v[16:19], a[168:171], a[112:115], 0
  v_mfma_f32_16x16x32_bf16 v[20:23], a[172:175], a[112:115], 0
  v_mfma_f32_16x16x32_bf16 v[24:27], a[176:179], a[112:115], 0
  s_waitcnt vmcnt(12)
  v_mfma_f32_16x16x32_bf16 v[8:11], a[180:183], a[116:119], v[8:11]
  s_waitcnt lgkmcnt(10)
  s_mul_i32 s78, s84, 55296
  v_mfma_f32_16x16x32_bf16 v[12:15], a[184:187], a[116:119], v[12:15]
  v_add_f32 v84, v84, v104
  s_add_u32 s78, s78, s88
  v_mfma_f32_16x16x32_bf16 v[16:19], a[188:191], a[116:119], v[16:19]
  v_add_f32 v85, v85, v105
  v_add_f32 v86, v86, v106
  v_mfma_f32_16x16x32_bf16 v[20:23], a[192:195], a[116:119], v[20:23]
  buffer_load_dwordx4 a[28:31], v4, s[40:43], s78 offen sc1
  v_add_f32 v87, v87, v107
  v_mfma_f32_16x16x32_bf16 v[24:27], a[196:199], a[116:119], v[24:27]
  v_add_f32 v88, v88, v108
  s_add_u32 s78, s78, 4096
  s_waitcnt vmcnt(12)
  v_mfma_f32_16x16x32_bf16 v[8:11], a[200:203], a[120:123], v[8:11]
  v_add_f32 v89, v89, v109
  v_add_f32 v90, v90, v110
  v_mfma_f32_16x16x32_bf16 v[12:15], a[204:207], a[120:123], v[12:15]
  buffer_load_dwordx4 a[32:35], v4, s[40:43], s78 offen sc1
  v_add_f32 v91, v91, v111
  v_mfma_f32_16x16x32_bf16 v[16:19], a[208:211], a[120:123], v[16:19]
  v_add_f32 v92, v92, v112
  s_add_u32 s78, s78, 4096
  v_mfma_f32_16x16x32_bf16 v[20:23], a[212:215], a[120:123], v[20:23]
  v_add_f32 v93, v93, v113
  buffer_load_dwordx4 a[36:39], v4, s[40:43], s78 offen sc1
  v_mfma_f32_16x16x32_bf16 v[24:27], a[216:219], a[120:123], v[24:27]
  v_add_f32 v94, v94, v114
  v_add_f32 v95, v95, v115
  s_waitcnt vmcnt(13)
  v_mfma_f32_16x16x32_bf16 v[8:11], a[220:223], a[124:127], v[8:11]
  s_add_u32 s78, s78, 4096
  v_add_f32 v96, v96, v116
  v_mfma_f32_16x16x32_bf16 v[12:15], a[224:227], a[124:127], v[12:15]
  v_add_f32 v97, v97, v117
  buffer_load_dwordx4 a[40:43], v4, s[40:43], s78 offen sc1
  v_mfma_f32_16x16x32_bf16 v[16:19], a[228:231], a[124:127], v[16:19]
  v_add_f32 v98, v98, v118
  v_add_f32 v99, v99, v119
  v_mfma_f32_16x16x32_bf16 v[20:23], a[232:235], a[124:127], v[20:23]
  s_add_u32 s78, s78, 4096
  v_add_f32 v100, v100, v120
  v_mfma_f32_16x16x32_bf16 v[24:27], a[236:239], a[124:127], v[24:27]
  v_add_f32 v101, v101, v121
  buffer_load_dwordx4 a[44:47], v4, s[40:43], s78 offen sc1
  s_waitcnt vmcnt(14)
  v_mfma_f32_16x16x32_bf16 v[8:11], a[240:243], a[128:131], v[8:11]
  v_add_f32 v102, v102, v122
  v_add_f32 v103, v103, v123
  v_mfma_f32_16x16x32_bf16 v[12:15], a[244:247], a[128:131], v[12:15]
  s_add_u32 s78, s78, 4096
  s_waitcnt lgkmcnt(5)
  v_mfma_f32_16x16x32_bf16 v[16:19], a[248:251], a[128:131], v[16:19]
  buffer_load_dwordx4 a[48:51], v4, s[40:43], s78 offen sc1
  v_add_f32 v84, v84, v124
  v_mfma_f32_16x16x32_bf16 v[20:23], a[252:255], a[128:131], v[20:23]
  v_add_f32 v85, v85, v125
  s_add_u32 s78, s78, 4096
  v_mfma_f32_16x16x32_bf16 v[24:27], v[164:167], a[128:131], v[24:27]
  v_add_f32 v86, v86, v126
  v_add_f32 v87, v87, v127
  s_waitcnt vmcnt(14)
  v_mfma_f32_16x16x32_bf16 v[8:11], v[168:171], a[132:135], v[8:11]
  buffer_load_dwordx4 a[52:55], v59, s[40:43], s78 offen sc1
  v_add_f32 v88, v88, v128
  v_mfma_f32_16x16x32_bf16 v[12:15], v[172:175], a[132:135], v[12:15]
  v_add_f32 v89, v89, v129
  s_mul_i32 s78, s85, 55296
  v_mfma_f32_16x16x32_bf16 v[16:19], v[176:179], a[132:135], v[16:19]
  v_add_f32 v90, v90, v130
  v_add_f32 v91, v91, v131
  v_mfma_f32_16x16x32_bf16 v[20:23], v[180:183], a[132:135], v[20:23]
  s_add_u32 s78, s78, s88
  v_add_f32 v92, v92, v132
  v_mfma_f32_16x16x32_bf16 v[24:27], v[184:187], a[132:135], v[24:27]
  v_add_f32 v93, v93, v133
  buffer_load_dwordx4 a[56:59], v4, s[40:43], s78 offen sc1
  s_waitcnt vmcnt(15)
  v_mfma_f32_16x16x32_bf16 v[8:11], v[188:191], a[136:139], v[8:11]
  v_add_f32 v94, v94, v134
  s_add_u32 s78, s78, 4096
  v_mfma_f32_16x16x32_bf16 v[12:15], v[192:195], a[136:139], v[12:15]
  v_add_f32 v95, v95, v135
  v_add_f32 v96, v96, v136
  v_mfma_f32_16x16x32_bf16 v[16:19], v[196:199], a[136:139], v[16:19]
  buffer_load_dwordx4 a[60:63], v4, s[40:43], s78 offen sc1
  v_add_f32 v97, v97, v137
  v_mfma_f32_16x16x32_bf16 v[20:23], v[200:203], a[136:139], v[20:23]
  v_add_f32 v98, v98, v138
  s_add_u32 s78, s78, 4096
  v_mfma_f32_16x16x32_bf16 v[24:27], v[204:207], a[136:139], v[24:27]
  v_add_f32 v99, v99, v139
  v_add_f32 v100, v100, v140
  s_waitcnt vmcnt(15)
  v_mfma_f32_16x16x32_bf16 v[28:31], a[160:163], a[0:3], 0
  buffer_load_dwordx4 a[64:67], v4, s[40:43], s78 offen sc1
  v_add_f32 v101, v101, v141
  v_mfma_f32_16x16x32_bf16 v[32:35], a[164:167], a[0:3], 0
  v_add_f32 v102, v102, v142
  s_add_u32 s78, s78, 4096
  v_mfma_f32_16x16x32_bf16 v[36:39], a[168:171], a[0:3], 0
  ds_write_b128 v253, v[8:11] offset:0
  v_mfma_f32_16x16x32_bf16 v[40:43], a[172:175], a[0:3], 0
  v_add_f32 v103, v103, v143
  buffer_load_dwordx4 a[68:71], v4, s[40:43], s78 offen sc1
  v_mfma_f32_16x16x32_bf16 v[44:47], a[176:179], a[0:3], 0
  s_waitcnt lgkmcnt(1)
  v_add_f32 v84, v84, v144
  s_waitcnt vmcnt(16)
  v_mfma_f32_16x16x32_bf16 v[28:31], a[180:183], a[4:7], v[28:31]
  ds_write_b128 v253, v[12:15] offset:1024
  v_mfma_f32_16x16x32_bf16 v[32:35], a[184:187], a[4:7], v[32:35]
  s_add_u32 s78, s78, 4096
  v_add_f32 v85, v85, v145
  v_mfma_f32_16x16x32_bf16 v[36:39], a[188:191], a[4:7], v[36:39]
  v_add_f32 v86, v86, v146
  buffer_load_dwordx4 a[72:75], v4, s[40:43], s78 offen sc1
  v_mfma_f32_16x16x32_bf16 v[40:43], a[192:195], a[4:7], v[40:43]
  ds_write_b128 v253, v[16:19] offset:2048
  v_mfma_f32_16x16x32_bf16 v[44:47], a[196:199], a[4:7], v[44:47]
  v_add_f32 v87, v87, v147
  v_add_f32 v88, v88, v148
  s_waitcnt vmcnt(16)
  v_mfma_f32_16x16x32_bf16 v[28:31], a[200:203], a[8:11], v[28:31]
  s_add_u32 s78, s78, 4096
  v_add_f32 v89, v89, v149
  v_mfma_f32_16x16x32_bf16 v[32:35], a[204:207], a[8:11], v[32:35]
  ds_write_b128 v253, v[20:23] offset:3072
  v_mfma_f32_16x16x32_bf16 v[36:39], a[208:211], a[8:11], v[36:39]
  v_add_f32 v90, v90, v150
  buffer_load_dwordx4 a[76:79], v4, s[40:43], s78 offen sc1
  v_mfma_f32_16x16x32_bf16 v[40:43], a[212:215], a[8:11], v[40:43]
  v_add_f32 v91, v91, v151
  v_add_f32 v92, v92, v152
  v_mfma_f32_16x16x32_bf16 v[44:47], a[216:219], a[8:11], v[44:47]
  ds_write_b128 v253, v[24:27] offset:4096
  s_waitcnt vmcnt(16)
  v_mfma_f32_16x16x32_bf16 v[28:31], a[220:223], a[12:15], v[28:31]
  s_add_u32 s78, s78, 4096
  v_add_f32 v93, v93, v153
  v_mfma_f32_16x16x32_bf16 v[32:35], a[224:227], a[12:15], v[32:35]
  buffer_load_dwordx4 a[80:83], v59, s[40:43], s78 offen sc1
  v_add_f32 v94, v94, v154
  v_mfma_f32_16x16x32_bf16 v[36:39], a[228:231], a[12:15], v[36:39]
  v_add_f32 v95, v95, v155
  v_mfma_f32_16x16x32_bf16 v[40:43], a[232:235], a[12:15], v[40:43]
  v_add_f32 v96, v96, v156
  v_add_f32 v97, v97, v157
  v_mfma_f32_16x16x32_bf16 v[44:47], a[236:239], a[12:15], v[44:47]
  v_add_f32 v98, v98, v158
  s_waitcnt vmcnt(16)
  v_mfma_f32_16x16x32_bf16 v[28:31], a[240:243], a[16:19], v[28:31]
  v_add_f32 v99, v99, v159
  v_mfma_f32_16x16x32_bf16 v[32:35], a[244:247], a[16:19], v[32:35]
  v_add_f32 v100, v100, v160
  v_add_f32 v101, v101, v161
  v_mfma_f32_16x16x32_bf16 v[36:39], a[248:251], a[16:19], v[36:39]
  v_add_f32 v102, v102, v162
  v_mfma_f32_16x16x32_bf16 v[40:43], a[252:255], a[16:19], v[40:43]
  v_add_f32 v103, v103, v163
  v_mfma_f32_16x16x32_bf16 v[44:47], v[164:167], a[16:19], v[44:47]
  v_cvt_pk_bf16_f32 v48, v84, v85
  s_waitcnt vmcnt(15)
  v_mfma_f32_16x16x32_bf16 v[28:31], v[168:171], a[20:23], v[28:31]
  v_cvt_pk_bf16_f32 v49, v86, v87
  v_cvt_pk_bf16_f32 v50, v88, v89
  v_mfma_f32_16x16x32_bf16 v[32:35], v[172:175], a[20:23], v[32:35]
  v_cvt_pk_bf16_f32 v51, v90, v91
  v_mfma_f32_16x16x32_bf16 v[36:39], v[176:179], a[20:23], v[36:39]
  v_cvt_pk_bf16_f32 v52, v92, v93
  v_mfma_f32_16x16x32_bf16 v[40:43], v[180:183], a[20:23], v[40:43]
  v_cvt_pk_bf16_f32 v53, v94, v95
  v_cvt_pk_bf16_f32 v54, v96, v97
  v_mfma_f32_16x16x32_bf16 v[44:47], v[184:187], a[20:23], v[44:47]
  v_cvt_pk_bf16_f32 v55, v98, v99
  s_waitcnt vmcnt(14)
  v_mfma_f32_16x16x32_bf16 v[28:31], v[188:191], a[24:27], v[28:31]
  v_cvt_pk_bf16_f32 v56, v100, v101
  v_mfma_f32_16x16x32_bf16 v[32:35], v[192:195], a[24:27], v[32:35]
  v_cvt_pk_bf16_f32 v57, v102, v103
  s_add_u32 s63, s90, 0
  s_add_u32 s62, s63, s64
  s_add_u32 s63, s63, s65
  s_add_u32 s61, s62, 16384
  s_cmp_eq_u32 s55, 0
  s_cbranch_scc1 Lsafe_61
  buffer_store_dwordx4 v[48:51], v248, s[40:43], s62 offen
  buffer_store_dwordx4 v[52:55], v248, s[40:43], s61 offen
  buffer_store_dwordx2 v[56:57], v248, s[40:43], s63 offen
  s_branch Ljoin_62
Lsafe_61:
  buffer_store_dwordx4 v[48:51], v248, s[40:43], s62 offen sc1
  buffer_store_dwordx4 v[52:55], v248, s[40:43], s61 offen sc1
  buffer_store_dwordx2 v[56:57], v248, s[40:43], s63 offen sc1
Ljoin_62:
  v_mfma_f32_16x16x32_bf16 v[36:39], v[196:199], a[24:27], v[36:39]
  v_mul_u32_u24 v60, 1280, v2
  v_mfma_f32_16x16x32_bf16 v[40:43], v[200:203], a[24:27], v[40:43]
  v_lshl_add_u32 v61, v3, 3, v60
  v_mfma_f32_16x16x32_bf16 v[44:47], v[204:207], a[24:27], v[44:47]
  v_and_b32 v5, 1, v3
  s_waitcnt vmcnt(16)
  v_mfma_f32_16x16x32_bf16 v[8:11], a[160:163], a[28:31], 0
  v_lshl_add_u32 v60, v5, 5, v60
  v_mfma_f32_16x16x32_bf16 v[12:15], a[164:167], a[28:31], 0
  v_lshrrev_b32 v5, 1, v3
  v_mfma_f32_16x16x32_bf16 v[16:19], a[168:171], a[28:31], 0
  ds_write_b128 v254, v[28:31] offset:0
  v_mfma_f32_16x16x32_bf16 v[20:23], a[172:175], a[28:31], 0
  v_lshl_add_u32 v60, v5, 4, v60
  v_mfma_f32_16x16x32_bf16 v[24:27], a[176:179], a[28:31], 0
  s_mul_i32 s86, s56, 20480
  s_waitcnt vmcnt(15)
  v_mfma_f32_16x16x32_bf16 v[8:11], a[180:183], a[32:35], v[8:11]
  ds_write_b128 v254, v[32:35] offset:1024
  v_mfma_f32_16x16x32_bf16 v[12:15], a[184:187], a[32:35], v[12:15]
  s_mul_i32 s87, s57, 160
  v_mfma_f32_16x16x32_bf16 v[16:19], a[188:191], a[32:35], v[16:19]
  s_add_u32 s86, s86, s87
  v_mfma_f32_16x16x32_bf16 v[20:23], a[192:195], a[32:35], v[20:23]
  ds_write_b128 v254, v[36:39] offset:2048
  v_mfma_f32_16x16x32_bf16 v[24:27], a[196:199], a[32:35], v[24:27]
  s_waitcnt vmcnt(14)
  v_mfma_f32_16x16x32_bf16 v[8:11], a[200:203], a[36:39], v[8:11]
  v_mfma_f32_16x16x32_bf16 v[12:15], a[204:207], a[36:39], v[12:15]
  ds_write_b128 v254, v[40:43] offset:3072
  v_mfma_f32_16x16x32_bf16 v[16:19], a[208:211], a[36:39], v[16:19]
  v_mfma_f32_16x16x32_bf16 v[20:23], a[212:215], a[36:39], v[20:23]
  v_mfma_f32_16x16x32_bf16 v[24:27], a[216:219], a[36:39], v[24:27]
  ds_write_b128 v254, v[44:47] offset:4096
  s_waitcnt vmcnt(13)
  v_mfma_f32_16x16x32_bf16 v[8:11], a[220:223], a[40:43], v[8:11]
  v_mfma_f32_16x16x32_bf16 v[12:15], a[224:227], a[40:43], v[12:15]
  v_mfma_f32_16x16x32_bf16 v[16:19], a[228:231], a[40:43], v[16:19]
  v_mfma_f32_16x16x32_bf16 v[20:23], a[232:235], a[40:43], v[20:23]
  v_mfma_f32_16x16x32_bf16 v[24:27], a[236:239], a[40:43], v[24:27]
  s_waitcnt vmcnt(12)
  v_mfma_f32_16x16x32_bf16 v[8:11], a[240:243], a[44:47], v[8:11]
  v_mfma_f32_16x16x32_bf16 v[12:15], a[244:247], a[44:47], v[12:15]
  v_mfma_f32_16x16x32_bf16 v[16:19], a[248:251], a[44:47], v[16:19]
  v_mfma_f32_16x16x32_bf16 v[20:23], a[252:255], a[44:47], v[20:23]
  s_waitcnt vmcnt(0)
  s_xor_b32 s58, s67, 128
  s_add_u32 s58, s58, 28368896
  v_mov_b32 v6, s3
  s_mov_b64 exec, 1
  s_cmp_eq_u32 s55, 0
  s_cbranch_scc1 Lsafe_63
  buffer_store_dword v6, v251, s[40:43], s58 offen
  s_branch Ljoin_64
Lsafe_63:
  buffer_store_dword v6, v251, s[40:43], s58 offen sc1
Ljoin_64:
  s_mov_b64 exec, -1
  v_mfma_f32_16x16x32_bf16 v[24:27], v[164:167], a[44:47], v[24:27]
  v_mfma_f32_16x16x32_bf16 v[8:11], v[168:171], a[48:51], v[8:11]
  v_mfma_f32_16x16x32_bf16 v[12:15], v[172:175], a[48:51], v[12:15]
  v_mfma_f32_16x16x32_bf16 v[16:19], v[176:179], a[48:51], v[16:19]
  v_mfma_f32_16x16x32_bf16 v[20:23], v[180:183], a[48:51], v[20:23]
  v_mfma_f32_16x16x32_bf16 v[24:27], v[184:187], a[48:51], v[24:27]
  v_mfma_f32_16x16x32_bf16 v[8:11], v[188:191], a[52:55], v[8:11]
  v_mfma_f32_16x16x32_bf16 v[12:15], v[192:195], a[52:55], v[12:15]
  v_mfma_f32_16x16x32_bf16 v[16:19], v[196:199], a[52:55], v[16:19]
  v_mfma_f32_16x16x32_bf16 v[20:23], v[200:203], a[52:55], v[20:23]
  v_mfma_f32_16x16x32_bf16 v[24:27], v[204:207], a[52:55], v[24:27]
  v_mfma_f32_16x16x32_bf16 v[64:67], a[160:163], a[56:59], v[220:223]
  s_add_u32 s60, s67, 28368896
  v_mfma_f32_16x16x32_bf16 v[68:71], a[164:167], a[56:59], v[224:227]
  s_add_u32 s63, s44, 0
  s_add_u32 s62, s63, s64
  v_mfma_f32_16x16x32_bf16 v[72:75], a[168:171], a[56:59], v[228:231]
  ds_write_b128 v255, v[8:11] offset:0
  v_mfma_f32_16x16x32_bf16 v[76:79], a[172:175], a[56:59], v[232:235]
  s_add_u32 s63, s63, s65
  s_add_u32 s61, s62, 16384
  v_mfma_f32_16x16x32_bf16 v[80:83], a[176:179], a[56:59], v[236:239]
  buffer_load_dword v240, v251, s[40:43], s60 offen sc1
  v_mfma_f32_16x16x32_bf16 v[64:67], a[180:183], a[60:63], v[64:67]
  ds_write_b128 v255, v[12:15] offset:1024
  v_mfma_f32_16x16x32_bf16 v[68:71], a[184:187], a[60:63], v[68:71]
  v_mfma_f32_16x16x32_bf16 v[72:75], a[188:191], a[60:63], v[72:75]
  v_mfma_f32_16x16x32_bf16 v[76:79], a[192:195], a[60:63], v[76:79]
  ds_write_b128 v255, v[16:19] offset:2048
  v_mfma_f32_16x16x32_bf16 v[80:83], a[196:199], a[60:63], v[80:83]
  v_mfma_f32_16x16x32_bf16 v[64:67], a[200:203], a[64:67], v[64:67]
  v_mfma_f32_16x16x32_bf16 v[68:71], a[204:207], a[64:67], v[68:71]
  ds_write_b128 v255, v[20:23] offset:3072
  v_mfma_f32_16x16x32_bf16 v[72:75], a[208:211], a[64:67], v[72:75]
  v_mfma_f32_16x16x32_bf16 v[76:79], a[212:215], a[64:67], v[76:79]
  v_mfma_f32_16x16x32_bf16 v[80:83], a[216:219], a[64:67], v[80:83]
  ds_write_b128 v255, v[24:27] offset:4096
  v_mfma_f32_16x16x32_bf16 v[64:67], a[220:223], a[68:71], v[64:67]
  v_mfma_f32_16x16x32_bf16 v[68:71], a[224:227], a[68:71], v[68:71]
  v_mfma_f32_16x16x32_bf16 v[72:75], a[228:231], a[68:71], v[72:75]
  v_mfma_f32_16x16x32_bf16 v[76:79], a[232:235], a[68:71], v[76:79]
  v_mfma_f32_16x16x32_bf16 v[80:83], a[236:239], a[68:71], v[80:83]
  s_waitcnt vmcnt(0)
  v_mfma_f32_16x16x32_bf16 v[64:67], a[240:243], a[72:75], v[64:67]
  s_waitcnt lgkmcnt(0)
  s_barrier
  ds_read_b128 v[104:107], v219 offset:0
  v_mfma_f32_16x16x32_bf16 v[68:71], a[244:247], a[72:75], v[68:71]
  ds_read_b128 v[108:111], v219 offset:1024
  v_mfma_f32_16x16x32_bf16 v[72:75], a[248:251], a[72:75], v[72:75]
  ds_read_b128 v[112:115], v219 offset:2048
  v_mfma_f32_16x16x32_bf16 v[76:79], a[252:255], a[72:75], v[76:79]
  ds_read_b128 v[116:119], v219 offset:3072
  v_mfma_f32_16x16x32_bf16 v[80:83], v[164:167], a[72:75], v[80:83]
  ds_read_b128 v[120:123], v219 offset:4096
  v_mfma_f32_16x16x32_bf16 v[64:67], v[168:171], a[76:79], v[64:67]
  ds_read_b128 v[124:127], v219 offset:5120
  v_mfma_f32_16x16x32_bf16 v[68:71], v[172:175], a[76:79], v[68:71]
  ds_read_b128 v[128:131], v219 offset:6144
  v_mfma_f32_16x16x32_bf16 v[72:75], v[176:179], a[76:79], v[72:75]
  ds_read_b128 v[132:135], v219 offset:7168
  v_mfma_f32_16x16x32_bf16 v[76:79], v[180:183], a[76:79], v[76:79]
  ds_read_b128 v[136:139], v219 offset:8192
  v_mfma_f32_16x16x32_bf16 v[80:83], v[184:187], a[76:79], v[80:83]
  ds_read_b128 v[140:143], v219 offset:9216
  v_mfma_f32_16x16x32_bf16 v[64:67], v[188:191], a[80:83], v[64:67]
  ds_read_b128 v[144:147], v219 offset:10240
  v_mfma_f32_16x16x32_bf16 v[68:71], v[192:195], a[80:83], v[68:71]
  ds_read_b128 v[148:151], v219 offset:11264
  v_mfma_f32_16x16x32_bf16 v[72:75], v[196:199], a[80:83], v[72:75]
  ds_read_b128 v[152:155], v219 offset:12288
  v_mfma_f32_16x16x32_bf16 v[76:79], v[200:203], a[80:83], v[76:79]
  ds_read_b128 v[156:159], v219 offset:13312
  v_mfma_f32_16x16x32_bf16 v[80:83], v[204:207], a[80:83], v[80:83]
  ds_read_b128 v[160:163], v219 offset:14336
  buffer_load_dwordx4 v[208:211], v248, s[40:43], s62 offen sc1
  buffer_load_dwordx4 v[212:215], v248, s[40:43], s61 offen sc1
  buffer_load_dwordx2 v[216:217], v248, s[40:43], s63 offen sc1
  s_waitcnt lgkmcnt(10)
  v_pk_add_f32 v[64:65], v[64:65], v[104:105]
  v_pk_add_f32 v[66:67], v[66:67], v[106:107]
  v_pk_add_f32 v[68:69], v[68:69], v[108:109]
  v_pk_add_f32 v[70:71], v[70:71], v[110:111]
  v_pk_add_f32 v[72:73], v[72:73], v[112:113]
  v_pk_add_f32 v[74:75], v[74:75], v[114:115]
  v_pk_add_f32 v[76:77], v[76:77], v[116:117]
  v_pk_add_f32 v[78:79], v[78:79], v[118:119]
  v_pk_add_f32 v[80:81], v[80:81], v[120:121]
  v_pk_add_f32 v[82:83], v[82:83], v[122:123]
  s_waitcnt lgkmcnt(5)
  v_pk_add_f32 v[64:65], v[64:65], v[124:125]
  v_pk_add_f32 v[66:67], v[66:67], v[126:127]
  v_pk_add_f32 v[68:69], v[68:69], v[128:129]
  v_pk_add_f32 v[70:71], v[70:71], v[130:131]
  v_pk_add_f32 v[72:73], v[72:73], v[132:133]
  v_pk_add_f32 v[74:75], v[74:75], v[134:135]
  v_pk_add_f32 v[76:77], v[76:77], v[136:137]
  v_pk_add_f32 v[78:79], v[78:79], v[138:139]
  v_pk_add_f32 v[80:81], v[80:81], v[140:141]
  v_pk_add_f32 v[82:83], v[82:83], v[142:143]
  s_waitcnt lgkmcnt(0)
  v_pk_add_f32 v[64:65], v[64:65], v[144:145]
  v_pk_add_f32 v[66:67], v[66:67], v[146:147]
  v_pk_add_f32 v[68:69], v[68:69], v[148:149]
  v_pk_add_f32 v[70:71], v[70:71], v[150:151]
  v_pk_add_f32 v[72:73], v[72:73], v[152:153]
  v_pk_add_f32 v[74:75], v[74:75], v[154:155]
  v_pk_add_f32 v[76:77], v[76:77], v[156:157]
  v_pk_add_f32 v[78:79], v[78:79], v[158:159]
  v_pk_add_f32 v[80:81], v[80:81], v[160:161]
  v_pk_add_f32 v[82:83], v[82:83], v[162:163]
  s_waitcnt vmcnt(0)
  v_cmp_ne_u32 vcc, s3, v240
  s_nop 4
  s_cbranch_vccz Lg6_ok
  s_mov_b32 s48, 0
Lpoll_65:
  buffer_load_dword v240, v251, s[40:43], s60 offen sc1
  s_add_u32 s48, s48, 1
  s_cmp_gt_u32 s48, 0x40000
  s_cbranch_scc1 Lend
  s_waitcnt vmcnt(0)
  v_cmp_ne_u32 vcc, s3, v240
  s_nop 4
  s_cbranch_vccnz Lpoll_65
  buffer_load_dwordx4 v[208:211], v248, s[40:43], s62 offen sc1
  buffer_load_dwordx4 v[212:215], v248, s[40:43], s61 offen sc1
  buffer_load_dwordx2 v[216:217], v248, s[40:43], s63 offen sc1
  s_waitcnt vmcnt(0)
Lg6_ok:
  v_lshlrev_b32 v84, 16, v208
  v_and_b32 v85, 0xffff0000, v208
  v_lshlrev_b32 v86, 16, v209
  v_and_b32 v87, 0xffff0000, v209
  v_lshlrev_b32 v88, 16, v210
  v_and_b32 v89, 0xffff0000, v210
  v_lshlrev_b32 v90, 16, v211
  v_and_b32 v91, 0xffff0000, v211
  v_lshlrev_b32 v92, 16, v212
  v_and_b32 v93, 0xffff0000, v212
  v_lshlrev_b32 v94, 16, v213
  v_and_b32 v95, 0xffff0000, v213
  v_lshlrev_b32 v96, 16, v214
  v_and_b32 v97, 0xffff0000, v214
  v_lshlrev_b32 v98, 16, v215
  v_and_b32 v99, 0xffff0000, v215
  v_lshlrev_b32 v100, 16, v216
  v_and_b32 v101, 0xffff0000, v216
  v_lshlrev_b32 v102, 16, v217
  v_and_b32 v103, 0xffff0000, v217
  v_pk_add_f32 v[64:65], v[64:65], v[84:85]
  v_pk_add_f32 v[66:67], v[66:67], v[86:87]
  v_pk_add_f32 v[68:69], v[68:69], v[88:89]
  v_pk_add_f32 v[70:71], v[70:71], v[90:91]
  v_pk_add_f32 v[72:73], v[72:73], v[92:93]
  v_pk_add_f32 v[74:75], v[74:75], v[94:95]
  v_pk_add_f32 v[76:77], v[76:77], v[96:97]
  v_pk_add_f32 v[78:79], v[78:79], v[98:99]
  v_pk_add_f32 v[80:81], v[80:81], v[100:101]
  v_pk_add_f32 v[82:83], v[82:83], v[102:103]
  v_cvt_pk_bf16_f32 v48, v64, v65
  v_cvt_pk_bf16_f32 v49, v66, v67
  v_cvt_pk_bf16_f32 v50, v68, v69
  v_cvt_pk_bf16_f32 v51, v70, v71
  v_cvt_pk_bf16_f32 v52, v72, v73
  v_cvt_pk_bf16_f32 v53, v74, v75
  v_cvt_pk_bf16_f32 v54, v76, v77
  v_cvt_pk_bf16_f32 v55, v78, v79
  v_cvt_pk_bf16_f32 v56, v80, v81
  v_cvt_pk_bf16_f32 v57, v82, v83
  buffer_store_dwordx2 v[56:57], v61, s[36:39], s86 offen offset:128
  v_permlane16_swap_b32 v48, v50
  v_permlane16_swap_b32 v49, v51
  buffer_store_dwordx4 v[48:51], v60, s[36:39], s86 offen offset:0
  v_permlane16_swap_b32 v52, v54
  v_permlane16_swap_b32 v53, v55
  buffer_store_dwordx4 v[52:55], v60, s[36:39], s86 offen offset:64
  s_nop 1
Lend:
  s_endpgm
Latt_fb:
  ds_read_b128 a[0:3], v252 offset:0
  ds_read_b128 a[4:7], v246 offset:0
  s_waitcnt lgkmcnt(0)
  v_mfma_f32_32x32x16_bf16 v[64:79], a[0:3], v[224:227], 0
  v_mfma_f32_32x32x16_bf16 v[64:79], a[4:7], v[228:231], v[64:79]
  s_nop 7
  ds_read_b128 a[0:3], v252 offset:512
  ds_read_b128 a[4:7], v246 offset:512
  s_waitcnt lgkmcnt(0)
  v_mfma_f32_32x32x16_bf16 v[80:95], a[0:3], v[224:227], 0
  v_mfma_f32_32x32x16_bf16 v[80:95], a[4:7], v[228:231], v[80:95]
  s_nop 7
  ds_read_b128 a[0:3], v252 offset:1024
  ds_read_b128 a[4:7], v246 offset:1024
  s_waitcnt lgkmcnt(0)
  v_mfma_f32_32x32x16_bf16 v[96:111], a[0:3], v[224:227], 0
  v_mfma_f32_32x32x16_bf16 v[96:111], a[4:7], v[228:231], v[96:111]
  s_nop 7
  ds_read_b128 a[0:3], v252 offset:1536
  ds_read_b128 a[4:7], v246 offset:1536
  s_waitcnt lgkmcnt(0)
  v_mfma_f32_32x32x16_bf16 v[112:127], a[0:3], v[224:227], 0
  v_mfma_f32_32x32x16_bf16 v[112:127], a[4:7], v[228:231], v[112:127]
  s_nop 7
  ds_read_b128 a[0:3], v252 offset:2048
  ds_read_b128 a[4:7], v246 offset:2048
  s_waitcnt lgkmcnt(0)
  v_mfma_f32_32x32x16_bf16 v[128:143], a[0:3], v[224:227], 0
  v_mfma_f32_32x32x16_bf16 v[128:143], a[4:7], v[228:231], v[128:143]
  s_nop 7
  ds_read_b128 a[0:3], v252 offset:2560
  ds_read_b128 a[4:7], v246 offset:2560
  s_waitcnt lgkmcnt(0)
  v_mfma_f32_32x32x16_bf16 v[144:159], a[0:3], v[224:227], 0
  v_mfma_f32_32x32x16_bf16 v[144:159], a[4:7], v[228:231], v[144:159]
  s_nop 7
  ds_read_b128 a[0:3], v252 offset:3072
  ds_read_b128 a[4:7], v246 offset:3072
  s_waitcnt lgkmcnt(0)
  v_mfma_f32_32x32x16_bf16 v[160:175], a[0:3], v[224:227], 0
  v_mfma_f32_32x32x16_bf16 v[160:175], a[4:7], v[228:231], v[160:175]
  s_nop 7
  ds_read_b128 a[0:3], v252 offset:3584
  ds_read_b128 a[4:7], v246 offset:3584
  s_waitcnt lgkmcnt(0)
  v_mfma_f32_32x32x16_bf16 v[176:191], a[0:3], v[224:227], 0
  v_mfma_f32_32x32x16_bf16 v[176:191], a[4:7], v[228:231], v[176:191]
  s_nop 7
  ds_read_b128 a[0:3], v252 offset:4096
  ds_read_b128 a[4:7], v246 offset:4096
  s_waitcnt lgkmcnt(0)
  v_mfma_f32_32x32x16_bf16 v[192:207], a[0:3], v[224:227], 0
  v_mfma_f32_32x32x16_bf16 v[192:207], a[4:7], v[228:231], v[192:207]
  s_nop 7
  s_nop 3
  v_cndmask_b32 v192, v64, v192, s[64:65]
  v_cndmask_b32 v193, v65, v193, s[66:67]
  v_cndmask_b32 v194, v66, v194, s[68:69]
  v_cndmask_b32 v195, v67, v195, s[70:71]
  v_cndmask_b32 v196, v68, v196, s[72:73]
  v_cndmask_b32 v197, v69, v197, s[74:75]
  v_cndmask_b32 v198, v70, v198, s[76:77]
  v_cndmask_b32 v199, v71, v199, s[78:79]
  v_cndmask_b32 v200, v72, v200, s[80:81]
  v_cndmask_b32 v201, v73, v201, s[82:83]
  v_cndmask_b32 v202, v74, v202, s[84:85]
  v_cndmask_b32 v203, v75, v203, s[86:87]
  v_cndmask_b32 v204, v76, v204, s[88:89]
  v_cndmask_b32 v205, v77, v205, s[90:91]
  v_cndmask_b32 v206, v78, v206, s[98:99]
  v_cndmask_b32 v207, v79, v207, s[100:101]
  v_mov_b32 v18, v80
  v_max3_f32 v18, v18, v80, v81
  v_max3_f32 v18, v18, v82, v83
  v_max3_f32 v18, v18, v84, v85
  v_max3_f32 v18, v18, v86, v87
  v_max3_f32 v18, v18, v88, v89
  v_max3_f32 v18, v18, v90, v91
  v_max3_f32 v18, v18, v92, v93
  v_max3_f32 v18, v18, v94, v95
  v_max3_f32 v18, v18, v96, v97
  v_max3_f32 v18, v18, v98, v99
  v_max3_f32 v18, v18, v100, v101
  v_max3_f32 v18, v18, v102, v103
  v_max3_f32 v18, v18, v104, v105
  v_max3_f32 v18, v18, v106, v107
  v_max3_f32 v18, v18, v108, v109
  v_max3_f32 v18, v18, v110, v111
  v_max3_f32 v18, v18, v112, v113
  v_max3_f32 v18, v18, v114, v115
  v_max3_f32 v18, v18, v116, v117
  v_max3_f32 v18, v18, v118, v119
  v_max3_f32 v18, v18, v120, v121
  v_max3_f32 v18, v18, v122, v123
  v_max3_f32 v18, v18, v124, v125
  v_max3_f32 v18, v18, v126, v127
  v_max3_f32 v18, v18, v128, v129
  v_max3_f32 v18, v18, v130, v131
  v_max3_f32 v18, v18, v132, v133
  v_max3_f32 v18, v18, v134, v135
  v_max3_f32 v18, v18, v136, v137
  v_max3_f32 v18, v18, v138, v139
  v_max3_f32 v18, v18, v140, v141
  v_max3_f32 v18, v18, v142, v143
  v_max3_f32 v18, v18, v144, v145
  v_max3_f32 v18, v18, v146, v147
  v_max3_f32 v18, v18, v148, v149
  v_max3_f32 v18, v18, v150, v151
  v_max3_f32 v18, v18, v152, v153
  v_max3_f32 v18, v18, v154, v155
  v_max3_f32 v18, v18, v156, v157
  v_max3_f32 v18, v18, v158, v159
  v_max3_f32 v18, v18, v160, v161
  v_max3_f32 v18, v18, v162, v163
  v_max3_f32 v18, v18, v164, v165
  v_max3_f32 v18, v18, v166, v167
  v_max3_f32 v18, v18, v168, v169
  v_max3_f32 v18, v18, v170, v171
  v_max3_f32 v18, v18, v172, v173
  v_max3_f32 v18, v18, v174, v175
  v_max3_f32 v18, v18, v176, v177
  v_max3_f32 v18, v18, v178, v179
  v_max3_f32 v18, v18, v180, v181
  v_max3_f32 v18, v18, v182, v183
  v_max3_f32 v18, v18, v184, v185
  v_max3_f32 v18, v18, v186, v187
  v_max3_f32 v18, v18, v188, v189
  v_max3_f32 v18, v18, v190, v191
  v_max3_f32 v18, v18, v192, v193
  v_max3_f32 v18, v18, v194, v195
  v_max3_f32 v18, v18, v196, v197
  v_max3_f32 v18, v18, v198, v199
  v_max3_f32 v18, v18, v200, v201
  v_max3_f32 v18, v18, v202, v203
  v_max3_f32 v18, v18, v204, v205
  v_max3_f32 v18, v18, v206, v207
  v_mov_b32 v19, v18
  s_nop 1
  v_permlane32_swap_b32 v18, v19
  v_max_f32 v18, v18, v19
  v_sub_f32 v18, 0, v18
  v_mov_b32 v19, v18
  v_pk_add_f32 v[80:81], v[80:81], v[18:19]
  v_pk_add_f32 v[82:83], v[82:83], v[18:19]
  v_pk_add_f32 v[84:85], v[84:85], v[18:19]
  v_pk_add_f32 v[86:87], v[86:87], v[18:19]
  v_pk_add_f32 v[88:89], v[88:89], v[18:19]
  v_pk_add_f32 v[90:91], v[90:91], v[18:19]
  v_pk_add_f32 v[92:93], v[92:93], v[18:19]
  v_pk_add_f32 v[94:95], v[94:95], v[18:19]
  v_exp_f32 v80, v80
  v_exp_f32 v81, v81
  v_exp_f32 v82, v82
  v_exp_f32 v83, v83
  v_exp_f32 v84, v84
  v_exp_f32 v85, v85
  v_exp_f32 v86, v86
  v_exp_f32 v87, v87
  v_exp_f32 v88, v88
  v_exp_f32 v89, v89
  v_exp_f32 v90, v90
  v_exp_f32 v91, v91
  v_exp_f32 v92, v92
  v_exp_f32 v93, v93
  v_exp_f32 v94, v94
  v_exp_f32 v95, v95
  v_cvt_pk_bf16_f32 v208, v80, v81
  v_cvt_pk_bf16_f32 v209, v82, v83
  v_cvt_pk_bf16_f32 v210, v84, v85
  v_cvt_pk_bf16_f32 v211, v86, v87
  v_cvt_pk_bf16_f32 v212, v88, v89
  v_cvt_pk_bf16_f32 v213, v90, v91
  v_cvt_pk_bf16_f32 v214, v92, v93
  v_cvt_pk_bf16_f32 v215, v94, v95
  ds_read_b64_tr_b16 a[0:1], v253 offset:512
  ds_read_b64_tr_b16 a[2:3], v253 offset:640
  ds_read_b64_tr_b16 a[4:5], v253 offset:768
  ds_read_b64_tr_b16 a[6:7], v253 offset:896
  s_waitcnt lgkmcnt(0)
  v_mfma_f32_32x32x16_bf16 v[32:47], a[0:3], v[208:211], 0
  v_mfma_f32_32x32x16_bf16 v[32:47], a[4:7], v[212:215], v[32:47]
  s_nop 7
  v_pk_add_f32 v[96:97], v[96:97], v[18:19]
  v_pk_add_f32 v[98:99], v[98:99], v[18:19]
  v_pk_add_f32 v[100:101], v[100:101], v[18:19]
  v_pk_add_f32 v[102:103], v[102:103], v[18:19]
  v_pk_add_f32 v[104:105], v[104:105], v[18:19]
  v_pk_add_f32 v[106:107], v[106:107], v[18:19]
  v_pk_add_f32 v[108:109], v[108:109], v[18:19]
  v_pk_add_f32 v[110:111], v[110:111], v[18:19]
  v_exp_f32 v96, v96
  v_exp_f32 v97, v97
  v_exp_f32 v98, v98
  v_exp_f32 v99, v99
  v_exp_f32 v100, v100
  v_exp_f32 v101, v101
  v_exp_f32 v102, v102
  v_exp_f32 v103, v103
  v_exp_f32 v104, v104
  v_exp_f32 v105, v105
  v_exp_f32 v106, v106
  v_exp_f32 v107, v107
  v_exp_f32 v108, v108
  v_exp_f32 v109, v109
  v_exp_f32 v110, v110
  v_exp_f32 v111, v111
  v_cvt_pk_bf16_f32 v208, v96, v97
  v_cvt_pk_bf16_f32 v209, v98, v99
  v_cvt_pk_bf16_f32 v210, v100, v101
  v_cvt_pk_bf16_f32 v211, v102, v103
  v_cvt_pk_bf16_f32 v212, v104, v105
  v_cvt_pk_bf16_f32 v213, v106, v107
  v_cvt_pk_bf16_f32 v214, v108, v109
  v_cvt_pk_bf16_f32 v215, v110, v111
  ds_read_b64_tr_b16 a[0:1], v253 offset:1024
  ds_read_b64_tr_b16 a[2:3], v253 offset:1152
  ds_read_b64_tr_b16 a[4:5], v253 offset:1280
  ds_read_b64_tr_b16 a[6:7], v253 offset:1408
  s_waitcnt lgkmcnt(0)
  v_mfma_f32_32x32x16_bf16 v[32:47], a[0:3], v[208:211], v[32:47]
  v_mfma_f32_32x32x16_bf16 v[32:47], a[4:7], v[212:215], v[32:47]
  s_nop 7
  v_pk_add_f32 v[112:113], v[112:113], v[18:19]
  v_pk_add_f32 v[114:115], v[114:115], v[18:19]
  v_pk_add_f32 v[116:117], v[116:117], v[18:19]
  v_pk_add_f32 v[118:119], v[118:119], v[18:19]
  v_pk_add_f32 v[120:121], v[120:121], v[18:19]
  v_pk_add_f32 v[122:123], v[122:123], v[18:19]
  v_pk_add_f32 v[124:125], v[124:125], v[18:19]
  v_pk_add_f32 v[126:127], v[126:127], v[18:19]
  v_exp_f32 v112, v112
  v_exp_f32 v113, v113
  v_exp_f32 v114, v114
  v_exp_f32 v115, v115
  v_exp_f32 v116, v116
  v_exp_f32 v117, v117
  v_exp_f32 v118, v118
  v_exp_f32 v119, v119
  v_exp_f32 v120, v120
  v_exp_f32 v121, v121
  v_exp_f32 v122, v122
  v_exp_f32 v123, v123
  v_exp_f32 v124, v124
  v_exp_f32 v125, v125
  v_exp_f32 v126, v126
  v_exp_f32 v127, v127
  v_cvt_pk_bf16_f32 v208, v112, v113
  v_cvt_pk_bf16_f32 v209, v114, v115
  v_cvt_pk_bf16_f32 v210, v116, v117
  v_cvt_pk_bf16_f32 v211, v118, v119
  v_cvt_pk_bf16_f32 v212, v120, v121
  v_cvt_pk_bf16_f32 v213, v122, v123
  v_cvt_pk_bf16_f32 v214, v124, v125
  v_cvt_pk_bf16_f32 v215, v126, v127
  ds_read_b64_tr_b16 a[0:1], v253 offset:1536
  ds_read_b64_tr_b16 a[2:3], v253 offset:1664
  ds_read_b64_tr_b16 a[4:5], v253 offset:1792
  ds_read_b64_tr_b16 a[6:7], v253 offset:1920
  s_waitcnt lgkmcnt(0)
  v_mfma_f32_32x32x16_bf16 v[32:47], a[0:3], v[208:211], v[32:47]
  v_mfma_f32_32x32x16_bf16 v[32:47], a[4:7], v[212:215], v[32:47]
  s_nop 7
  v_pk_add_f32 v[128:129], v[128:129], v[18:19]
  v_pk_add_f32 v[130:131], v[130:131], v[18:19]
  v_pk_add_f32 v[132:133], v[132:133], v[18:19]
  v_pk_add_f32 v[134:135], v[134:135], v[18:19]
  v_pk_add_f32 v[136:137], v[136:137], v[18:19]
  v_pk_add_f32 v[138:139], v[138:139], v[18:19]
  v_pk_add_f32 v[140:141], v[140:141], v[18:19]
  v_pk_add_f32 v[142:143], v[142:143], v[18:19]
  v_exp_f32 v128, v128
  v_exp_f32 v129, v129
  v_exp_f32 v130, v130
  v_exp_f32 v131, v131
  v_exp_f32 v132, v132
  v_exp_f32 v133, v133
  v_exp_f32 v134, v134
  v_exp_f32 v135, v135
  v_exp_f32 v136, v136
  v_exp_f32 v137, v137
  v_exp_f32 v138, v138
  v_exp_f32 v139, v139
  v_exp_f32 v140, v140
  v_exp_f32 v141, v141
  v_exp_f32 v142, v142
  v_exp_f32 v143, v143
  v_cvt_pk_bf16_f32 v208, v128, v129
  v_cvt_pk_bf16_f32 v209, v130, v131
  v_cvt_pk_bf16_f32 v210, v132, v133
  v_cvt_pk_bf16_f32 v211, v134, v135
  v_cvt_pk_bf16_f32 v212, v136, v137
  v_cvt_pk_bf16_f32 v213, v138, v139
  v_cvt_pk_bf16_f32 v214, v140, v141
  v_cvt_pk_bf16_f32 v215, v142, v143
  ds_read_b64_tr_b16 a[0:1], v253 offset:2048
  ds_read_b64_tr_b16 a[2:3], v253 offset:2176
  ds_read_b64_tr_b16 a[4:5], v253 offset:2304
  ds_read_b64_tr_b16 a[6:7], v253 offset:2432
  s_waitcnt lgkmcnt(0)
  v_mfma_f32_32x32x16_bf16 v[32:47], a[0:3], v[208:211], v[32:47]
  v_mfma_f32_32x32x16_bf16 v[32:47], a[4:7], v[212:215], v[32:47]
  s_nop 7
  v_pk_add_f32 v[144:145], v[144:145], v[18:19]
  v_pk_add_f32 v[146:147], v[146:147], v[18:19]
  v_pk_add_f32 v[148:149], v[148:149], v[18:19]
  v_pk_add_f32 v[150:151], v[150:151], v[18:19]
  v_pk_add_f32 v[152:153], v[152:153], v[18:19]
  v_pk_add_f32 v[154:155], v[154:155], v[18:19]
  v_pk_add_f32 v[156:157], v[156:157], v[18:19]
  v_pk_add_f32 v[158:159], v[158:159], v[18:19]
  v_exp_f32 v144, v144
  v_exp_f32 v145, v145
  v_exp_f32 v146, v146
  v_exp_f32 v147, v147
  v_exp_f32 v148, v148
  v_exp_f32 v149, v149
  v_exp_f32 v150, v150
  v_exp_f32 v151, v151
  v_exp_f32 v152, v152
  v_exp_f32 v153, v153
  v_exp_f32 v154, v154
  v_exp_f32 v155, v155
  v_exp_f32 v156, v156
  v_exp_f32 v157, v157
  v_exp_f32 v158, v158
  v_exp_f32 v159, v159
  v_cvt_pk_bf16_f32 v208, v144, v145
  v_cvt_pk_bf16_f32 v209, v146, v147
  v_cvt_pk_bf16_f32 v210, v148, v149
  v_cvt_pk_bf16_f32 v211, v150, v151
  v_cvt_pk_bf16_f32 v212, v152, v153
  v_cvt_pk_bf16_f32 v213, v154, v155
  v_cvt_pk_bf16_f32 v214, v156, v157
  v_cvt_pk_bf16_f32 v215, v158, v159
  ds_read_b64_tr_b16 a[0:1], v253 offset:2560
  ds_read_b64_tr_b16 a[2:3], v253 offset:2688
  ds_read_b64_tr_b16 a[4:5], v253 offset:2816
  ds_read_b64_tr_b16 a[6:7], v253 offset:2944
  s_waitcnt lgkmcnt(0)
  v_mfma_f32_32x32x16_bf16 v[32:47], a[0:3], v[208:211], v[32:47]
  v_mfma_f32_32x32x16_bf16 v[32:47], a[4:7], v[212:215], v[32:47]
  s_nop 7
  v_pk_add_f32 v[160:161], v[160:161], v[18:19]
  v_pk_add_f32 v[162:163], v[162:163], v[18:19]
  v_pk_add_f32 v[164:165], v[164:165], v[18:19]
  v_pk_add_f32 v[166:167], v[166:167], v[18:19]
  v_pk_add_f32 v[168:169], v[168:169], v[18:19]
  v_pk_add_f32 v[170:171], v[170:171], v[18:19]
  v_pk_add_f32 v[172:173], v[172:173], v[18:19]
  v_pk_add_f32 v[174:175], v[174:175], v[18:19]
  v_exp_f32 v160, v160
  v_exp_f32 v161, v161
  v_exp_f32 v162, v162
  v_exp_f32 v163, v163
  v_exp_f32 v164, v164
  v_exp_f32 v165, v165
  v_exp_f32 v166, v166
  v_exp_f32 v167, v167
  v_exp_f32 v168, v168
  v_exp_f32 v169, v169
  v_exp_f32 v170, v170
  v_exp_f32 v171, v171
  v_exp_f32 v172, v172
  v_exp_f32 v173, v173
  v_exp_f32 v174, v174
  v_exp_f32 v175, v175
  v_cvt_pk_bf16_f32 v208, v160, v161
  v_cvt_pk_bf16_f32 v209, v162, v163
  v_cvt_pk_bf16_f32 v210, v164, v165
  v_cvt_pk_bf16_f32 v211, v166, v167
  v_cvt_pk_bf16_f32 v212, v168, v169
  v_cvt_pk_bf16_f32 v213, v170, v171
  v_cvt_pk_bf16_f32 v214, v172, v173
  v_cvt_pk_bf16_f32 v215, v174, v175
  ds_read_b64_tr_b16 a[0:1], v253 offset:3072
  ds_read_b64_tr_b16 a[2:3], v253 offset:3200
  ds_read_b64_tr_b16 a[4:5], v253 offset:3328
  ds_read_b64_tr_b16 a[6:7], v253 offset:3456
  s_waitcnt lgkmcnt(0)
  v_mfma_f32_32x32x16_bf16 v[32:47], a[0:3], v[208:211], v[32:47]
  v_mfma_f32_32x32x16_bf16 v[32:47], a[4:7], v[212:215], v[32:47]
  s_nop 7
  v_pk_add_f32 v[176:177], v[176:177], v[18:19]
  v_pk_add_f32 v[178:179], v[178:179], v[18:19]
  v_pk_add_f32 v[180:181], v[180:181], v[18:19]
  v_pk_add_f32 v[182:183], v[182:183], v[18:19]
  v_pk_add_f32 v[184:185], v[184:185], v[18:19]
  v_pk_add_f32 v[186:187], v[186:187], v[18:19]
  v_pk_add_f32 v[188:189], v[188:189], v[18:19]
  v_pk_add_f32 v[190:191], v[190:191], v[18:19]
  v_exp_f32 v176, v176
  v_exp_f32 v177, v177
  v_exp_f32 v178, v178
  v_exp_f32 v179, v179
  v_exp_f32 v180, v180
  v_exp_f32 v181, v181
  v_exp_f32 v182, v182
  v_exp_f32 v183, v183
  v_exp_f32 v184, v184
  v_exp_f32 v185, v185
  v_exp_f32 v186, v186
  v_exp_f32 v187, v187
  v_exp_f32 v188, v188
  v_exp_f32 v189, v189
  v_exp_f32 v190, v190
  v_exp_f32 v191, v191
  v_cvt_pk_bf16_f32 v208, v176, v177
  v_cvt_pk_bf16_f32 v209, v178, v179
  v_cvt_pk_bf16_f32 v210, v180, v181
  v_cvt_pk_bf16_f32 v211, v182, v183
  v_cvt_pk_bf16_f32 v212, v184, v185
  v_cvt_pk_bf16_f32 v213, v186, v187
  v_cvt_pk_bf16_f32 v214, v188, v189
  v_cvt_pk_bf16_f32 v215, v190, v191
  ds_read_b64_tr_b16 a[0:1], v253 offset:3584
  ds_read_b64_tr_b16 a[2:3], v253 offset:3712
  ds_read_b64_tr_b16 a[4:5], v253 offset:3840
  ds_read_b64_tr_b16 a[6:7], v253 offset:3968
  s_waitcnt lgkmcnt(0)
  v_mfma_f32_32x32x16_bf16 v[32:47], a[0:3], v[208:211], v[32:47]
  v_mfma_f32_32x32x16_bf16 v[32:47], a[4:7], v[212:215], v[32:47]
  s_nop 7
  v_pk_add_f32 v[192:193], v[192:193], v[18:19]
  v_pk_add_f32 v[194:195], v[194:195], v[18:19]
  v_pk_add_f32 v[196:197], v[196:197], v[18:19]
  v_pk_add_f32 v[198:199], v[198:199], v[18:19]
  v_pk_add_f32 v[200:201], v[200:201], v[18:19]
  v_pk_add_f32 v[202:203], v[202:203], v[18:19]
  v_pk_add_f32 v[204:205], v[204:205], v[18:19]
  v_pk_add_f32 v[206:207], v[206:207], v[18:19]
  v_exp_f32 v192, v192
  v_exp_f32 v193, v193
  v_exp_f32 v194, v194
  v_exp_f32 v195, v195
  v_exp_f32 v196, v196
  v_exp_f32 v197, v197
  v_exp_f32 v198, v198
  v_exp_f32 v199, v199
  v_exp_f32 v200, v200
  v_exp_f32 v201, v201
  v_exp_f32 v202, v202
  v_exp_f32 v203, v203
  v_exp_f32 v204, v204
  v_exp_f32 v205, v205
  v_exp_f32 v206, v206
  v_exp_f32 v207, v207
  v_cvt_pk_bf16_f32 v208, v192, v193
  v_cvt_pk_bf16_f32 v209, v194, v195
  v_cvt_pk_bf16_f32 v210, v196, v197
  v_cvt_pk_bf16_f32 v211, v198, v199
  v_cvt_pk_bf16_f32 v212, v200, v201
  v_cvt_pk_bf16_f32 v213, v202, v203
  v_cvt_pk_bf16_f32 v214, v204, v205
  v_cvt_pk_bf16_f32 v215, v206, v207
  v_bfi_b32 v216, v24, 0, v208
  v_bfi_b32 v217, v25, 0, v209
  v_bfi_b32 v218, v26, 0, v210
  v_bfi_b32 v219, v27, 0, v211
  v_bfi_b32 v220, v28, 0, v212
  v_bfi_b32 v221, v29, 0, v213
  v_bfi_b32 v222, v30, 0, v214
  v_bfi_b32 v223, v31, 0, v215
  v_and_b32 v208, v24, v208
  v_and_b32 v209, v25, v209
  v_and_b32 v210, v26, v210
  v_and_b32 v211, v27, v211
  v_and_b32 v212, v28, v212
  v_and_b32 v213, v29, v213
  v_and_b32 v214, v30, v214
  v_and_b32 v215, v31, v215
  ds_read_b64_tr_b16 a[0:1], v253 offset:0
  ds_read_b64_tr_b16 a[2:3], v253 offset:128
  ds_read_b64_tr_b16 a[4:5], v253 offset:256
  ds_read_b64_tr_b16 a[6:7], v253 offset:384
  s_waitcnt lgkmcnt(0)
  v_mfma_f32_32x32x16_bf16 v[32:47], a[0:3], v[216:219], v[32:47]
  v_mfma_f32_32x32x16_bf16 v[32:47], a[4:7], v[220:223], v[32:47]
  s_nop 7
  ds_read_b64_tr_b16 a[0:1], v253 offset:4096
  ds_read_b64_tr_b16 a[2:3], v253 offset:4224
  ds_read_b64_tr_b16 a[4:5], v253 offset:4352
  ds_read_b64_tr_b16 a[6:7], v253 offset:4480
  s_waitcnt lgkmcnt(0)
  v_mfma_f32_32x32x16_bf16 v[32:47], a[0:3], v[208:211], v[32:47]
  v_mfma_f32_32x32x16_bf16 v[32:47], a[4:7], v[212:215], v[32:47]
  s_nop 7
  ds_read_b128 a[0:3], v252 offset:512
  ds_read_b128 a[4:7], v246 offset:512
  s_waitcnt lgkmcnt(0)
  v_mfma_f32_32x32x16_bf16 v[64:79], a[0:3], v[232:235], 0
  v_mfma_f32_32x32x16_bf16 v[64:79], a[4:7], v[236:239], v[64:79]
  s_nop 7
  ds_read_b128 a[0:3], v252 offset:1024
  ds_read_b128 a[4:7], v246 offset:1024
  s_waitcnt lgkmcnt(0)
  v_mfma_f32_32x32x16_bf16 v[80:95], a[0:3], v[232:235], 0
  v_mfma_f32_32x32x16_bf16 v[80:95], a[4:7], v[236:239], v[80:95]
  s_nop 7
  ds_read_b128 a[0:3], v252 offset:1536
  ds_read_b128 a[4:7], v246 offset:1536
  s_waitcnt lgkmcnt(0)
  v_mfma_f32_32x32x16_bf16 v[96:111], a[0:3], v[232:235], 0
  v_mfma_f32_32x32x16_bf16 v[96:111], a[4:7], v[236:239], v[96:111]
  s_nop 7
  ds_read_b128 a[0:3], v252 offset:2048
  ds_read_b128 a[4:7], v246 offset:2048
  s_waitcnt lgkmcnt(0)
  v_mfma_f32_32x32x16_bf16 v[112:127], a[0:3], v[232:235], 0
  v_mfma_f32_32x32x16_bf16 v[112:127], a[4:7], v[236:239], v[112:127]
  s_nop 7
  ds_read_b128 a[0:3], v252 offset:2560
  ds_read_b128 a[4:7], v246 offset:2560
  s_waitcnt lgkmcnt(0)
  v_mfma_f32_32x32x16_bf16 v[128:143], a[0:3], v[232:235], 0
  v_mfma_f32_32x32x16_bf16 v[128:143], a[4:7], v[236:239], v[128:143]
  s_nop 7
  ds_read_b128 a[0:3], v252 offset:3072
  ds_read_b128 a[4:7], v246 offset:3072
  s_waitcnt lgkmcnt(0)
  v_mfma_f32_32x32x16_bf16 v[144:159], a[0:3], v[232:235], 0
  v_mfma_f32_32x32x16_bf16 v[144:159], a[4:7], v[236:239], v[144:159]
  s_nop 7
  ds_read_b128 a[0:3], v252 offset:3584
  ds_read_b128 a[4:7], v246 offset:3584
  s_waitcnt lgkmcnt(0)
  v_mfma_f32_32x32x16_bf16 v[160:175], a[0:3], v[232:235], 0
  v_mfma_f32_32x32x16_bf16 v[160:175], a[4:7], v[236:239], v[160:175]
  s_nop 7
  ds_read_b128 a[0:3], v252 offset:4096
  ds_read_b128 a[4:7], v246 offset:4096
  s_waitcnt lgkmcnt(0)
  v_mfma_f32_32x32x16_bf16 v[176:191], a[0:3], v[232:235], 0
  v_mfma_f32_32x32x16_bf16 v[176:191], a[4:7], v[236:239], v[176:191]
  s_nop 7
  ds_read_b128 a[0:3], v252 offset:4608
  ds_read_b128 a[4:7], v246 offset:4608
  s_waitcnt lgkmcnt(0)
  v_mfma_f32_32x32x16_bf16 v[192:207], a[0:3], v[232:235], 0
  v_mfma_f32_32x32x16_bf16 v[192:207], a[4:7], v[236:239], v[192:207]
  s_nop 7
  s_nop 3
  v_cndmask_b32 v192, v64, v192, s[64:65]
  v_cndmask_b32 v193, v65, v193, s[66:67]
  v_cndmask_b32 v194, v66, v194, s[68:69]
  v_cndmask_b32 v195, v67, v195, s[70:71]
  v_cndmask_b32 v196, v68, v196, s[72:73]
  v_cndmask_b32 v197, v69, v197, s[74:75]
  v_cndmask_b32 v198, v70, v198, s[76:77]
  v_cndmask_b32 v199, v71, v199, s[78:79]
  v_cndmask_b32 v200, v72, v200, s[80:81]
  v_cndmask_b32 v201, v73, v201, s[82:83]
  v_cndmask_b32 v202, v74, v202, s[84:85]
  v_cndmask_b32 v203, v75, v203, s[86:87]
  v_cndmask_b32 v204, v76, v204, s[88:89]
  v_cndmask_b32 v205, v77, v205, s[90:91]
  v_cndmask_b32 v206, v78, v206, s[98:99]
  v_cndmask_b32 v207, v79, v207, s[100:101]
  v_mov_b32 v18, v80
  v_max3_f32 v18, v18, v80, v81
  v_max3_f32 v18, v18, v82, v83
  v_max3_f32 v18, v18, v84, v85
  v_max3_f32 v18, v18, v86, v87
  v_max3_f32 v18, v18, v88, v89
  v_max3_f32 v18, v18, v90, v91
  v_max3_f32 v18, v18, v92, v93
  v_max3_f32 v18, v18, v94, v95
  v_max3_f32 v18, v18, v96, v97
  v_max3_f32 v18, v18, v98, v99
  v_max3_f32 v18, v18, v100, v101
  v_max3_f32 v18, v18, v102, v103
  v_max3_f32 v18, v18, v104, v105
  v_max3_f32 v18, v18, v106, v107
  v_max3_f32 v18, v18, v108, v109
  v_max3_f32 v18, v18, v110, v111
  v_max3_f32 v18, v18, v112, v113
  v_max3_f32 v18, v18, v114, v115
  v_max3_f32 v18, v18, v116, v117
  v_max3_f32 v18, v18, v118, v119
  v_max3_f32 v18, v18, v120, v121
  v_max3_f32 v18, v18, v122, v123
  v_max3_f32 v18, v18, v124, v125
  v_max3_f32 v18, v18, v126, v127
  v_max3_f32 v18, v18, v128, v129
  v_max3_f32 v18, v18, v130, v131
  v_max3_f32 v18, v18, v132, v133
  v_max3_f32 v18, v18, v134, v135
  v_max3_f32 v18, v18, v136, v137
  v_max3_f32 v18, v18, v138, v139
  v_max3_f32 v18, v18, v140, v141
  v_max3_f32 v18, v18, v142, v143
  v_max3_f32 v18, v18, v144, v145
  v_max3_f32 v18, v18, v146, v147
  v_max3_f32 v18, v18, v148, v149
  v_max3_f32 v18, v18, v150, v151
  v_max3_f32 v18, v18, v152, v153
  v_max3_f32 v18, v18, v154, v155
  v_max3_f32 v18, v18, v156, v157
  v_max3_f32 v18, v18, v158, v159
  v_max3_f32 v18, v18, v160, v161
  v_max3_f32 v18, v18, v162, v163
  v_max3_f32 v18, v18, v164, v165
  v_max3_f32 v18, v18, v166, v167
  v_max3_f32 v18, v18, v168, v169
  v_max3_f32 v18, v18, v170, v171
  v_max3_f32 v18, v18, v172, v173
  v_max3_f32 v18, v18, v174, v175
  v_max3_f32 v18, v18, v176, v177
  v_max3_f32 v18, v18, v178, v179
  v_max3_f32 v18, v18, v180, v181
  v_max3_f32 v18, v18, v182, v183
  v_max3_f32 v18, v18, v184, v185
  v_max3_f32 v18, v18, v186, v187
  v_max3_f32 v18, v18, v188, v189
  v_max3_f32 v18, v18, v190, v191
  v_max3_f32 v18, v18, v192, v193
  v_max3_f32 v18, v18, v194, v195
  v_max3_f32 v18, v18, v196, v197
  v_max3_f32 v18, v18, v198, v199
  v_max3_f32 v18, v18, v200, v201
  v_max3_f32 v18, v18, v202, v203
  v_max3_f32 v18, v18, v204, v205
  v_max3_f32 v18, v18, v206, v207
  v_mov_b32 v19, v18
  s_nop 1
  v_permlane32_swap_b32 v18, v19
  v_max_f32 v18, v18, v19
  v_sub_f32 v18, 0, v18
  v_mov_b32 v19, v18
  v_pk_add_f32 v[80:81], v[80:81], v[18:19]
  v_pk_add_f32 v[82:83], v[82:83], v[18:19]
  v_pk_add_f32 v[84:85], v[84:85], v[18:19]
  v_pk_add_f32 v[86:87], v[86:87], v[18:19]
  v_pk_add_f32 v[88:89], v[88:89], v[18:19]
  v_pk_add_f32 v[90:91], v[90:91], v[18:19]
  v_pk_add_f32 v[92:93], v[92:93], v[18:19]
  v_pk_add_f32 v[94:95], v[94:95], v[18:19]
  v_exp_f32 v80, v80
  v_exp_f32 v81, v81
  v_exp_f32 v82, v82
  v_exp_f32 v83, v83
  v_exp_f32 v84, v84
  v_exp_f32 v85, v85
  v_exp_f32 v86, v86
  v_exp_f32 v87, v87
  v_exp_f32 v88, v88
  v_exp_f32 v89, v89
  v_exp_f32 v90, v90
  v_exp_f32 v91, v91
  v_exp_f32 v92, v92
  v_exp_f32 v93, v93
  v_exp_f32 v94, v94
  v_exp_f32 v95, v95
  v_cvt_pk_bf16_f32 v208, v80, v81
  v_cvt_pk_bf16_f32 v209, v82, v83
  v_cvt_pk_bf16_f32 v210, v84, v85
  v_cvt_pk_bf16_f32 v211, v86, v87
  v_cvt_pk_bf16_f32 v212, v88, v89
  v_cvt_pk_bf16_f32 v213, v90, v91
  v_cvt_pk_bf16_f32 v214, v92, v93
  v_cvt_pk_bf16_f32 v215, v94, v95
  ds_read_b64_tr_b16 a[0:1], v253 offset:1024
  ds_read_b64_tr_b16 a[2:3], v253 offset:1152
  ds_read_b64_tr_b16 a[4:5], v253 offset:1280
  ds_read_b64_tr_b16 a[6:7], v253 offset:1408
  s_waitcnt lgkmcnt(0)
  v_mfma_f32_32x32x16_bf16 v[48:63], a[0:3], v[208:211], 0
  v_mfma_f32_32x32x16_bf16 v[48:63], a[4:7], v[212:215], v[48:63]
  s_nop 7
  v_pk_add_f32 v[96:97], v[96:97], v[18:19]
  v_pk_add_f32 v[98:99], v[98:99], v[18:19]
  v_pk_add_f32 v[100:101], v[100:101], v[18:19]
  v_pk_add_f32 v[102:103], v[102:103], v[18:19]
  v_pk_add_f32 v[104:105], v[104:105], v[18:19]
  v_pk_add_f32 v[106:107], v[106:107], v[18:19]
  v_pk_add_f32 v[108:109], v[108:109], v[18:19]
  v_pk_add_f32 v[110:111], v[110:111], v[18:19]
  v_exp_f32 v96, v96
  v_exp_f32 v97, v97
  v_exp_f32 v98, v98
  v_exp_f32 v99, v99
  v_exp_f32 v100, v100
  v_exp_f32 v101, v101
  v_exp_f32 v102, v102
  v_exp_f32 v103, v103
  v_exp_f32 v104, v104
  v_exp_f32 v105, v105
  v_exp_f32 v106, v106
  v_exp_f32 v107, v107
  v_exp_f32 v108, v108
  v_exp_f32 v109, v109
  v_exp_f32 v110, v110
  v_exp_f32 v111, v111
  v_cvt_pk_bf16_f32 v208, v96, v97
  v_cvt_pk_bf16_f32 v209, v98, v99
  v_cvt_pk_bf16_f32 v210, v100, v101
  v_cvt_pk_bf16_f32 v211, v102, v103
  v_cvt_pk_bf16_f32 v212, v104, v105
  v_cvt_pk_bf16_f32 v213, v106, v107
  v_cvt_pk_bf16_f32 v214, v108, v109
  v_cvt_pk_bf16_f32 v215, v110, v111
  ds_read_b64_tr_b16 a[0:1], v253 offset:1536
  ds_read_b64_tr_b16 a[2:3], v253 offset:1664
  ds_read_b64_tr_b16 a[4:5], v253 offset:1792
  ds_read_b64_tr_b16 a[6:7], v253 offset:1920
  s_waitcnt lgkmcnt(0)
  v_mfma_f32_32x32x16_bf16 v[48:63], a[0:3], v[208:211], v[48:63]
  v_mfma_f32_32x32x16_bf16 v[48:63], a[4:7], v[212:215], v[48:63]
  s_nop 7
  v_pk_add_f32 v[112:113], v[112:113], v[18:19]
  v_pk_add_f32 v[114:115], v[114:115], v[18:19]
  v_pk_add_f32 v[116:117], v[116:117], v[18:19]
  v_pk_add_f32 v[118:119], v[118:119], v[18:19]
  v_pk_add_f32 v[120:121], v[120:121], v[18:19]
  v_pk_add_f32 v[122:123], v[122:123], v[18:19]
  v_pk_add_f32 v[124:125], v[124:125], v[18:19]
  v_pk_add_f32 v[126:127], v[126:127], v[18:19]
  v_exp_f32 v112, v112
  v_exp_f32 v113, v113
  v_exp_f32 v114, v114
  v_exp_f32 v115, v115
  v_exp_f32 v116, v116
  v_exp_f32 v117, v117
  v_exp_f32 v118, v118
  v_exp_f32 v119, v119
  v_exp_f32 v120, v120
  v_exp_f32 v121, v121
  v_exp_f32 v122, v122
  v_exp_f32 v123, v123
  v_exp_f32 v124, v124
  v_exp_f32 v125, v125
  v_exp_f32 v126, v126
  v_exp_f32 v127, v127
  v_cvt_pk_bf16_f32 v208, v112, v113
  v_cvt_pk_bf16_f32 v209, v114, v115
  v_cvt_pk_bf16_f32 v210, v116, v117
  v_cvt_pk_bf16_f32 v211, v118, v119
  v_cvt_pk_bf16_f32 v212, v120, v121
  v_cvt_pk_bf16_f32 v213, v122, v123
  v_cvt_pk_bf16_f32 v214, v124, v125
  v_cvt_pk_bf16_f32 v215, v126, v127
  ds_read_b64_tr_b16 a[0:1], v253 offset:2048
  ds_read_b64_tr_b16 a[2:3], v253 offset:2176
  ds_read_b64_tr_b16 a[4:5], v253 offset:2304
  ds_read_b64_tr_b16 a[6:7], v253 offset:2432
  s_waitcnt lgkmcnt(0)
  v_mfma_f32_32x32x16_bf16 v[48:63], a[0:3], v[208:211], v[48:63]
  v_mfma_f32_32x32x16_bf16 v[48:63], a[4:7], v[212:215], v[48:63]
  s_nop 7
  v_pk_add_f32 v[128:129], v[128:129], v[18:19]
  v_pk_add_f32 v[130:131], v[130:131], v[18:19]
  v_pk_add_f32 v[132:133], v[132:133], v[18:19]
  v_pk_add_f32 v[134:135], v[134:135], v[18:19]
  v_pk_add_f32 v[136:137], v[136:137], v[18:19]
  v_pk_add_f32 v[138:139], v[138:139], v[18:19]
  v_pk_add_f32 v[140:141], v[140:141], v[18:19]
  v_pk_add_f32 v[142:143], v[142:143], v[18:19]
  v_exp_f32 v128, v128
  v_exp_f32 v129, v129
  v_exp_f32 v130, v130
  v_exp_f32 v131, v131
  v_exp_f32 v132, v132
  v_exp_f32 v133, v133
  v_exp_f32 v134, v134
  v_exp_f32 v135, v135
  v_exp_f32 v136, v136
  v_exp_f32 v137, v137
  v_exp_f32 v138, v138
  v_exp_f32 v139, v139
  v_exp_f32 v140, v140
  v_exp_f32 v141, v141
  v_exp_f32 v142, v142
  v_exp_f32 v143, v143
  v_cvt_pk_bf16_f32 v208, v128, v129
  v_cvt_pk_bf16_f32 v209, v130, v131
  v_cvt_pk_bf16_f32 v210, v132, v133
  v_cvt_pk_bf16_f32 v211, v134, v135
  v_cvt_pk_bf16_f32 v212, v136, v137
  v_cvt_pk_bf16_f32 v213, v138, v139
  v_cvt_pk_bf16_f32 v214, v140, v141
  v_cvt_pk_bf16_f32 v215, v142, v143
  ds_read_b64_tr_b16 a[0:1], v253 offset:2560
  ds_read_b64_tr_b16 a[2:3], v253 offset:2688
  ds_read_b64_tr_b16 a[4:5], v253 offset:2816
  ds_read_b64_tr_b16 a[6:7], v253 offset:2944
  s_waitcnt lgkmcnt(0)
  v_mfma_f32_32x32x16_bf16 v[48:63], a[0:3], v[208:211], v[48:63]
  v_mfma_f32_32x32x16_bf16 v[48:63], a[4:7], v[212:215], v[48:63]
  s_nop 7
  v_pk_add_f32 v[144:145], v[144:145], v[18:19]
  v_pk_add_f32 v[146:147], v[146:147], v[18:19]
  v_pk_add_f32 v[148:149], v[148:149], v[18:19]
  v_pk_add_f32 v[150:151], v[150:151], v[18:19]
  v_pk_add_f32 v[152:153], v[152:153], v[18:19]
  v_pk_add_f32 v[154:155], v[154:155], v[18:19]
  v_pk_add_f32 v[156:157], v[156:157], v[18:19]
  v_pk_add_f32 v[158:159], v[158:159], v[18:19]
  v_exp_f32 v144, v144
  v_exp_f32 v145, v145
  v_exp_f32 v146, v146
  v_exp_f32 v147, v147
  v_exp_f32 v148, v148
  v_exp_f32 v149, v149
  v_exp_f32 v150, v150
  v_exp_f32 v151, v151
  v_exp_f32 v152, v152
  v_exp_f32 v153, v153
  v_exp_f32 v154, v154
  v_exp_f32 v155, v155
  v_exp_f32 v156, v156
  v_exp_f32 v157, v157
  v_exp_f32 v158, v158
  v_exp_f32 v159, v159
  v_cvt_pk_bf16_f32 v208, v144, v145
  v_cvt_pk_bf16_f32 v209, v146, v147
  v_cvt_pk_bf16_f32 v210, v148, v149
  v_cvt_pk_bf16_f32 v211, v150, v151
  v_cvt_pk_bf16_f32 v212, v152, v153
  v_cvt_pk_bf16_f32 v213, v154, v155
  v_cvt_pk_bf16_f32 v214, v156, v157
  v_cvt_pk_bf16_f32 v215, v158, v159
  ds_read_b64_tr_b16 a[0:1], v253 offset:3072
  ds_read_b64_tr_b16 a[2:3], v253 offset:3200
  ds_read_b64_tr_b16 a[4:5], v253 offset:3328
  ds_read_b64_tr_b16 a[6:7], v253 offset:3456
  s_waitcnt lgkmcnt(0)
  v_mfma_f32_32x32x16_bf16 v[48:63], a[0:3], v[208:211], v[48:63]
  v_mfma_f32_32x32x16_bf16 v[48:63], a[4:7], v[212:215], v[48:63]
  s_nop 7
  v_pk_add_f32 v[160:161], v[160:161], v[18:19]
  v_pk_add_f32 v[162:163], v[162:163], v[18:19]
  v_pk_add_f32 v[164:165], v[164:165], v[18:19]
  v_pk_add_f32 v[166:167], v[166:167], v[18:19]
  v_pk_add_f32 v[168:169], v[168:169], v[18:19]
  v_pk_add_f32 v[170:171], v[170:171], v[18:19]
  v_pk_add_f32 v[172:173], v[172:173], v[18:19]
  v_pk_add_f32 v[174:175], v[174:175], v[18:19]
  v_exp_f32 v160, v160
  v_exp_f32 v161, v161
  v_exp_f32 v162, v162
  v_exp_f32 v163, v163
  v_exp_f32 v164, v164
  v_exp_f32 v165, v165
  v_exp_f32 v166, v166
  v_exp_f32 v167, v167
  v_exp_f32 v168, v168
  v_exp_f32 v169, v169
  v_exp_f32 v170, v170
  v_exp_f32 v171, v171
  v_exp_f32 v172, v172
  v_exp_f32 v173, v173
  v_exp_f32 v174, v174
  v_exp_f32 v175, v175
  v_cvt_pk_bf16_f32 v208, v160, v161
  v_cvt_pk_bf16_f32 v209, v162, v163
  v_cvt_pk_bf16_f32 v210, v164, v165
  v_cvt_pk_bf16_f32 v211, v166, v167
  v_cvt_pk_bf16_f32 v212, v168, v169
  v_cvt_pk_bf16_f32 v213, v170, v171
  v_cvt_pk_bf16_f32 v214, v172, v173
  v_cvt_pk_bf16_f32 v215, v174, v175
  ds_read_b64_tr_b16 a[0:1], v253 offset:3584
  ds_read_b64_tr_b16 a[2:3], v253 offset:3712
  ds_read_b64_tr_b16 a[4:5], v253 offset:3840
  ds_read_b64_tr_b16 a[6:7], v253 offset:3968
  s_waitcnt lgkmcnt(0)
  v_mfma_f32_32x32x16_bf16 v[48:63], a[0:3], v[208:211], v[48:63]
  v_mfma_f32_32x32x16_bf16 v[48:63], a[4:7], v[212:215], v[48:63]
  s_nop 7
  v_pk_add_f32 v[176:177], v[176:177], v[18:19]
  v_pk_add_f32 v[178:179], v[178:179], v[18:19]
  v_pk_add_f32 v[180:181], v[180:181], v[18:19]
  v_pk_add_f32 v[182:183], v[182:183], v[18:19]
  v_pk_add_f32 v[184:185], v[184:185], v[18:19]
  v_pk_add_f32 v[186:187], v[186:187], v[18:19]
  v_pk_add_f32 v[188:189], v[188:189], v[18:19]
  v_pk_add_f32 v[190:191], v[190:191], v[18:19]
  v_exp_f32 v176, v176
  v_exp_f32 v177, v177
  v_exp_f32 v178, v178
  v_exp_f32 v179, v179
  v_exp_f32 v180, v180
  v_exp_f32 v181, v181
  v_exp_f32 v182, v182
  v_exp_f32 v183, v183
  v_exp_f32 v184, v184
  v_exp_f32 v185, v185
  v_exp_f32 v186, v186
  v_exp_f32 v187, v187
  v_exp_f32 v188, v188
  v_exp_f32 v189, v189
  v_exp_f32 v190, v190
  v_exp_f32 v191, v191
  v_cvt_pk_bf16_f32 v208, v176, v177
  v_cvt_pk_bf16_f32 v209, v178, v179
  v_cvt_pk_bf16_f32 v210, v180, v181
  v_cvt_pk_bf16_f32 v211, v182, v183
  v_cvt_pk_bf16_f32 v212, v184, v185
  v_cvt_pk_bf16_f32 v213, v186, v187
  v_cvt_pk_bf16_f32 v214, v188, v189
  v_cvt_pk_bf16_f32 v215, v190, v191
  ds_read_b64_tr_b16 a[0:1], v253 offset:4096
  ds_read_b64_tr_b16 a[2:3], v253 offset:4224
  ds_read_b64_tr_b16 a[4:5], v253 offset:4352
  ds_read_b64_tr_b16 a[6:7], v253 offset:4480
  s_waitcnt lgkmcnt(0)
  v_mfma_f32_32x32x16_bf16 v[48:63], a[0:3], v[208:211], v[48:63]
  v_mfma_f32_32x32x16_bf16 v[48:63], a[4:7], v[212:215], v[48:63]
  s_nop 7
  v_pk_add_f32 v[192:193], v[192:193], v[18:19]
  v_pk_add_f32 v[194:195], v[194:195], v[18:19]
  v_pk_add_f32 v[196:197], v[196:197], v[18:19]
  v_pk_add_f32 v[198:199], v[198:199], v[18:19]
  v_pk_add_f32 v[200:201], v[200:201], v[18:19]
  v_pk_add_f32 v[202:203], v[202:203], v[18:19]
  v_pk_add_f32 v[204:205], v[204:205], v[18:19]
  v_pk_add_f32 v[206:207], v[206:207], v[18:19]
  v_exp_f32 v192, v192
  v_exp_f32 v193, v193
  v_exp_f32 v194, v194
  v_exp_f32 v195, v195
  v_exp_f32 v196, v196
  v_exp_f32 v197, v197
  v_exp_f32 v198, v198
  v_exp_f32 v199, v199
  v_exp_f32 v200, v200
  v_exp_f32 v201, v201
  v_exp_f32 v202, v202
  v_exp_f32 v203, v203
  v_exp_f32 v204, v204
  v_exp_f32 v205, v205
  v_exp_f32 v206, v206
  v_exp_f32 v207, v207
  v_cvt_pk_bf16_f32 v208, v192, v193
  v_cvt_pk_bf16_f32 v209, v194, v195
  v_cvt_pk_bf16_f32 v210, v196, v197
  v_cvt_pk_bf16_f32 v211, v198, v199
  v_cvt_pk_bf16_f32 v212, v200, v201
  v_cvt_pk_bf16_f32 v213, v202, v203
  v_cvt_pk_bf16_f32 v214, v204, v205
  v_cvt_pk_bf16_f32 v215, v206, v207
  v_bfi_b32 v216, v24, 0, v208
  v_bfi_b32 v217, v25, 0, v209
  v_bfi_b32 v218, v26, 0, v210
  v_bfi_b32 v219, v27, 0, v211
  v_bfi_b32 v220, v28, 0, v212
  v_bfi_b32 v221, v29, 0, v213
  v_bfi_b32 v222, v30, 0, v214
  v_bfi_b32 v223, v31, 0, v215
  v_and_b32 v208, v24, v208
  v_and_b32 v209, v25, v209
  v_and_b32 v210, v26, v210
  v_and_b32 v211, v27, v211
  v_and_b32 v212, v28, v212
  v_and_b32 v213, v29, v213
  v_and_b32 v214, v30, v214
  v_and_b32 v215, v31, v215
  ds_read_b64_tr_b16 a[0:1], v253 offset:512
  ds_read_b64_tr_b16 a[2:3], v253 offset:640
  ds_read_b64_tr_b16 a[4:5], v253 offset:768
  ds_read_b64_tr_b16 a[6:7], v253 offset:896
  s_waitcnt lgkmcnt(0)
  v_mfma_f32_32x32x16_bf16 v[48:63], a[0:3], v[216:219], v[48:63]
  v_mfma_f32_32x32x16_bf16 v[48:63], a[4:7], v[220:223], v[48:63]
  s_nop 7
  ds_read_b64_tr_b16 a[0:1], v253 offset:4608
  ds_read_b64_tr_b16 a[2:3], v253 offset:4736
  ds_read_b64_tr_b16 a[4:5], v253 offset:4864
  ds_read_b64_tr_b16 a[6:7], v253 offset:4992
  s_waitcnt lgkmcnt(0)
  v_mfma_f32_32x32x16_bf16 v[48:63], a[0:3], v[208:211], v[48:63]
  v_mfma_f32_32x32x16_bf16 v[48:63], a[4:7], v[212:215], v[48:63]
  s_nop 7
  s_nop 3
  s_branch Latt_fin
.p2align 2
.type Lrtab,@object
Lrtab:
  .long 0x14104000
  .long 0x14104028
  .long 0x14104050
  .long 0x14104078
  .long 0x141040a0
  .long 0x141040c8
  .long 0x141040f0
  .long 0x14104118
  .long 0x14104140
  .long 0x14104168
  .long 0x14104190
  .long 0x141041b8
  .long 0x141041e0
  .long 0x14104208
  .long 0x14104230
  .long 0x14104258
  .long 0x50a0a010
  .long 0x50a0a0b0
  .long 0x50a0a150
  .long 0x50a0a1f0
  .long 0x8108000
  .long 0x8108020
  .long 0x8108050
  .long 0x8108070
  .long 0x8128040
  .long 0x81080a0
  .long 0x81080c0
  .long 0x81080f0
  .long 0x8108110
  .long 0x81280e0
  .long 0x8108140
  .long 0x8108160
  .long 0x8108190
  .long 0x81081b0
  .long 0x8128180
  .long 0x81081e0
  .long 0x8108200
  .long 0x8108230
  .long 0x8108250
  .long 0x8128220
  .long 0x8108000
  .long 0x8108020
  .long 0x8108050
  .long 0x8108070
  .long 0x8128040
  .long 0x81080a0
  .long 0x81080c0
  .long 0x81080f0
  .long 0x8108110
  .long 0x81280e0
  .long 0x8108140
  .long 0x8108160
  .long 0x8108190
  .long 0x81081b0
  .long 0x8128180
  .long 0x81081e0
  .long 0x8108200
  .long 0x8108230
  .long 0x8108250
  .long 0x8128220
  .long 0x8108000
  .long 0x8108020
  .long 0x8108040
  .long 0x8108070
  .long 0x8108090
  .long 0x81080b0
  .long 0x8138060
  .long 0x81080e0
  .long 0x8108100
  .long 0x8108120
  .long 0x8108150
  .long 0x8108170
  .long 0x8108190
  .long 0x8138140
  .long 0x81081c0
  .long 0x81081e0
  .long 0x8108200
  .long 0x8108230
  .long 0x8108250
  .long 0x8108270
  .long 0x8138220
  .long 0x81082a0
  .long 0x81082c0
  .long 0x81082e0
  .long 0x8108310
  .long 0x8108330
  .long 0x8108350
  .long 0x8138300
  .long 0x8108380
  .long 0x81083a0
  .long 0x81083c0
  .long 0x81083f0
  .long 0x8108410
  .long 0x8108430
  .long 0x81383e0
  .long 0x8108460
  .long 0x8108480
  .long 0x81084a0
  .long 0x81084d0
  .long 0x81084f0
  .long 0x8108510
  .long 0x81384c0
  .long 0x8108540
  .long 0x8108560
  .long 0x8108580
  .long 0x81085b0
  .long 0x81085d0
  .long 0x81085f0
  .long 0x81385a0
  .long 0x8108620
  .long 0x8108640
  .long 0x8108660
  .long 0x8108690
  .long 0x8118680
.size Lrtab, 456
Lcode_end:
.set CODE_BYTES, Lcode_end - sequential_preLN__sliding_block__mixer_s_mlp__prompt_kernel - 64
.section .rodata,"a"
.p2align 6
.amdhsa_kernel sequential_preLN__sliding_block__mixer_s_mlp__prompt_kernel
  .amdhsa_next_free_vgpr 512
  .amdhsa_next_free_sgpr 102
  .amdhsa_accum_offset 256
  .amdhsa_group_segment_fixed_size 0
  .amdhsa_kernarg_size 88
  .amdhsa_user_sgpr_count 2
  .amdhsa_user_sgpr_kernarg_segment_ptr 1
  .amdhsa_system_sgpr_workgroup_id_x 1
.end_amdhsa_kernel
```
